```python
import torch

def _softmax(x, axis=-1):
    return torch.softmax(x, dim=axis)
def _gelu(x):
    return torch.nn.functional.gelu(x, approximate="tanh")
def _silu(x):
    return torch.nn.functional.silu(x)
def _sigmoid(x):
    return torch.sigmoid(x)
def _layernorm(x, axis=-1, eps=1e-5):
    m = x.mean(dim=axis, keepdim=True)
    v = x.var(dim=axis, keepdim=True, unbiased=False)
    return (x - m) / torch.sqrt(v + eps)
def _scatter_add(tgt, idx, src, axis=0):
    return tgt.clone().index_add_(axis, idx, src)
def _segment_sum(src, seg, n):
    out = torch.zeros((n,) + src.shape[1:], dtype=src.dtype)
    return out.index_add_(0, seg, src)
def _pad(x, pw):
    flat = tuple(v for pair in reversed(pw) for v in pair)
    return torch.nn.functional.pad(x, flat)

kernel_name = 'gated_mix__ssm_conv_h3__glu_gated_swiglu__prompt'

def setup_inputs():

    _w = (lambda a: (lambda t: t.to(torch.bfloat16) if t.is_floating_point() else t)(torch.as_tensor(a)))
    def _A_setup():
        B, S, D = 1, 2048, 576
        ks = 4
        return {
            "q": _w((lambda *s: torch.randn(*s, dtype=torch.bfloat16) * 0.05)(B, S, D)),
            "k": _w((lambda *s: torch.randn(*s, dtype=torch.bfloat16) * 0.05)(B, S, D)),
            "v": _w((lambda *s: torch.randn(*s, dtype=torch.bfloat16) * 0.05)(B, S, D)),
            "shift_k": _w((lambda *s: torch.randn(*s, dtype=torch.bfloat16) * 0.05)(D, ks) * 0.5),
            "ssm_k": _w((lambda *s: torch.randn(*s, dtype=torch.bfloat16) * 0.05)(D, S) * (1.0 / S ** 0.5)),
            "ssm_D": _w((lambda *s: torch.randn(*s, dtype=torch.bfloat16) * 0.05)(D)),
        }
    _A_in = _A_setup()

    def _B_setup():
        B, S, D, F = 1, 2048, 576, 4608
        return {
            "x": _w((lambda *s: torch.randn(*s, dtype=torch.bfloat16) * 0.05)(B, S, D)),
            "w1": _w((lambda *s: torch.randn(*s, dtype=torch.bfloat16) * 0.05)(D, F) * (2.0 / D) ** 0.5),
            "w3": _w((lambda *s: torch.randn(*s, dtype=torch.bfloat16) * 0.05)(D, F) * (2.0 / D) ** 0.5),
            "w2": _w((lambda *s: torch.randn(*s, dtype=torch.bfloat16) * 0.05)(F, D) * (2.0 / F) ** 0.5),
        }
    _B_in = _B_setup()

    return {
        "A_q": _A_in["q"],
        "A_k": _A_in["k"],
        "A_v": _A_in["v"],
        "A_shift_k": _A_in["shift_k"],
        "A_ssm_k": _A_in["ssm_k"],
        "A_ssm_D": _A_in["ssm_D"],
        "B_x": _B_in["x"],
        "B_w1": _B_in["w1"],
        "B_w3": _B_in["w3"],
        "B_w2": _B_in["w2"],
        "gate_w": _w((lambda *s: torch.randn(*s, dtype=torch.bfloat16) * 0.05)(576) * 16.0),
    }

def reference(A_q, A_k, A_v, A_shift_k, A_ssm_k, A_ssm_D, B_x, B_w1, B_w3, B_w2, gate_w):
    def _A_ref(q, k, v, shift_k, ssm_k, ssm_D):
        B, S, D = q.shape
        ks = shift_k.shape[-1]
        k_pad = _pad(k, ((0, 0), (ks - 1, 0), (0, 0)))
        k_shift = torch.zeros_like(k)
        for t in range(ks):
            k_shift = k_shift + k_pad[:, t:t + S, :] * shift_k[:, ks - 1 - t][None, None, :]
        kv = k_shift * v
        L = 2 * S
        kv_pad = _pad(kv, ((0, 0), (0, S), (0, 0)))
        kf_pad = _pad(ssm_k, ((0, 0), (0, S)))
        kv_f = (lambda x, axes=(-2,-1): torch.fft.rfft2(x.float(), dim=axes))(kv_pad[:, None, :, :], axes=(1, 2))
        kf_f = (lambda x, axes=(-2,-1): torch.fft.rfft2(x.float(), dim=axes))(kf_pad[:, None, :], axes=(1, 2))
        kf_f = (lambda x, *d: x.permute(*d))(kf_f, 1, 2, 0)
        y_f = kv_f * kf_f[None, :, :, :]
        y = (lambda x, s, axes=(-2,-1): torch.fft.irfft2(x, s=s, dim=axes).to(torch.bfloat16))(y_f, (1, L), axes=(1, 2))[:, 0, :S, :]
        y = y + kv * ssm_D[None, None, :]
        return q * y

    def _B_ref(x, w1, w3, w2):
        gate = torch.einsum("bsd,df->bsf", x, w1)
        up = torch.einsum("bsd,df->bsf", x, w3)
        h = _silu(gate) * up
        out = torch.einsum("bsf,fd->bsd", h, w2)
        return out

    x = A_q
    g = _sigmoid((x * gate_w).sum(-1, keepdims=True))
    a = _A_ref(x, A_k, A_v, A_shift_k, A_ssm_k, A_ssm_D)
    b = _B_ref(x, B_w1, B_w3, B_w2)
    return g * a + (1 - g) * b
```

```asm
; @launch grid=(256,1,1) block=(256,1,1) lds=163840
.amdgcn_target "amdgcn-amd-amdhsa--gfx950"
.text
.globl gated_mix__ssm_conv_h3__glu_gated_swiglu__prompt_kernel
.p2align 12
.p2align 8
.type gated_mix__ssm_conv_h3__glu_gated_swiglu__prompt_kernel,@function
gated_mix__ssm_conv_h3__glu_gated_swiglu__prompt_kernel:
    s_cmp_ge_u32 s2, 256
    s_cbranch_scc1 KF_END
    s_load_dwordx16 s[4:19], s[0:1], 0
    s_load_dwordx8 s[20:27], s[0:1], 64
    s_load_dwordx4 s[28:31], s[0:1], 96
    v_lshrrev_b32 v245, 6, v0
    v_and_b32 v248, 63, v0
    s_getpc_b64 s[44:45]
KF_PC:
    s_mov_b32 s46, KF_END-KF_PC
    s_mov_b32 s47, 131072
    s_lshr_b32 s88, s2, 3
    v_lshl_add_u32 v246, s88, 2, v245
    v_lshl_add_u32 v246, v248, 7, v246
    v_lshlrev_b32 v246, 7, v246
    s_mov_b64 exec, 31
    buffer_load_dword a253, v246, s[44:47], 0 offen
    s_mov_b64 exec, -1
    s_and_b32 s88, s2, 7
    v_readfirstlane_b32 s52, v245
    s_lshr_b32 s89, s2, 3
    s_and_b32 s90, s88, 1
    s_lshl_b32 s90, s90, 2
    s_and_b32 s97, s89, 3
    s_add_u32 s90, s90, s97
    s_lshr_b32 s53, s88, 1
    s_lshr_b32 s98, s89, 4
    s_lshr_b32 s91, s89, 1
    s_and_b32 s91, s91, 6
    s_or_b32 s91, s91, s98
    s_mul_i32 s97, s53, 18
    s_lshl_b32 s93, s53, 1
    s_sub_u32 s93, 3, s93
    s_xor_b32 s93, s93, s91
    s_and_b32 s98, s93, 7
    s_cselect_b32 s92, s91, 16
    s_xor_b32 s93, s93, 4
    s_xor_b32 s94, s91, 12
    s_and_b32 s93, s93, 7
    s_cselect_b32 s94, s94, 17
    s_sub_u32 s94, s94, s92
    s_lshl_b32 s94, s94, 7
    s_add_u32 s92, s92, s97
    s_add_u32 s54, s91, s89
    s_and_b32 s54, s54, 3
    s_lshl_b32 s54, s54, 1
    s_mul_i32 s99, s54, 589824
    s_lshr_b32 s95, s52, 1
    s_and_b32 s96, s52, 1
    v_lshrrev_b32 v212, 3, v248
    s_lshl_b32 s100, s96, 5
    v_add_u32 v245, s100, v212
    v_mul_u32_u24 v242, 9216, v245
    v_bfe_u32 v245, v248, 1, 2
    v_bfe_u32 v246, v248, 4, 1
    s_lshl_b32 s97, s95, 1
    v_add_u32 v246, s97, v246
    v_xor_b32 v245, v245, v246
    v_lshl_add_u32 v242, v245, 5, v242
    v_and_b32 v213, 1, v248
    v_lshl_add_u32 v242, v213, 4, v242
    s_lshl_b32 s97, s92, 7
    s_add_u32 s97, s97, s99
    v_add_u32 v242, s97, v242
    s_lshl_b32 s55, s52, 12
    s_mov_b32 s58, 72704
    s_mov_b32 s59, 145408
    s_mov_b32 s60, 218112
    s_mov_b32 s38, 5308416
    s_mov_b32 s39, 131072
    s_mov_b32 m0, s55
    s_lshl_b32 s97, s90, 8
    s_lshl_b32 s98, s52, 6
    s_add_u32 s97, s97, s98
    v_add_u32 v245, s97, v212
    v_mul_u32_u24 v240, 1152, v245
    s_lshl_b32 s98, s54, 7
    v_add_u32 v240, s98, v240
    v_lshrrev_b32 v245, 4, v248
    v_and_b32 v246, 7, v248
    v_xor_b32 v245, v245, v246
    v_xor_b32 v246, 4, v245
    v_lshl_add_u32 v241, v246, 4, v240
    v_lshl_add_u32 v240, v245, 4, v240
    s_lshl_b32 s57, s52, 13
    s_mov_b32 s34, 2359296
    s_mov_b32 s35, 131072
    s_mov_b32 s61, 8192
    s_mov_b32 s62, 16384
    s_mov_b32 s63, 24576
    s_mov_b32 s64, 36864
    s_mov_b32 s65, 45056
    s_mov_b32 s66, 53248
    s_mov_b32 s67, 61440
    s_waitcnt lgkmcnt(0)
    s_cmp_eq_u32 s95, 0
    s_cselect_b32 s36, s18, s20
    s_cselect_b32 s37, s19, s21
    buffer_load_dwordx4 v242, s[36:39], 0 offen lds
    buffer_load_dwordx4 v242, s[36:39], s58 offen offset:1024 lds
    buffer_load_dwordx4 v242, s[36:39], s59 offen offset:2048 lds
    buffer_load_dwordx4 v242, s[36:39], s60 offen offset:3072 lds
    s_mov_b64 s[32:33], s[4:5]
    s_add_u32 m0, s57, 65536
    s_nop 0
    buffer_load_dwordx4 v240, s[32:35], 0 offen lds
    s_mov_b64 s[40:41], s[30:31]
    s_lshr_b32 s56, s55, 2
    s_mov_b32 s42, 37478400
    s_mov_b32 s43, 131072
    s_mov_b32 s47, 131072
    s_mov_b32 s51, 131072
    s_mov_b32 s3, 20000
    s_lshl_b32 s97, s90, 3
    s_add_u32 s97, s97, s91
    buffer_load_dwordx4 v241, s[32:35], s61 offen offset:1024 lds
    s_lshl_b32 s97, s97, 2
    s_add_u32 s97, s97, s53
    s_lshl_b32 s97, s97, 2
    s_add_u32 s97, s97, s52
    v_and_b32 v253, 31, v248
    v_mul_u32_u24 v253, 12, v253
    v_lshrrev_b32 v251, 5, v248
    v_mul_u32_u24 v252, 1152, v251
    v_add_u32 v252, v252, v253
    buffer_load_dwordx4 v240, s[32:35], s62 offen offset:2048 lds
    s_mul_i32 s98, s97, 2304
    v_add_u32 v252, s98, v252
    v_lshlrev_b32 v251, 2, v251
    s_lshl_b32 s97, s97, 3
    v_add_u32 v251, s97, v251
    v_bfe_u32 v214, v248, 1, 1
    v_bfe_u32 v215, v248, 2, 2
    v_lshrrev_b32 v219, 5, v248
    v_lshl_add_u32 v245, v219, 3, v215
    buffer_load_dwordx4 v241, s[32:35], s63 offen offset:3072 lds
    v_bfe_u32 v246, v248, 4, 1
    v_lshlrev_b32 v246, 4, v246
    v_lshl_add_u32 v246, v213, 3, v246
    v_lshl_add_u32 v216, v245, 7, v246
    v_lshl_add_u32 v216, v214, 13, v216
    v_lshrrev_b32 v217, 1, v215
    v_lshl_add_u32 v217, v214, 1, v217
    v_xor_b32 v218, 0, v217
    v_lshl_add_u32 v220, v218, 5, v216
    s_add_u32 m0, s57, 69632
    s_nop 0
    buffer_load_dwordx4 v240, s[32:35], s64 offen lds
    v_xor_b32 v218, 1, v217
    v_lshl_add_u32 v221, v218, 5, v216
    v_xor_b32 v218, 2, v217
    v_lshl_add_u32 v222, v218, 5, v216
    v_xor_b32 v218, 3, v217
    v_lshl_add_u32 v223, v218, 5, v216
    v_lshlrev_b32 v216, 2, v214
    v_lshl_add_u32 v217, v214, 11, v246
    v_xor_b32 v218, v245, v216
    buffer_load_dwordx4 v241, s[32:35], s65 offen offset:1024 lds
    v_lshl_add_u32 v232, v218, 5, v217
    v_lshlrev_b32 v244, 4, v248
    v_and_b32 v216, 31, v248
    v_lshlrev_b32 v216, 7, v216
    s_add_u32 s97, s57, 65536
    v_add_u32 v216, s97, v216
    v_bfe_u32 v217, v248, 1, 3
    v_xor_b32 v217, v217, v219
    v_xor_b32 v218, 0, v217
    buffer_load_dwordx4 v240, s[32:35], s66 offen offset:2048 lds
    v_lshl_add_u32 v236, v218, 4, v216
    v_xor_b32 v218, 2, v217
    v_lshl_add_u32 v237, v218, 4, v216
    v_xor_b32 v218, 4, v217
    v_lshl_add_u32 v238, v218, 4, v216
    v_xor_b32 v218, 6, v217
    v_lshl_add_u32 v239, v218, 4, v216
    s_lshl_b32 s97, s90, 3
    s_lshl_b32 s98, s52, 1
    buffer_load_dwordx4 v241, s[32:35], s67 offen offset:3072 lds
    s_add_u32 s97, s97, s98
    s_mul_i32 s97, s97, 288
    s_mul_i32 s98, s53, 72
    s_add_u32 s97, s97, s98
    s_mul_i32 s98, s91, 6
    s_add_u32 s68, s97, s98
    s_add_u32 s70, s68, 4
    s_lshl_b32 s98, s91, 1
    s_add_u32 s98, s98, 48
    s_or_b32 s86, s2, s52
    s_cmp_lg_u32 s86, 0
    s_cbranch_scc1 KF_NONONCE
    s_memrealtime s[86:87]
    v_mov_b32 v254, 0
    s_waitcnt lgkmcnt(0)
    s_or_b32 s86, s86, 1
    v_mov_b32 v255, s86
    s_mov_b64 exec, 1
    global_store_dword v254, v255, s[28:29] sc1
    s_mov_b64 exec, -1
KF_NONONCE:
    s_mov_b64 exec, 0
    s_cmp_eq_u32 s52, 0
    s_cbranch_scc1 KF_PG1
    s_cmp_eq_u32 s52, 1
    s_cbranch_scc1 KF_PG2
    s_cmp_eq_u32 s52, 2
    s_cbranch_scc1 KF_PG3
    s_branch KF_PG4
KF_WMID:
    s_mov_b64 exec, -1
    v_add_u32 v242, 589824, v242
    s_add_u32 m0, s55, 16384
    s_nop 0
    buffer_load_dwordx4 v242, s[36:39], 0 offen lds
    s_add_u32 s72, s97, s98
    s_add_u32 s98, s91, 64
    s_add_u32 s74, s97, s98
    s_lshl_b32 s68, s68, 10
    s_add_u32 s69, s68, 294912
    s_lshl_b32 s70, s70, 10
    s_add_u32 s71, s70, 294912
    s_lshl_b32 s72, s72, 10
    s_add_u32 s73, s72, 294912
    buffer_load_dwordx4 v242, s[36:39], s58 offen offset:1024 lds
    s_lshl_b32 s74, s74, 10
    s_add_u32 s75, s74, 294912
    s_lshl_b32 s97, s90, 2
    s_add_u32 s97, s97, s53
    s_lshl_b32 s97, s97, 2
    s_add_u32 s97, s97, s52
    s_lshl_b32 s97, s97, 7
    s_lshl_b32 s98, s91, 2
    s_add_u32 s97, s97, s98
    buffer_load_dwordx4 v242, s[36:39], s59 offen offset:2048 lds
    s_add_u32 s101, s97, 36282368
    s_mov_b32 s76, 0xbfb8aa3b
    s_mov_b32 s99, 0xffff0000
    s_mul_i32 s80, s52, 9216
    s_add_u32 s80, s80, 131072
    v_lshrrev_b32 v212, 3, v248
    v_mul_u32_u24 v212, 1152, v212
    v_and_b32 v213, 7, v248
    v_lshl_add_u32 v212, v213, 4, v212
    buffer_load_dwordx4 v242, s[36:39], s60 offen offset:3072 lds
    s_mov_b32 s17, s94
    s_lshl_b32 s83, s53, 3
    s_add_u32 s83, s83, s91
    s_mul_i32 s83, s83, 36864
    s_lshl_b32 s84, s54, 12
    s_add_u32 s83, s83, s84
    s_add_u32 s83, s83, s56
    s_add_u32 s16, s83, 36298752
    s_sub_u32 s84, s2, 128
    v_add_u32 v240, 128, v240
    v_add_u32 v241, 128, v241
    s_add_u32 m0, s57, 98304
    s_nop 0
    buffer_load_dwordx4 v240, s[32:35], 0 offen lds
    s_cmp_lt_u32 s84, 16
    s_cselect_b32 s85, 2, 3
    s_cmp_ge_u32 s52, s85
    s_cselect_b32 s90, -1, 0
    s_mov_b32 s91, s90
    s_add_u32 s84, s84, 256
    s_cmp_eq_u32 s52, 3
    s_cselect_b32 s83, s2, s84
    s_and_b32 s83, s83, s90
    s_add_u32 s83, s83, 1024
    s_mul_i32 s84, s83, 7282
    s_lshr_b32 s84, s84, 16
    buffer_load_dwordx4 v241, s[32:35], s61 offen offset:1024 lds
    s_mul_i32 s85, s84, 9
    s_sub_u32 s83, s83, s85
    s_mul_i32 s85, s84, 36864
    s_lshl_b32 s89, s83, 7
    s_add_u32 s92, s85, s89
    v_add_u32 v246, s92, v212
    s_mul_i32 s85, s84, 57
    s_lshr_b32 s85, s85, 11
    s_lshl_b32 s89, s85, 2
    buffer_load_dwordx4 v240, s[32:35], s62 offen offset:2048 lds
    s_sub_u32 s89, 6, s89
    s_and_b32 s89, s89, 14
    s_mul_i32 s85, s85, 36
    s_sub_u32 s84, s84, s85
    s_lshr_b32 s93, s84, 3
    s_and_b32 s93, s93, 2
    s_add_u32 s93, s93, 32
    s_xor_b32 s86, s89, s84
    s_and_b32 s86, s86, 46
    s_cselect_b32 s93, s84, s93
    s_lshl_b32 s86, s84, 3
    s_and_b32 s86, s86, 16
    s_add_u32 s89, s89, s86
    buffer_load_dwordx4 v241, s[32:35], s63 offen offset:3072 lds
    s_cmp_ge_u32 s84, 32
    s_cselect_b32 s93, s89, s93
    s_and_b32 s84, s84, 1
    s_or_b32 s84, s84, s93
    s_lshr_b32 s89, s84, 4
    s_lshl_b32 s89, s89, 1
    s_and_b32 s93, s84, 1
    s_add_u32 s93, s93, s89
    s_lshl_b32 s89, s89, 2
    s_xor_b32 s89, s89, s84
    s_add_u32 m0, s57, 102400
    s_nop 0
    buffer_load_dwordx4 v240, s[32:35], s64 offen lds
    s_bfe_u32 s89, s89, 0x30001
    s_cmp_eq_u32 s93, 3
    s_cselect_b32 s86, 1, 3
    s_cselect_b32 s93, 24, s93
    s_mul_i32 s89, s89, s86
    s_add_u32 s89, s89, s93
    s_cmp_lt_u32 s84, 32
    s_cselect_b32 s89, s89, s84
    s_add_u32 s89, s89, s85
    s_mul_i32 s89, s89, 9
    s_add_u32 s89, s89, s83
    s_lshl_b32 s89, s89, 12
    s_add_u32 s89, s89, 18874368
    buffer_load_dwordx4 v241, s[32:35], s65 offen offset:1024 lds
    v_lshrrev_b32 v245, 5, v248
    v_lshlrev_b32 v245, 4, v245
    v_bfe_u32 v213, v248, 4, 1
    v_lshl_add_u32 v245, v213, 2, v245
    v_bfe_u32 v213, v248, 2, 2
    v_add_u32 v245, v245, v213
    v_lshlrev_b32 v245, 7, v245
    v_and_b32 v213, 3, v248
    v_lshl_add_u32 v245, v213, 3, v245
    buffer_load_dwordx4 v240, s[32:35], s66 offen offset:2048 lds
    v_add_u32 v245, s80, v245
    s_lshl_b32 s83, s2, 1
    s_add_u32 s83, s83, s52
    s_xor_b32 s84, s2, 64
    s_add_u32 s84, s84, 512
    s_cmp_lt_u32 s52, 2
    s_cselect_b32 s83, s83, s84
    s_cmp_lt_u32 s83, 576
    s_cselect_b32 s85, -1, 0
    s_cmp_lt_u32 s52, 3
    s_cselect_b32 s78, s85, 0
    s_mov_b32 s79, s78
    buffer_load_dwordx4 v241, s[32:35], s67 offen offset:3072 lds
    s_and_b32 s83, s83, s78
    s_mul_i32 s84, s83, 7282
    s_lshr_b32 s84, s84, 16
    s_mul_i32 s85, s84, 9
    s_sub_u32 s85, s83, s85
    s_mul_i32 s83, s84, 36864
    s_lshl_b32 s81, s85, 7
    s_add_u32 s83, s83, s81
    v_add_u32 v212, s83, v212
    s_mov_b64 exec, 0
    s_cmp_lt_u32 s2, 64
    s_cbranch_scc1 KF_WT
    s_cmp_eq_u32 s52, 0
    s_cbranch_scc1 KF_PG8
    s_cmp_eq_u32 s52, 1
    s_cbranch_scc1 KF_PG7
    s_cmp_eq_u32 s52, 2
    s_cbranch_scc1 KF_THREE
    s_branch KF_PG9
KF_WT:
    s_cmp_eq_u32 s52, 0
    s_cbranch_scc1 KF_PG8
    s_cmp_eq_u32 s52, 1
    s_cbranch_scc1 KF_PG7
    s_cmp_eq_u32 s52, 2
    s_cbranch_scc1 KF_THREE
    s_branch KF_PG9
KF_WEND:
    s_mov_b64 exec, -1
    s_cmp_eq_u32 s54, 6
    s_mov_b32 s82, 589824
    s_cselect_b32 s82, 0xffc10000, s82
    v_add_u32 v242, s82, v242
    s_add_u32 m0, s55, 32768
    s_nop 0
    buffer_load_dwordx4 v242, s[36:39], 0 offen lds
    v_subrev_u32 v213, 4608, v212
    v_add_u32 v214, 4608, v212
    v_and_b32 v218, 15, v248
    v_lshlrev_b32 v215, 3, v218
    s_lshl_b32 s83, s85, 9
    v_add_u32 v215, s83, v215
    v_lshrrev_b32 v219, 4, v248
    v_lshlrev_b32 v250, 12, v218
    v_lshlrev_b32 v218, 4, v219
    buffer_load_dwordx4 v242, s[36:39], s58 offen offset:1024 lds
    v_sub_u32 v250, v250, v218
    s_lshl_b32 s83, s85, 18
    s_lshl_b32 s84, s84, 6
    s_sub_u32 s83, s83, s84
    s_add_u32 s83, s83, 24186864
    v_add_u32 v250, s83, v250
    v_bfe_u32 v218, v248, 2, 2
    v_lshl_add_u32 v218, v219, 3, v218
    v_lshlrev_b32 v249, 7, v218
    buffer_load_dwordx4 v242, s[36:39], s59 offen offset:2048 lds
    v_and_b32 v218, 3, v248
    v_lshl_add_u32 v249, v218, 3, v249
    s_min_u32 s83, s80, 149504
    v_add_u32 v249, s83, v249
    v_bfe_u32 v218, v248, 1, 2
    v_mul_u32_u24 v224, 9216, v218
    v_lshrrev_b32 v218, 3, v248
    v_lshl_add_u32 v224, v218, 5, v224
    v_mul_u32_u24 v243, 36864, v218
    buffer_load_dwordx4 v242, s[36:39], s60 offen offset:3072 lds
    v_lshrrev_b32 v218, 5, v248
    v_mul_u32_u24 v218, 896, v218
    v_add_u32 v224, v218, v224
    v_and_b32 v218, 1, v248
    v_lshl_add_u32 v224, v218, 4, v224
    v_mov_b32 v228, v224
    v_and_b32 v218, 7, v248
    v_lshl_add_u32 v243, v218, 4, v243
    s_lshl_b32 s83, s2, 1
    v_add_u32 v242, 589824, v242
    s_add_u32 m0, s55, 49152
    s_nop 0
    buffer_load_dwordx4 v242, s[36:39], 0 offen lds
    s_add_u32 s83, s83, s96
    s_and_b32 s84, s83, 3
    s_lshr_b32 s83, s83, 2
    s_mul_i32 s18, s83, 36864
    s_mul_i32 s85, s84, 2304
    s_add_u32 s18, s18, s85
    s_lshl_b32 s85, s84, 8
    s_sub_u32 s85, 384, s85
    s_and_b32 s85, s85, 896
    buffer_load_dwordx4 v242, s[36:39], s58 offen offset:1024 lds
    s_add_u32 s18, s18, s85
    s_mul_i32 s30, s84, 294912
    s_lshr_b32 s84, s83, 4
    s_lshl_b32 s84, s84, 1
    s_add_u32 s84, s84, s95
    s_lshl_b32 s84, s84, 4
    s_and_b32 s83, s83, 15
    s_xor_b32 s83, s83, s95
    s_add_u32 s83, s83, s84
    buffer_load_dwordx4 v242, s[36:39], s59 offen offset:2048 lds
    s_lshl_b32 s83, s83, 7
    s_add_u32 s83, s83, 36298752
    s_add_u32 s30, s30, s83
    s_add_u32 s83, s52, 1
    s_and_b32 s83, s83, 2
    s_cmp_lt_u32 s2, 64
    s_cselect_b32 s83, s83, 0
    s_cmp_lg_u32 s83, 0
    s_cselect_b64 s[20:21], -1, 0
    s_and_b32 s83, s2, 63
    s_add_u32 s83, s83, 512
    buffer_load_dwordx4 v242, s[36:39], s60 offen offset:3072 lds
    s_and_b32 s84, s83, 3
    s_lshr_b32 s83, s83, 2
    s_mul_i32 s19, s83, 36864
    s_mul_i32 s85, s84, 2304
    s_add_u32 s19, s19, s85
    s_lshl_b32 s85, s84, 8
    s_sub_u32 s85, 384, s85
    s_and_b32 s85, s85, 896
    s_add_u32 s19, s19, s85
    s_mul_i32 s31, s84, 294912
    s_lshr_b32 s84, s83, 4
    s_lshl_b32 s84, s84, 1
    s_add_u32 s84, s84, s95
    s_lshl_b32 s84, s84, 4
    s_and_b32 s83, s83, 15
    s_xor_b32 s83, s83, s95
    s_add_u32 s83, s83, s84
    s_lshl_b32 s83, s83, 7
    s_add_u32 s83, s83, 36298752
    s_add_u32 s31, s31, s83
    s_waitcnt vmcnt(28)
    s_barrier
    ds_read_b64_tr_b16 v[192:193], v220
    ds_read_b64_tr_b16 v[194:195], v220 offset:512
    ds_read_b64_tr_b16 v[196:197], v221
    ds_read_b64_tr_b16 v[198:199], v221 offset:512
    ds_read_b64_tr_b16 v[200:201], v222
    ds_read_b64_tr_b16 v[202:203], v222 offset:512
    ds_read_b64_tr_b16 v[204:205], v223
    ds_read_b64_tr_b16 v[206:207], v223 offset:512
    s_waitcnt vmcnt(24)
    ds_read_b128 v[0:3], v236
    ds_read_b128 v[8:11], v237
    ds_read_b128 v[16:19], v238
    ds_read_b128 v[24:27], v239
    s_waitcnt vmcnt(20)
    ds_read_b128 v[4:7], v236 offset:4096
    ds_read_b128 v[12:15], v237 offset:4096
    ds_read_b128 v[20:23], v238 offset:4096
    ds_read_b128 v[28:31], v239 offset:4096
    s_waitcnt lgkmcnt(0)
    v_mfma_f32_32x32x16_bf16 v[32:47], v[192:195], v[0:3], 0
    ds_read_b64_tr_b16 v[208:209], v220 offset:2048
    s_cmp_eq_u32 s54, 6
    s_mov_b32 s82, 128
    s_cselect_b32 s82, 0xfffffc80, s82
    v_add_u32 v240, s82, v240
    v_add_u32 v241, s82, v241
    v_mfma_f32_32x32x16_bf16 v[48:63], v[192:195], v[4:7], 0
    ds_read_b64_tr_b16 v[210:211], v220 offset:2560
    s_add_u32 m0, s57, 65536
    s_nop 0
    buffer_load_dwordx4 v240, s[32:35], 0 offen lds
    v_mfma_f32_32x32x16_bf16 v[64:79], v[196:199], v[0:3], 0
    ds_read_b64_tr_b16 v[192:193], v221 offset:2048
    s_lshr_b32 s97, s2, 3
    v_mfma_f32_32x32x16_bf16 v[80:95], v[196:199], v[4:7], 0
    ds_read_b64_tr_b16 v[194:195], v221 offset:2560
    buffer_load_dwordx4 v241, s[32:35], s61 offen offset:1024 lds
    v_mfma_f32_32x32x16_bf16 v[96:111], v[200:203], v[0:3], 0
    ds_read_b64_tr_b16 v[196:197], v222 offset:2048
    s_lshl_b32 s98, s97, 1
    v_mfma_f32_32x32x16_bf16 v[112:127], v[200:203], v[4:7], 0
    ds_read_b64_tr_b16 v[198:199], v222 offset:2560
    buffer_load_dwordx4 v240, s[32:35], s62 offen offset:2048 lds
    v_mfma_f32_32x32x16_bf16 v[128:143], v[204:207], v[0:3], 0
    ds_read_b64_tr_b16 v[200:201], v223 offset:2048
    s_and_b32 s100, s52, 1
    v_mfma_f32_32x32x16_bf16 v[144:159], v[204:207], v[4:7], 0
    ds_read_b64_tr_b16 v[202:203], v223 offset:2560
    buffer_load_dwordx4 v241, s[32:35], s63 offen offset:3072 lds
    s_add_u32 m0, s57, 69632
    s_waitcnt lgkmcnt(4)
    v_mfma_f32_32x32x16_bf16 v[32:47], v[208:211], v[8:11], v[32:47]
    ds_read_b64_tr_b16 v[204:205], v220 offset:4096
    s_add_u32 s98, s98, s100
    v_mfma_f32_32x32x16_bf16 v[48:63], v[208:211], v[12:15], v[48:63]
    ds_read_b64_tr_b16 v[206:207], v220 offset:4608
    buffer_load_dwordx4 v240, s[32:35], s64 offen lds
    v_mfma_f32_32x32x16_bf16 v[64:79], v[192:195], v[8:11], v[64:79]
    ds_read_b64_tr_b16 v[208:209], v221 offset:4096
    s_add_u32 s100, s98, 512
    v_mfma_f32_32x32x16_bf16 v[80:95], v[192:195], v[12:15], v[80:95]
    ds_read_b64_tr_b16 v[210:211], v221 offset:4608
    buffer_load_dwordx4 v241, s[32:35], s65 offen offset:1024 lds
    s_waitcnt lgkmcnt(4)
    v_mfma_f32_32x32x16_bf16 v[96:111], v[196:199], v[8:11], v[96:111]
    ds_read_b64_tr_b16 v[192:193], v222 offset:4096
    s_waitcnt vmcnt(18)
    ds_read_b128 a[0:3], v236 offset:32768
    s_mul_i32 s100, s100, 9216
    v_mfma_f32_32x32x16_bf16 v[112:127], v[196:199], v[12:15], v[112:127]
    ds_read_b64_tr_b16 v[194:195], v222 offset:4608
    ds_read_b128 a[8:11], v237 offset:32768
    buffer_load_dwordx4 v240, s[32:35], s66 offen offset:2048 lds
    v_mfma_f32_32x32x16_bf16 v[128:143], v[200:203], v[8:11], v[128:143]
    ds_read_b64_tr_b16 v[196:197], v223 offset:4096
    ds_read_b128 a[16:19], v238 offset:32768
    s_mul_i32 s98, s98, 73728
    v_mfma_f32_32x32x16_bf16 v[144:159], v[200:203], v[12:15], v[144:159]
    ds_read_b64_tr_b16 v[198:199], v223 offset:4608
    ds_read_b128 a[24:27], v239 offset:32768
    buffer_load_dwordx4 v241, s[32:35], s67 offen offset:3072 lds
    s_mov_b64 s[44:45], s[24:25]
    s_waitcnt lgkmcnt(8)
    v_mfma_f32_32x32x16_bf16 v[32:47], v[204:207], v[16:19], v[32:47]
    ds_read_b64_tr_b16 v[200:201], v220 offset:6144
    s_waitcnt vmcnt(16)
    ds_read_b128 a[4:7], v236 offset:36864
    s_mov_b32 s46, 1152
    s_lshl_b32 s94, s53, 1
    v_mfma_f32_32x32x16_bf16 v[48:63], v[204:207], v[20:23], v[48:63]
    ds_read_b64_tr_b16 v[202:203], v220 offset:6656
    ds_read_b128 a[12:15], v237 offset:36864
    buffer_load_dwordx3 v[160:162], v252, s[32:35], 0 offen
    v_mfma_f32_32x32x16_bf16 v[64:79], v[208:211], v[16:19], v[64:79]
    ds_read_b64_tr_b16 v[204:205], v221 offset:6144
    ds_read_b128 a[20:23], v238 offset:36864
    buffer_load_dwordx3 v[164:166], v253, s[44:47], 0 offen
    s_sub_u32 s94, 3, s94
    v_mfma_f32_32x32x16_bf16 v[80:95], v[208:211], v[20:23], v[80:95]
    ds_read_b64_tr_b16 v[206:207], v221 offset:6656
    ds_read_b128 a[28:31], v239 offset:36864
    buffer_load_dwordx3 v[168:170], v252, s[32:35], 0 offen offset:384
    s_waitcnt lgkmcnt(9)
    v_mfma_f32_32x32x16_bf16 v[96:111], v[192:195], v[16:19], v[96:111]
    ds_read_b64_tr_b16 v[208:209], v222 offset:6144
    s_and_b32 s94, s94, 7
    v_mfma_f32_32x32x16_bf16 v[112:127], v[192:195], v[20:23], v[112:127]
    ds_read_b64_tr_b16 v[210:211], v222 offset:6656
    buffer_load_dwordx3 v[172:174], v253, s[44:47], 0 offen offset:384
    v_mfma_f32_32x32x16_bf16 v[128:143], v[196:199], v[16:19], v[128:143]
    ds_read_b64_tr_b16 v[192:193], v223 offset:6144
    buffer_load_dwordx3 v[176:178], v252, s[32:35], 0 offen offset:768
    s_add_u32 s98, s98, 2176
    v_mfma_f32_32x32x16_bf16 v[144:159], v[196:199], v[20:23], v[144:159]
    ds_read_b64_tr_b16 v[194:195], v223 offset:6656
    s_waitcnt lgkmcnt(4)
    s_barrier
    buffer_load_dwordx3 v[180:182], v253, s[44:47], 0 offen offset:768
    v_mfma_f32_32x32x16_bf16 v[32:47], v[200:203], v[24:27], v[32:47]
    ds_read_b64_tr_b16 v[196:197], v220 offset:16384
    v_add_u32 v240, 128, v240
    v_add_u32 v241, 128, v241
    s_add_u32 m0, s57, 98304
    s_nop 0
    buffer_load_dwordx4 v240, s[32:35], 0 offen lds
    v_mfma_f32_32x32x16_bf16 v[48:63], v[200:203], v[28:31], v[48:63]
    ds_read_b64_tr_b16 v[198:199], v220 offset:16896
    v_and_b32 v254, 7, v248
    v_mul_u32_u24 v255, 9216, v254
    v_mfma_f32_32x32x16_bf16 v[64:79], v[204:207], v[24:27], v[64:79]
    ds_read_b64_tr_b16 v[200:201], v221 offset:16384
    v_add_u32 v255, s98, v255
    buffer_load_dwordx4 v241, s[32:35], s61 offen offset:1024 lds
    v_mfma_f32_32x32x16_bf16 v[80:95], v[204:207], v[28:31], v[80:95]
    ds_read_b64_tr_b16 v[202:203], v221 offset:16896
    v_cmp_eq_u32 vcc, s94, v254
    v_lshrrev_b32 v254, 3, v248
    v_add_u32 v254, 16, v254
    v_cndmask_b32 v254, v248, v254, vcc
    s_waitcnt lgkmcnt(4)
    v_mfma_f32_32x32x16_bf16 v[96:111], v[208:211], v[24:27], v[96:111]
    ds_read_b64_tr_b16 v[204:205], v222 offset:16384
    v_mfma_f32_32x32x16_bf16 v[112:127], v[208:211], v[28:31], v[112:127]
    ds_read_b64_tr_b16 v[206:207], v222 offset:16896
    buffer_load_dwordx4 v240, s[32:35], s62 offen offset:2048 lds
    v_mfma_f32_32x32x16_bf16 v[128:143], v[192:195], v[24:27], v[128:143]
    ds_read_b64_tr_b16 v[208:209], v223 offset:16384
    v_lshl_add_u32 v254, v254, 7, s100
    v_cmp_gt_u32 vcc, 16, v248
    s_nop 1
    v_cndmask_b32 v254, v255, v254, vcc
    v_mfma_f32_32x32x16_bf16 v[144:159], v[192:195], v[28:31], v[144:159]
    ds_read_b64_tr_b16 v[210:211], v223 offset:16896
    buffer_load_dwordx4 v241, s[32:35], s63 offen offset:3072 lds
    s_add_u32 m0, s57, 102400
    s_waitcnt lgkmcnt(4)
    v_mfma_f32_32x32x16_bf16 v[32:47], v[196:199], a[0:3], v[32:47]
    ds_read_b64_tr_b16 v[192:193], v220 offset:18432
    v_mul_u32_u24 v255, 1152, v248
    s_mul_i32 s100, s53, 2304
    v_mfma_f32_32x32x16_bf16 v[48:63], v[196:199], a[4:7], v[48:63]
    ds_read_b64_tr_b16 v[194:195], v220 offset:18944
    buffer_load_dwordx4 v240, s[32:35], s64 offen lds
    s_and_b32 s98, s2, 1
    v_mfma_f32_32x32x16_bf16 v[64:79], v[200:203], a[0:3], v[64:79]
    ds_read_b64_tr_b16 v[196:197], v221 offset:18432
    s_lshl_b32 s98, s98, 5
    v_mfma_f32_32x32x16_bf16 v[80:95], v[200:203], a[4:7], v[80:95]
    ds_read_b64_tr_b16 v[198:199], v221 offset:18944
    buffer_load_dwordx4 v241, s[32:35], s65 offen offset:1024 lds
    s_add_u32 s98, s98, s97
    s_lshl_b32 s98, s98, 2
    s_waitcnt lgkmcnt(4)
    v_mfma_f32_32x32x16_bf16 v[96:111], v[204:207], a[0:3], v[96:111]
    ds_read_b64_tr_b16 v[200:201], v222 offset:18432
    s_add_u32 s98, s98, s52
    v_mfma_f32_32x32x16_bf16 v[112:127], v[204:207], a[4:7], v[112:127]
    ds_read_b64_tr_b16 v[202:203], v222 offset:18944
    buffer_load_dwordx4 v240, s[32:35], s66 offen offset:2048 lds
    s_mul_i32 s98, s98, 9216
    v_mfma_f32_32x32x16_bf16 v[128:143], v[208:211], a[0:3], v[128:143]
    ds_read_b64_tr_b16 v[204:205], v223 offset:18432
    v_mfma_f32_32x32x16_bf16 v[144:159], v[208:211], a[4:7], v[144:159]
    ds_read_b64_tr_b16 v[206:207], v223 offset:18944
    buffer_load_dwordx4 v241, s[32:35], s67 offen offset:3072 lds
    s_mov_b64 s[48:49], s[6:7]
    s_mov_b32 s50, 2359296
    s_waitcnt lgkmcnt(4)
    v_mfma_f32_32x32x16_bf16 v[32:47], v[192:195], a[8:11], v[32:47]
    ds_read_b64_tr_b16 v[208:209], v220 offset:20480
    s_mov_b32 m0, s80
    v_mfma_f32_32x32x16_bf16 v[48:63], v[192:195], a[12:15], v[48:63]
    ds_read_b64_tr_b16 v[210:211], v220 offset:20992
    s_mov_b64 exec, s[78:79]
    buffer_load_dwordx4 v213, s[48:51], 0 offen lds
    s_mov_b64 exec, -1
    s_add_u32 m0, s80, 1024
    v_mfma_f32_32x32x16_bf16 v[64:79], v[196:199], a[8:11], v[64:79]
    ds_read_b64_tr_b16 v[192:193], v221 offset:20480
    s_mov_b64 exec, s[78:79]
    buffer_load_dwordx4 v214, s[48:51], 0 offen lds
    s_mov_b64 exec, -1
    v_mfma_f32_32x32x16_bf16 v[80:95], v[196:199], a[12:15], v[80:95]
    ds_read_b64_tr_b16 v[194:195], v221 offset:20992
    s_mov_b64 exec, s[78:79]
    buffer_load_dwordx4 v214, s[48:51], s61 offen offset:1024 lds
    s_mov_b64 exec, -1
    s_waitcnt lgkmcnt(4)
    v_mfma_f32_32x32x16_bf16 v[96:111], v[200:203], a[8:11], v[96:111]
    ds_read_b64_tr_b16 v[196:197], v222 offset:20480
    s_waitcnt vmcnt(21)
    ds_read_b128 a[32:35], v236
    s_cmp_eq_u32 s53, 1
    s_cselect_b32 s94, 24, 16
    v_mfma_f32_32x32x16_bf16 v[112:127], v[200:203], a[12:15], v[112:127]
    ds_read_b64_tr_b16 v[198:199], v222 offset:20992
    ds_read_b128 a[40:43], v237
    s_mov_b64 exec, s[78:79]
    buffer_load_dwordx4 v214, s[48:51], s62 offen offset:2048 lds
    s_mov_b64 exec, -1
    v_mfma_f32_32x32x16_bf16 v[128:143], v[204:207], a[8:11], v[128:143]
    ds_read_b64_tr_b16 v[200:201], v223 offset:20480
    ds_read_b128 a[48:51], v238
KF_PG1:
    s_cbranch_execz KF_WMID
    s_mov_b64 exec, s[78:79]
    buffer_load_dwordx4 v214, s[48:51], s63 offen offset:3072 lds
    s_mov_b64 exec, -1
    v_mfma_f32_32x32x16_bf16 v[144:159], v[204:207], a[12:15], v[144:159]
    ds_read_b64_tr_b16 v[202:203], v223 offset:20992
    ds_read_b128 a[56:59], v239
    s_mov_b64 s[48:49], s[8:9]
    s_add_u32 m0, s80, 5120
    s_waitcnt lgkmcnt(8)
    v_mfma_f32_32x32x16_bf16 v[32:47], v[208:211], a[16:19], v[32:47]
    ds_read_b64_tr_b16 v[204:205], v220 offset:22528
    s_waitcnt vmcnt(19)
    ds_read_b128 a[36:39], v236 offset:4096
    v_mfma_f32_32x32x16_bf16 v[48:63], v[208:211], a[20:23], v[48:63]
    ds_read_b64_tr_b16 v[206:207], v220 offset:23040
    ds_read_b128 a[44:47], v237 offset:4096
    s_mov_b64 exec, s[78:79]
    buffer_load_dwordx4 v212, s[48:51], 0 offen lds
    s_mov_b64 exec, -1
    v_mfma_f32_32x32x16_bf16 v[64:79], v[192:195], a[16:19], v[64:79]
    ds_read_b64_tr_b16 v[208:209], v221 offset:22528
    ds_read_b128 a[52:55], v238 offset:4096
    s_mov_b64 exec, s[78:79]
    buffer_load_dwordx4 v212, s[48:51], s61 offen offset:1024 lds
    s_mov_b64 exec, -1
    v_mfma_f32_32x32x16_bf16 v[80:95], v[192:195], a[20:23], v[80:95]
    ds_read_b64_tr_b16 v[210:211], v221 offset:23040
    ds_read_b128 a[60:63], v239 offset:4096
    s_waitcnt lgkmcnt(9)
    v_mfma_f32_32x32x16_bf16 v[96:111], v[196:199], a[16:19], v[96:111]
    ds_read_b64_tr_b16 v[192:193], v222 offset:22528
    s_mov_b64 exec, s[78:79]
    buffer_load_dwordx4 v212, s[48:51], s62 offen offset:2048 lds
    s_mov_b64 exec, -1
    v_mfma_f32_32x32x16_bf16 v[112:127], v[196:199], a[20:23], v[112:127]
    ds_read_b64_tr_b16 v[194:195], v222 offset:23040
    s_mov_b64 exec, s[78:79]
    buffer_load_dwordx4 v212, s[48:51], s63 offen offset:3072 lds
    s_mov_b64 exec, -1
    s_mov_b64 s[48:49], s[10:11]
    v_mfma_f32_32x32x16_bf16 v[128:143], v[200:203], a[16:19], v[128:143]
    ds_read_b64_tr_b16 v[196:197], v223 offset:22528
    s_mov_b32 s50, 4608
    buffer_load_dwordx2 v[184:185], v215, s[48:51], 0 offen
    v_mfma_f32_32x32x16_bf16 v[144:159], v[200:203], a[20:23], v[144:159]
    ds_read_b64_tr_b16 v[198:199], v223 offset:23040
    s_waitcnt lgkmcnt(4)
    s_barrier
    buffer_load_dwordx2 v[186:187], v215, s[48:51], 0 offen offset:128
    v_mfma_f32_32x32x16_bf16 v[32:47], v[204:207], a[24:27], v[32:47]
    ds_read_b64_tr_b16 v[200:201], v220 offset:32768
    buffer_load_dwordx2 v[188:189], v215, s[48:51], 0 offen offset:256
    buffer_load_dwordx2 v[190:191], v215, s[48:51], 0 offen offset:384
    v_mfma_f32_32x32x16_bf16 v[48:63], v[204:207], a[28:31], v[48:63]
    ds_read_b64_tr_b16 v[202:203], v220 offset:33280
    s_cmp_eq_u32 s54, 4
    s_mov_b32 s82, 128
    s_cselect_b32 s82, 0xfffffc80, s82
    v_add_u32 v240, s82, v240
    v_add_u32 v241, s82, v241
    v_mfma_f32_32x32x16_bf16 v[64:79], v[208:211], a[24:27], v[64:79]
    ds_read_b64_tr_b16 v[204:205], v221 offset:32768
    s_add_u32 m0, s57, 65536
    s_nop 0
    buffer_load_dwordx4 v240, s[32:35], 0 offen lds
    v_mfma_f32_32x32x16_bf16 v[80:95], v[208:211], a[28:31], v[80:95]
    ds_read_b64_tr_b16 v[206:207], v221 offset:33280
    s_waitcnt lgkmcnt(4)
    v_mfma_f32_32x32x16_bf16 v[96:111], v[192:195], a[24:27], v[96:111]
    ds_read_b64_tr_b16 v[208:209], v222 offset:32768
    buffer_load_dwordx4 v241, s[32:35], s61 offen offset:1024 lds
    v_mfma_f32_32x32x16_bf16 v[112:127], v[192:195], a[28:31], v[112:127]
    ds_read_b64_tr_b16 v[210:211], v222 offset:33280
    v_mfma_f32_32x32x16_bf16 v[128:143], v[196:199], a[24:27], v[128:143]
    ds_read_b64_tr_b16 v[192:193], v223 offset:32768
    buffer_load_dwordx4 v240, s[32:35], s62 offen offset:2048 lds
    v_mfma_f32_32x32x16_bf16 v[144:159], v[196:199], a[28:31], v[144:159]
    ds_read_b64_tr_b16 v[194:195], v223 offset:33280
    s_waitcnt lgkmcnt(4)
    v_mfma_f32_32x32x16_bf16 v[32:47], v[200:203], a[32:35], v[32:47]
    ds_read_b64_tr_b16 v[196:197], v220 offset:34816
    buffer_load_dwordx4 v241, s[32:35], s63 offen offset:3072 lds
    s_add_u32 m0, s57, 69632
    v_mfma_f32_32x32x16_bf16 v[48:63], v[200:203], a[36:39], v[48:63]
    ds_read_b64_tr_b16 v[198:199], v220 offset:35328
    v_mfma_f32_32x32x16_bf16 v[64:79], v[204:207], a[32:35], v[64:79]
    ds_read_b64_tr_b16 v[200:201], v221 offset:34816
    buffer_load_dwordx4 v240, s[32:35], s64 offen lds
    s_waitcnt vmcnt(26)
    v_lshlrev_b32 v179, 16, v160
    v_lshlrev_b32 v183, 16, v164
    v_mfma_f32_32x32x16_bf16 v[80:95], v[204:207], a[36:39], v[80:95]
    ds_read_b64_tr_b16 v[202:203], v221 offset:35328
    v_and_b32 v160, s99, v160
    v_and_b32 v164, s99, v164
    v_mul_f32 v163, v179, v183
    v_mul_f32 v167, v160, v164
    s_waitcnt lgkmcnt(4)
    v_mfma_f32_32x32x16_bf16 v[96:111], v[208:211], a[32:35], v[96:111]
    ds_read_b64_tr_b16 v[204:205], v222 offset:34816
    buffer_load_dwordx4 v241, s[32:35], s65 offen offset:1024 lds
    v_lshlrev_b32 v171, 16, v161
    v_lshlrev_b32 v175, 16, v165
    v_and_b32 v161, s99, v161
    v_mfma_f32_32x32x16_bf16 v[112:127], v[208:211], a[36:39], v[112:127]
    ds_read_b64_tr_b16 v[206:207], v222 offset:35328
    v_and_b32 v165, s99, v165
    v_fmac_f32 v163, v171, v175
    v_fmac_f32 v167, v161, v165
    v_mfma_f32_32x32x16_bf16 v[128:143], v[192:195], a[32:35], v[128:143]
    ds_read_b64_tr_b16 v[208:209], v223 offset:34816
    buffer_load_dwordx4 v240, s[32:35], s66 offen offset:2048 lds
    v_lshlrev_b32 v179, 16, v162
    v_lshlrev_b32 v183, 16, v166
    v_and_b32 v162, s99, v162
    v_mfma_f32_32x32x16_bf16 v[144:159], v[192:195], a[36:39], v[144:159]
    ds_read_b64_tr_b16 v[210:211], v223 offset:35328
    v_and_b32 v166, s99, v166
    v_fmac_f32 v163, v179, v183
    v_fmac_f32 v167, v162, v166
    s_waitcnt lgkmcnt(4)
    v_mfma_f32_32x32x16_bf16 v[32:47], v[196:199], a[40:43], v[32:47]
    ds_read_b64_tr_b16 v[192:193], v220 offset:36864
    buffer_load_dwordx4 v241, s[32:35], s67 offen offset:3072 lds
    s_cmp_eq_u32 s54, 4
    s_mov_b32 s82, 589824
    s_cselect_b32 s82, 0xffc10000, s82
    v_mfma_f32_32x32x16_bf16 v[48:63], v[196:199], a[44:47], v[48:63]
    ds_read_b64_tr_b16 v[194:195], v220 offset:37376
    v_add_u32 v242, s82, v242
    s_add_u32 m0, s55, 0
    v_lshlrev_b32 v171, 16, v168
    v_lshlrev_b32 v175, 16, v172
    v_and_b32 v168, s99, v168
    v_mfma_f32_32x32x16_bf16 v[64:79], v[200:203], a[40:43], v[64:79]
    ds_read_b64_tr_b16 v[196:197], v221 offset:36864
    buffer_load_dwordx4 v242, s[36:39], 0 offen lds
    v_and_b32 v172, s99, v172
    v_fmac_f32 v163, v171, v175
    v_fmac_f32 v167, v168, v172
    v_mfma_f32_32x32x16_bf16 v[80:95], v[200:203], a[44:47], v[80:95]
    ds_read_b64_tr_b16 v[198:199], v221 offset:37376
    v_lshlrev_b32 v179, 16, v169
    v_lshlrev_b32 v183, 16, v173
    v_and_b32 v169, s99, v169
    v_and_b32 v173, s99, v173
    s_waitcnt lgkmcnt(4)
    v_mfma_f32_32x32x16_bf16 v[96:111], v[204:207], a[40:43], v[96:111]
    ds_read_b64_tr_b16 v[200:201], v222 offset:36864
    s_waitcnt vmcnt(26)
    ds_read_b128 a[64:67], v236 offset:32768
    buffer_load_dwordx4 v242, s[36:39], s58 offen offset:1024 lds
    v_fmac_f32 v163, v179, v183
    v_mfma_f32_32x32x16_bf16 v[112:127], v[204:207], a[44:47], v[112:127]
    ds_read_b64_tr_b16 v[202:203], v222 offset:37376
    ds_read_b128 a[72:75], v237 offset:32768
    v_fmac_f32 v167, v169, v173
    v_lshlrev_b32 v171, 16, v170
    v_lshlrev_b32 v175, 16, v174
    v_and_b32 v170, s99, v170
    v_mfma_f32_32x32x16_bf16 v[128:143], v[208:211], a[40:43], v[128:143]
    ds_read_b64_tr_b16 v[204:205], v223 offset:36864
    ds_read_b128 a[80:83], v238 offset:32768
    buffer_load_dwordx4 v242, s[36:39], s59 offen offset:2048 lds
    v_and_b32 v174, s99, v174
    v_fmac_f32 v163, v171, v175
    v_mfma_f32_32x32x16_bf16 v[144:159], v[208:211], a[44:47], v[144:159]
    ds_read_b64_tr_b16 v[206:207], v223 offset:37376
    ds_read_b128 a[88:91], v239 offset:32768
    v_fmac_f32 v167, v170, v174
    v_lshlrev_b32 v179, 16, v176
    v_lshlrev_b32 v183, 16, v180
    s_waitcnt lgkmcnt(8)
    v_mfma_f32_32x32x16_bf16 v[32:47], v[192:195], a[48:51], v[32:47]
    ds_read_b64_tr_b16 v[208:209], v220 offset:38912
    s_waitcnt vmcnt(24)
    ds_read_b128 a[68:71], v236 offset:36864
    buffer_load_dwordx4 v242, s[36:39], s60 offen offset:3072 lds
    v_and_b32 v176, s99, v176
    v_mfma_f32_32x32x16_bf16 v[48:63], v[192:195], a[52:55], v[48:63]
    ds_read_b64_tr_b16 v[210:211], v220 offset:39424
    ds_read_b128 a[76:79], v237 offset:36864
    v_and_b32 v180, s99, v180
    v_fmac_f32 v163, v179, v183
    v_fmac_f32 v167, v176, v180
    v_lshlrev_b32 v171, 16, v177
    v_mfma_f32_32x32x16_bf16 v[64:79], v[196:199], a[48:51], v[64:79]
    ds_read_b64_tr_b16 v[192:193], v221 offset:38912
    ds_read_b128 a[84:87], v238 offset:36864
    v_lshlrev_b32 v175, 16, v181
    v_and_b32 v177, s99, v177
    v_and_b32 v181, s99, v181
    v_fmac_f32 v163, v171, v175
    v_mfma_f32_32x32x16_bf16 v[80:95], v[196:199], a[52:55], v[80:95]
    ds_read_b64_tr_b16 v[194:195], v221 offset:39424
    ds_read_b128 a[92:95], v239 offset:36864
    v_fmac_f32 v167, v177, v181
    v_lshlrev_b32 v179, 16, v178
    v_lshlrev_b32 v183, 16, v182
    s_waitcnt lgkmcnt(9)
    v_mfma_f32_32x32x16_bf16 v[96:111], v[200:203], a[48:51], v[96:111]
    ds_read_b64_tr_b16 v[196:197], v222 offset:38912
    s_bfm_b64 exec, s94, 0
    buffer_load_dword a253, v254, s[36:39], s100 offen
    s_mov_b64 exec, 0xff
    buffer_load_dword a252, v255, s[32:35], s98 offen offset:1024
    s_mov_b64 exec, -1
    v_mfma_f32_32x32x16_bf16 v[112:127], v[200:203], a[52:55], v[112:127]
    ds_read_b64_tr_b16 v[198:199], v222 offset:39424
    s_mov_b64 s[48:49], s[22:23]
    s_mov_b32 s50, 5308416
    s_mov_b32 m0, s80
    v_and_b32 v178, s99, v178
    v_and_b32 v182, s99, v182
    v_mfma_f32_32x32x16_bf16 v[128:143], v[204:207], a[48:51], v[128:143]
    ds_read_b64_tr_b16 v[200:201], v223 offset:38912
    s_mov_b64 exec, s[90:91]
    buffer_load_dwordx4 v246, s[48:51], 0 offen lds
    s_mov_b64 exec, -1
    v_fmac_f32 v163, v179, v183
    v_mfma_f32_32x32x16_bf16 v[144:159], v[204:207], a[52:55], v[144:159]
    ds_read_b64_tr_b16 v[202:203], v223 offset:39424
    s_waitcnt lgkmcnt(4)
    s_barrier
    v_fmac_f32 v167, v178, v182
    v_add_f32 v163, v163, v167
    v_mfma_f32_32x32x16_bf16 v[32:47], v[208:211], a[56:59], v[32:47]
    ds_read_b64_tr_b16 v[204:205], v220 offset:49152
    s_mov_b64 exec, s[90:91]
    buffer_load_dwordx4 v246, s[48:51], s61 offen offset:1024 lds
    s_mov_b64 exec, -1
    v_add_f32_dpp v163, v163, v163 row_ror:8 row_mask:0xf bank_mask:0xf
    v_mfma_f32_32x32x16_bf16 v[48:63], v[208:211], a[60:63], v[48:63]
    ds_read_b64_tr_b16 v[206:207], v220 offset:49664
    s_mov_b64 exec, s[90:91]
    buffer_load_dwordx4 v246, s[48:51], s62 offen offset:2048 lds
    s_mov_b64 exec, -1
    v_add_f32_dpp v163, v163, v163 row_ror:4 row_mask:0xf bank_mask:0xf
    v_mfma_f32_32x32x16_bf16 v[64:79], v[192:195], a[56:59], v[64:79]
    ds_read_b64_tr_b16 v[208:209], v221 offset:49152
    s_mov_b64 exec, s[90:91]
    buffer_load_dwordx4 v246, s[48:51], s63 offen offset:3072 lds
    s_mov_b64 exec, -1
    v_add_f32_dpp v163, v163, v163 row_ror:2 row_mask:0xf bank_mask:0xf
    v_mfma_f32_32x32x16_bf16 v[80:95], v[192:195], a[60:63], v[80:95]
    ds_read_b64_tr_b16 v[210:211], v221 offset:49664
    buffer_load_dwordx4 v[224:227], v224, s[36:39], s18 offen
    v_add_f32_dpp v163, v163, v163 row_ror:1 row_mask:0xf bank_mask:0xf
    v_mov_b32 v167, v163
    s_waitcnt lgkmcnt(4)
    v_mfma_f32_32x32x16_bf16 v[96:111], v[196:199], a[56:59], v[96:111]
    ds_read_b64_tr_b16 v[192:193], v222 offset:49152
    v_permlane16_swap_b32 v163, v167
    v_add_f32 v163, v163, v167
    v_cvt_pk_bf16_f32 v163, v163, v163
    v_lshlrev_b32 v163, 16, v163
    v_mul_f32 v163, s76, v163
    v_exp_f32 v163, v163
    s_nop 0
    v_add_f32 v163, 1.0, v163
    v_rcp_f32 v163, v163
    s_nop 0
    v_cvt_pk_bf16_f32 v163, v163, v163
    v_lshlrev_b32 v163, 16, v163
    v_mfma_f32_32x32x16_bf16 v[112:127], v[196:199], a[60:63], v[112:127]
    ds_read_b64_tr_b16 v[194:195], v222 offset:49664
    s_mov_b64 exec, s[20:21]
    buffer_load_dwordx4 v[228:231], v228, s[36:39], s19 offen
    s_mov_b64 exec, -1
    v_add_u32 v240, 128, v240
    v_mfma_f32_32x32x16_bf16 v[128:143], v[200:203], a[56:59], v[128:143]
    ds_read_b64_tr_b16 v[196:197], v223 offset:49152
    s_mov_b32 s83, 28901376
    s_mov_b32 exec_lo, 1
    s_mov_b32 exec_hi, 1
    buffer_store_dword v163, v251, s[40:43], s83 offen sc1
    s_mov_b64 exec, -1
    v_mfma_f32_32x32x16_bf16 v[144:159], v[200:203], a[60:63], v[144:159]
    ds_read_b64_tr_b16 v[198:199], v223 offset:49664
    v_add_u32 v241, 128, v241
    s_add_u32 m0, s57, 98304
    s_nop 0
    buffer_load_dwordx4 v240, s[32:35], 0 offen lds
    s_waitcnt lgkmcnt(4)
    v_mfma_f32_32x32x16_bf16 v[32:47], v[204:207], a[64:67], v[32:47]
    ds_read_b64_tr_b16 v[200:201], v220 offset:51200
    s_waitcnt vmcnt(22)
    ds_read_b64_tr_b16 v[160:161], v249
    ds_read_b64_tr_b16 v[162:163], v249 offset:512
    ds_read_b64_tr_b16 v[164:165], v249 offset:1024
    ds_read_b64_tr_b16 v[166:167], v249 offset:5120
    v_mfma_f32_32x32x16_bf16 v[48:63], v[204:207], a[68:71], v[48:63]
    ds_read_b64_tr_b16 v[202:203], v220 offset:51712
    buffer_load_dwordx4 v241, s[32:35], s61 offen offset:1024 lds
    ds_read_b64_tr_b16 v[168:169], v249 offset:5632
    v_lshlrev_b32 v233, 16, v184
    v_lshlrev_b32 v234, 16, v185
    v_mfma_f32_32x32x16_bf16 v[64:79], v[208:211], a[64:67], v[64:79]
    ds_read_b64_tr_b16 v[204:205], v221 offset:51200
    v_and_b32 v184, s99, v184
    v_and_b32 v185, s99, v185
    s_waitcnt lgkmcnt(1)
    v_lshlrev_b32 v180, 16, v161
    v_lshlrev_b32 v181, 16, v162
    v_mfma_f32_32x32x16_bf16 v[80:95], v[208:211], a[68:71], v[80:95]
    ds_read_b64_tr_b16 v[206:207], v221 offset:51712
    buffer_load_dwordx4 v240, s[32:35], s62 offen offset:2048 lds
    v_lshlrev_b32 v182, 16, v163
    v_lshlrev_b32 v183, 16, v164
    v_lshlrev_b32 v251, 16, v165
    v_mfma_f32_32x32x16_bf16 v[96:111], v[192:195], a[64:67], v[96:111]
    ds_read_b64_tr_b16 v[208:209], v222 offset:51200
    v_and_b32 v160, s99, v160
    v_and_b32 v161, s99, v161
    v_and_b32 v162, s99, v162
    v_and_b32 v163, s99, v163
    v_mfma_f32_32x32x16_bf16 v[112:127], v[192:195], a[68:71], v[112:127]
    ds_read_b64_tr_b16 v[210:211], v222 offset:51712
    buffer_load_dwordx4 v241, s[32:35], s63 offen offset:3072 lds
    s_add_u32 m0, s57, 102400
    v_and_b32 v164, s99, v164
    v_and_b32 v165, s99, v165
    v_mfma_f32_32x32x16_bf16 v[128:143], v[196:199], a[64:67], v[128:143]
    ds_read_b64_tr_b16 v[192:193], v223 offset:51200
    ds_read_b64_tr_b16 v[170:171], v249 offset:32
    ds_read_b64_tr_b16 v[172:173], v249 offset:544
    ds_read_b64_tr_b16 v[174:175], v249 offset:1056
    ds_read_b64_tr_b16 v[176:177], v249 offset:5152
    ds_read_b64_tr_b16 v[178:179], v249 offset:5664
    v_mfma_f32_32x32x16_bf16 v[144:159], v[196:199], a[68:71], v[144:159]
    ds_read_b64_tr_b16 v[194:195], v223 offset:51712
    buffer_load_dwordx4 v240, s[32:35], s64 offen lds
    v_mul_f32 v212, v233, v181
    v_mul_f32 v213, v233, v162
    s_waitcnt lgkmcnt(9)
    v_mfma_f32_32x32x16_bf16 v[32:47], v[200:203], a[72:75], v[32:47]
    ds_read_b64_tr_b16 v[196:197], v220 offset:53248
    v_mul_f32 v214, v233, v182
    v_mul_f32 v215, v233, v163
    v_mul_f32 v216, v233, v183
    v_mul_f32 v217, v233, v164
    v_mul_f32 v218, v233, v251
    v_mfma_f32_32x32x16_bf16 v[48:63], v[200:203], a[76:79], v[48:63]
    ds_read_b64_tr_b16 v[198:199], v220 offset:53760
    buffer_load_dwordx4 v241, s[32:35], s65 offen offset:1024 lds
    v_mul_f32 v219, v233, v165
    v_fmac_f32 v212, v184, v161
    v_fmac_f32 v213, v184, v181
    v_mfma_f32_32x32x16_bf16 v[64:79], v[204:207], a[72:75], v[64:79]
    ds_read_b64_tr_b16 v[200:201], v221 offset:53248
    v_fmac_f32 v214, v184, v162
    v_fmac_f32 v215, v184, v182
    v_fmac_f32 v216, v184, v163
    v_fmac_f32 v217, v184, v183
    v_mfma_f32_32x32x16_bf16 v[80:95], v[204:207], a[76:79], v[80:95]
    ds_read_b64_tr_b16 v[202:203], v221 offset:53760
    buffer_load_dwordx4 v240, s[32:35], s66 offen offset:2048 lds
    v_fmac_f32 v218, v184, v164
    v_fmac_f32 v219, v184, v251
    s_waitcnt lgkmcnt(4)
    v_mfma_f32_32x32x16_bf16 v[96:111], v[208:211], a[72:75], v[96:111]
    ds_read_b64_tr_b16 v[204:205], v222 offset:53248
    s_waitcnt vmcnt(24)
    ds_read_b128 a[96:99], v236
    v_fmac_f32 v212, v234, v180
    v_fmac_f32 v213, v234, v161
    v_fmac_f32 v214, v234, v181
    v_mfma_f32_32x32x16_bf16 v[112:127], v[208:211], a[76:79], v[112:127]
    ds_read_b64_tr_b16 v[206:207], v222 offset:53760
    ds_read_b128 a[104:107], v237
    buffer_load_dwordx4 v241, s[32:35], s67 offen offset:3072 lds
    v_add_u32 v242, 589824, v242
    s_add_u32 m0, s55, 16384
    v_mfma_f32_32x32x16_bf16 v[128:143], v[192:195], a[72:75], v[128:143]
    ds_read_b64_tr_b16 v[208:209], v223 offset:53248
    ds_read_b128 a[112:115], v238
    v_fmac_f32 v215, v234, v162
    v_fmac_f32 v216, v234, v182
    v_fmac_f32 v217, v234, v163
    v_fmac_f32 v218, v234, v183
    v_mfma_f32_32x32x16_bf16 v[144:159], v[192:195], a[76:79], v[144:159]
    ds_read_b64_tr_b16 v[210:211], v223 offset:53760
    ds_read_b128 a[120:123], v239
    buffer_load_dwordx4 v242, s[36:39], 0 offen lds
    v_fmac_f32 v219, v234, v164
    s_waitcnt lgkmcnt(8)
    v_mfma_f32_32x32x16_bf16 v[32:47], v[196:199], a[80:83], v[32:47]
    ds_read_b64_tr_b16 v[192:193], v220 offset:55296
    s_waitcnt vmcnt(22)
    ds_read_b128 a[100:103], v236 offset:4096
    v_fmac_f32 v212, v185, v160
    v_fmac_f32 v213, v185, v180
    v_fmac_f32 v214, v185, v161
    v_mfma_f32_32x32x16_bf16 v[48:63], v[196:199], a[84:87], v[48:63]
    ds_read_b64_tr_b16 v[194:195], v220 offset:55808
    ds_read_b128 a[108:111], v237 offset:4096
    buffer_load_dwordx4 v242, s[36:39], s58 offen offset:1024 lds
    v_fmac_f32 v215, v185, v181
    v_fmac_f32 v216, v185, v162
    v_mfma_f32_32x32x16_bf16 v[64:79], v[200:203], a[80:83], v[64:79]
    ds_read_b64_tr_b16 v[196:197], v221 offset:55296
    ds_read_b128 a[116:119], v238 offset:4096
    v_fmac_f32 v217, v185, v182
    v_fmac_f32 v218, v185, v163
    v_fmac_f32 v219, v185, v183
    v_lshlrev_b32 v160, 16, v166
    v_mfma_f32_32x32x16_bf16 v[80:95], v[200:203], a[84:87], v[80:95]
    ds_read_b64_tr_b16 v[198:199], v221 offset:55808
    ds_read_b128 a[124:127], v239 offset:4096
    buffer_load_dwordx4 v242, s[36:39], s59 offen offset:2048 lds
    v_and_b32 v161, s99, v166
    s_waitcnt lgkmcnt(9)
    v_mfma_f32_32x32x16_bf16 v[96:111], v[204:207], a[80:83], v[96:111]
    ds_read_b64_tr_b16 v[200:201], v222 offset:55296
    v_lshlrev_b32 v162, 16, v167
    v_and_b32 v163, s99, v167
    v_mul_f32 v212, v212, v160
    v_mul_f32 v213, v213, v161
    v_mul_f32 v214, v214, v162
    v_mfma_f32_32x32x16_bf16 v[112:127], v[204:207], a[84:87], v[112:127]
    ds_read_b64_tr_b16 v[202:203], v222 offset:55808
    buffer_load_dwordx4 v242, s[36:39], s60 offen offset:3072 lds
    s_mov_b64 s[44:45], s[28:29]
    s_mov_b32 s46, 256
    v_mul_f32 v215, v215, v163
    v_mfma_f32_32x32x16_bf16 v[128:143], v[208:211], a[80:83], v[128:143]
    ds_read_b64_tr_b16 v[204:205], v223 offset:55296
    v_lshlrev_b32 v160, 16, v168
    v_and_b32 v161, s99, v168
    v_lshlrev_b32 v162, 16, v169
    v_and_b32 v163, s99, v169
    v_mul_f32 v216, v216, v160
    v_mfma_f32_32x32x16_bf16 v[144:159], v[208:211], a[84:87], v[144:159]
    ds_read_b64_tr_b16 v[206:207], v223 offset:55808
    s_waitcnt vmcnt(21) lgkmcnt(4)
    s_barrier
    buffer_load_dword a254, off, s[44:47], 0
    v_mfma_f32_32x32x16_bf16 v[32:47], v[192:195], a[88:91], v[32:47]
    ds_read_b64_tr_b16 v[208:209], v220
    s_cmp_eq_u32 s54, 2
    s_mov_b32 s82, 128
    s_cselect_b32 s82, 0xfffffc80, s82
    v_add_u32 v240, s82, v240
    v_add_u32 v241, s82, v241
    v_mfma_f32_32x32x16_bf16 v[48:63], v[192:195], a[92:95], v[48:63]
    ds_read_b64_tr_b16 v[210:211], v220 offset:512
    s_add_u32 m0, s57, 65536
    s_nop 0
    buffer_load_dwordx4 v240, s[32:35], 0 offen lds
    v_mul_f32 v217, v217, v161
    v_mul_f32 v218, v218, v162
    v_mfma_f32_32x32x16_bf16 v[64:79], v[196:199], a[88:91], v[64:79]
    ds_read_b64_tr_b16 v[192:193], v221
    v_mul_f32 v219, v219, v163
    v_cvt_pk_bf16_f32 v252, v219, v218
    v_cvt_pk_bf16_f32 v253, v217, v216
    v_cvt_pk_bf16_f32 v254, v215, v214
    v_cvt_pk_bf16_f32 v255, v213, v212
    v_mfma_f32_32x32x16_bf16 v[80:95], v[196:199], a[92:95], v[80:95]
    ds_read_b64_tr_b16 v[194:195], v221 offset:512
    buffer_load_dwordx4 v241, s[32:35], s61 offen offset:1024 lds
    s_waitcnt lgkmcnt(4)
    v_mfma_f32_32x32x16_bf16 v[96:111], v[200:203], a[88:91], v[96:111]
    ds_read_b64_tr_b16 v[196:197], v222
    s_mov_b32 s86, 0
    s_mov_b64 exec, s[78:79]
    buffer_store_dwordx4 v[252:255], v250, s[40:43], s86 offen sc1
    s_mov_b64 exec, -1
    v_mfma_f32_32x32x16_bf16 v[112:127], v[200:203], a[92:95], v[112:127]
    ds_read_b64_tr_b16 v[198:199], v222 offset:512
    v_lshlrev_b32 v233, 16, v186
    v_lshlrev_b32 v234, 16, v187
    v_and_b32 v186, s99, v186
    v_and_b32 v187, s99, v187
    v_lshlrev_b32 v180, 16, v171
    v_mfma_f32_32x32x16_bf16 v[128:143], v[204:207], a[88:91], v[128:143]
    ds_read_b64_tr_b16 v[200:201], v223
    buffer_load_dwordx4 v240, s[32:35], s62 offen offset:2048 lds
    v_lshlrev_b32 v181, 16, v172
    v_lshlrev_b32 v182, 16, v173
    v_lshlrev_b32 v183, 16, v174
    v_mfma_f32_32x32x16_bf16 v[144:159], v[204:207], a[92:95], v[144:159]
    ds_read_b64_tr_b16 v[202:203], v223 offset:512
    v_lshlrev_b32 v251, 16, v175
    v_and_b32 v170, s99, v170
    v_and_b32 v171, s99, v171
    v_and_b32 v172, s99, v172
    s_waitcnt lgkmcnt(4)
    v_mfma_f32_32x32x16_bf16 v[32:47], v[208:211], a[96:99], v[32:47]
    ds_read_b64_tr_b16 v[204:205], v220 offset:2048
    buffer_load_dwordx4 v241, s[32:35], s63 offen offset:3072 lds
    s_add_u32 m0, s57, 69632
    v_and_b32 v173, s99, v173
    v_and_b32 v174, s99, v174
    v_mfma_f32_32x32x16_bf16 v[48:63], v[208:211], a[100:103], v[48:63]
    ds_read_b64_tr_b16 v[206:207], v220 offset:2560
    v_and_b32 v175, s99, v175
    ds_read_b64_tr_b16 v[160:161], v249 offset:64
    ds_read_b64_tr_b16 v[162:163], v249 offset:576
    ds_read_b64_tr_b16 v[164:165], v249 offset:1088
    ds_read_b64_tr_b16 v[166:167], v249 offset:5184
    v_mfma_f32_32x32x16_bf16 v[64:79], v[192:195], a[96:99], v[64:79]
    ds_read_b64_tr_b16 v[208:209], v221 offset:2048
    buffer_load_dwordx4 v240, s[32:35], s64 offen lds
    ds_read_b64_tr_b16 v[168:169], v249 offset:5696
    v_mul_f32 v212, v233, v181
    v_mul_f32 v213, v233, v172
    v_mfma_f32_32x32x16_bf16 v[80:95], v[192:195], a[100:103], v[80:95]
    ds_read_b64_tr_b16 v[210:211], v221 offset:2560
    v_mul_f32 v214, v233, v182
    v_mul_f32 v215, v233, v173
    v_mul_f32 v216, v233, v183
    v_mul_f32 v217, v233, v174
    s_waitcnt lgkmcnt(9)
    v_mfma_f32_32x32x16_bf16 v[96:111], v[196:199], a[96:99], v[96:111]
    ds_read_b64_tr_b16 v[192:193], v222 offset:2048
    buffer_load_dwordx4 v241, s[32:35], s65 offen offset:1024 lds
    v_mul_f32 v218, v233, v251
    v_mul_f32 v219, v233, v175
    v_fmac_f32 v212, v186, v171
    v_mfma_f32_32x32x16_bf16 v[112:127], v[196:199], a[100:103], v[112:127]
    ds_read_b64_tr_b16 v[194:195], v222 offset:2560
    v_fmac_f32 v213, v186, v181
    v_fmac_f32 v214, v186, v172
    v_fmac_f32 v215, v186, v182
    v_fmac_f32 v216, v186, v173
    v_fmac_f32 v217, v186, v183
    v_mfma_f32_32x32x16_bf16 v[128:143], v[200:203], a[96:99], v[128:143]
    ds_read_b64_tr_b16 v[196:197], v223 offset:2048
    buffer_load_dwordx4 v240, s[32:35], s66 offen offset:2048 lds
    v_fmac_f32 v218, v186, v174
    v_fmac_f32 v219, v186, v251
    v_fmac_f32 v212, v234, v180
    v_mfma_f32_32x32x16_bf16 v[144:159], v[200:203], a[100:103], v[144:159]
    ds_read_b64_tr_b16 v[198:199], v223 offset:2560
    v_fmac_f32 v213, v234, v171
    v_fmac_f32 v214, v234, v181
    v_fmac_f32 v215, v234, v172
    v_fmac_f32 v216, v234, v182
    s_waitcnt lgkmcnt(4)
    v_mfma_f32_32x32x16_bf16 v[32:47], v[204:207], a[104:107], v[32:47]
    ds_read_b64_tr_b16 v[200:201], v220 offset:4096
    buffer_load_dwordx4 v241, s[32:35], s67 offen offset:3072 lds
    s_cmp_eq_u32 s54, 2
    s_mov_b32 s82, 589824
    s_cselect_b32 s82, 0xffc10000, s82
    v_mfma_f32_32x32x16_bf16 v[48:63], v[204:207], a[108:111], v[48:63]
    ds_read_b64_tr_b16 v[202:203], v220 offset:4608
    v_add_u32 v242, s82, v242
    s_add_u32 m0, s55, 32768
    v_fmac_f32 v217, v234, v173
    v_fmac_f32 v218, v234, v183
    v_fmac_f32 v219, v234, v174
    v_mfma_f32_32x32x16_bf16 v[64:79], v[208:211], a[104:107], v[64:79]
    ds_read_b64_tr_b16 v[204:205], v221 offset:4096
    buffer_load_dwordx4 v242, s[36:39], 0 offen lds
    v_fmac_f32 v212, v187, v170
    v_fmac_f32 v213, v187, v180
    v_fmac_f32 v214, v187, v171
    v_mfma_f32_32x32x16_bf16 v[80:95], v[208:211], a[108:111], v[80:95]
    ds_read_b64_tr_b16 v[206:207], v221 offset:4608
    v_fmac_f32 v215, v187, v181
    v_fmac_f32 v216, v187, v172
    v_fmac_f32 v217, v187, v182
    v_fmac_f32 v218, v187, v173
    s_waitcnt lgkmcnt(4)
    v_mfma_f32_32x32x16_bf16 v[96:111], v[192:195], a[104:107], v[96:111]
    ds_read_b64_tr_b16 v[208:209], v222 offset:4096
    s_waitcnt vmcnt(19)
    ds_read_b128 a[128:131], v236 offset:32768
    buffer_load_dwordx4 v242, s[36:39], s58 offen offset:1024 lds
    v_fmac_f32 v219, v187, v183
    v_mfma_f32_32x32x16_bf16 v[112:127], v[192:195], a[108:111], v[112:127]
    ds_read_b64_tr_b16 v[210:211], v222 offset:4608
    ds_read_b128 a[136:139], v237 offset:32768
    v_lshlrev_b32 v170, 16, v176
    v_and_b32 v171, s99, v176
    v_lshlrev_b32 v172, 16, v177
    v_and_b32 v173, s99, v177
    v_mfma_f32_32x32x16_bf16 v[128:143], v[196:199], a[104:107], v[128:143]
    ds_read_b64_tr_b16 v[192:193], v223 offset:4096
    ds_read_b128 a[144:147], v238 offset:32768
    buffer_load_dwordx4 v242, s[36:39], s59 offen offset:2048 lds
    v_mul_f32 v212, v212, v170
    v_mul_f32 v213, v213, v171
    v_mfma_f32_32x32x16_bf16 v[144:159], v[196:199], a[108:111], v[144:159]
    ds_read_b64_tr_b16 v[194:195], v223 offset:4608
    ds_read_b128 a[152:155], v239 offset:32768
    v_mul_f32 v214, v214, v172
    v_mul_f32 v215, v215, v173
    v_lshlrev_b32 v170, 16, v178
    s_waitcnt lgkmcnt(8)
    v_mfma_f32_32x32x16_bf16 v[32:47], v[200:203], a[112:115], v[32:47]
    ds_read_b64_tr_b16 v[196:197], v220 offset:6144
    s_waitcnt vmcnt(17)
    ds_read_b128 a[132:135], v236 offset:36864
    buffer_load_dwordx4 v242, s[36:39], s60 offen offset:3072 lds
    v_and_b32 v171, s99, v178
    v_mfma_f32_32x32x16_bf16 v[48:63], v[200:203], a[116:119], v[48:63]
    ds_read_b64_tr_b16 v[198:199], v220 offset:6656
    ds_read_b128 a[140:143], v237 offset:36864
    v_lshlrev_b32 v172, 16, v179
    v_and_b32 v173, s99, v179
    v_mul_f32 v216, v216, v170
    v_mul_f32 v217, v217, v171
    v_mfma_f32_32x32x16_bf16 v[64:79], v[204:207], a[112:115], v[64:79]
    ds_read_b64_tr_b16 v[200:201], v221 offset:6144
    ds_read_b128 a[148:151], v238 offset:36864
    v_mul_f32 v218, v218, v172
    v_mul_f32 v219, v219, v173
    v_cvt_pk_bf16_f32 v252, v219, v218
    v_cvt_pk_bf16_f32 v253, v217, v216
    v_mfma_f32_32x32x16_bf16 v[80:95], v[204:207], a[116:119], v[80:95]
    ds_read_b64_tr_b16 v[202:203], v221 offset:6656
    ds_read_b128 a[156:159], v239 offset:36864
    v_cvt_pk_bf16_f32 v254, v215, v214
    v_cvt_pk_bf16_f32 v255, v213, v212
    s_waitcnt lgkmcnt(9)
    v_mfma_f32_32x32x16_bf16 v[96:111], v[208:211], a[112:115], v[96:111]
    ds_read_b64_tr_b16 v[204:205], v222 offset:6144
    s_mov_b32 s86, 65536
    s_mov_b64 exec, s[78:79]
    buffer_store_dwordx4 v[252:255], v250, s[40:43], s86 offen sc1
    s_mov_b64 exec, -1
    v_mfma_f32_32x32x16_bf16 v[112:127], v[208:211], a[116:119], v[112:127]
    ds_read_b64_tr_b16 v[206:207], v222 offset:6656
    buffer_store_dwordx4 v[224:227], v243, s[40:43], s30 offen sc1
    v_mfma_f32_32x32x16_bf16 v[128:143], v[192:195], a[112:115], v[128:143]
    ds_read_b64_tr_b16 v[208:209], v223 offset:6144
    v_lshlrev_b32 v233, 16, v188
    v_lshlrev_b32 v234, 16, v189
    v_and_b32 v188, s99, v188
    v_and_b32 v189, s99, v189
    v_lshlrev_b32 v180, 16, v161
    v_mfma_f32_32x32x16_bf16 v[144:159], v[192:195], a[116:119], v[144:159]
    ds_read_b64_tr_b16 v[210:211], v223 offset:6656
    s_waitcnt vmcnt(16) lgkmcnt(4)
    s_barrier
    v_lshlrev_b32 v181, 16, v162
    v_lshlrev_b32 v182, 16, v163
    v_mfma_f32_32x32x16_bf16 v[32:47], v[196:199], a[120:123], v[32:47]
    ds_read_b64_tr_b16 v[192:193], v220 offset:16384
    s_mov_b64 exec, s[20:21]
    buffer_store_dwordx4 v[228:231], v243, s[40:43], s31 offen sc1
    s_mov_b64 exec, -1
    v_mfma_f32_32x32x16_bf16 v[48:63], v[196:199], a[124:127], v[48:63]
    ds_read_b64_tr_b16 v[194:195], v220 offset:16896
    v_add_u32 v240, 128, v240
    v_add_u32 v241, 128, v241
    s_add_u32 m0, s57, 98304
    s_nop 0
    buffer_load_dwordx4 v240, s[32:35], 0 offen lds
    v_mfma_f32_32x32x16_bf16 v[64:79], v[200:203], a[120:123], v[64:79]
    ds_read_b64_tr_b16 v[196:197], v221 offset:16384
    v_lshlrev_b32 v183, 16, v164
    v_lshlrev_b32 v251, 16, v165
    v_and_b32 v160, s99, v160
    v_and_b32 v161, s99, v161
    v_and_b32 v162, s99, v162
KF_PG2:
    s_cbranch_execz KF_WMID
    v_mfma_f32_32x32x16_bf16 v[80:95], v[200:203], a[124:127], v[80:95]
    ds_read_b64_tr_b16 v[198:199], v221 offset:16896
    buffer_load_dwordx4 v241, s[32:35], s61 offen offset:1024 lds
    v_and_b32 v163, s99, v163
    v_and_b32 v164, s99, v164
    s_waitcnt lgkmcnt(4)
    v_mfma_f32_32x32x16_bf16 v[96:111], v[204:207], a[120:123], v[96:111]
    ds_read_b64_tr_b16 v[200:201], v222 offset:16384
    v_and_b32 v165, s99, v165
    ds_read_b64_tr_b16 v[170:171], v249 offset:96
    ds_read_b64_tr_b16 v[172:173], v249 offset:608
    ds_read_b64_tr_b16 v[174:175], v249 offset:1120
    ds_read_b64_tr_b16 v[176:177], v249 offset:5216
    v_mfma_f32_32x32x16_bf16 v[112:127], v[204:207], a[124:127], v[112:127]
    ds_read_b64_tr_b16 v[202:203], v222 offset:16896
    buffer_load_dwordx4 v240, s[32:35], s62 offen offset:2048 lds
    ds_read_b64_tr_b16 v[178:179], v249 offset:5728
    v_mul_f32 v212, v233, v181
    v_mul_f32 v213, v233, v162
    v_mfma_f32_32x32x16_bf16 v[128:143], v[208:211], a[120:123], v[128:143]
    ds_read_b64_tr_b16 v[204:205], v223 offset:16384
    v_mul_f32 v214, v233, v182
    v_mul_f32 v215, v233, v163
    v_mul_f32 v216, v233, v183
    v_mul_f32 v217, v233, v164
    v_mul_f32 v218, v233, v251
    v_mfma_f32_32x32x16_bf16 v[144:159], v[208:211], a[124:127], v[144:159]
    ds_read_b64_tr_b16 v[206:207], v223 offset:16896
    buffer_load_dwordx4 v241, s[32:35], s63 offen offset:3072 lds
    s_add_u32 m0, s57, 102400
    v_mul_f32 v219, v233, v165
    s_waitcnt lgkmcnt(9)
    v_mfma_f32_32x32x16_bf16 v[32:47], v[192:195], a[128:131], v[32:47]
    ds_read_b64_tr_b16 v[208:209], v220 offset:18432
    v_fmac_f32 v212, v188, v161
    v_fmac_f32 v213, v188, v181
    v_fmac_f32 v214, v188, v162
    v_fmac_f32 v215, v188, v182
    v_fmac_f32 v216, v188, v163
    v_mfma_f32_32x32x16_bf16 v[48:63], v[192:195], a[132:135], v[48:63]
    ds_read_b64_tr_b16 v[210:211], v220 offset:18944
    buffer_load_dwordx4 v240, s[32:35], s64 offen lds
    v_fmac_f32 v217, v188, v183
    v_fmac_f32 v218, v188, v164
    v_fmac_f32 v219, v188, v251
    v_mfma_f32_32x32x16_bf16 v[64:79], v[196:199], a[128:131], v[64:79]
    ds_read_b64_tr_b16 v[192:193], v221 offset:18432
    v_fmac_f32 v212, v234, v180
    v_fmac_f32 v213, v234, v161
    v_fmac_f32 v214, v234, v181
    v_fmac_f32 v215, v234, v162
    v_fmac_f32 v216, v234, v182
    v_mfma_f32_32x32x16_bf16 v[80:95], v[196:199], a[132:135], v[80:95]
    ds_read_b64_tr_b16 v[194:195], v221 offset:18944
    buffer_load_dwordx4 v241, s[32:35], s65 offen offset:1024 lds
    v_fmac_f32 v217, v234, v163
    v_fmac_f32 v218, v234, v183
    s_waitcnt lgkmcnt(4)
    v_mfma_f32_32x32x16_bf16 v[96:111], v[200:203], a[128:131], v[96:111]
    ds_read_b64_tr_b16 v[196:197], v222 offset:18432
    v_fmac_f32 v219, v234, v164
    v_fmac_f32 v212, v189, v160
    v_fmac_f32 v213, v189, v180
    v_fmac_f32 v214, v189, v161
    v_fmac_f32 v215, v189, v181
    v_mfma_f32_32x32x16_bf16 v[112:127], v[200:203], a[132:135], v[112:127]
    ds_read_b64_tr_b16 v[198:199], v222 offset:18944
    buffer_load_dwordx4 v240, s[32:35], s66 offen offset:2048 lds
    v_fmac_f32 v216, v189, v162
    v_fmac_f32 v217, v189, v182
    v_fmac_f32 v218, v189, v163
    v_mfma_f32_32x32x16_bf16 v[128:143], v[204:207], a[128:131], v[128:143]
    ds_read_b64_tr_b16 v[200:201], v223 offset:18432
    v_fmac_f32 v219, v189, v183
    v_lshlrev_b32 v160, 16, v166
    v_and_b32 v161, s99, v166
    v_lshlrev_b32 v162, 16, v167
    v_and_b32 v163, s99, v167
    v_mfma_f32_32x32x16_bf16 v[144:159], v[204:207], a[132:135], v[144:159]
    ds_read_b64_tr_b16 v[202:203], v223 offset:18944
    buffer_load_dwordx4 v241, s[32:35], s67 offen offset:3072 lds
    v_add_u32 v242, 589824, v242
    s_add_u32 m0, s55, 49152
    s_waitcnt lgkmcnt(4)
    v_mfma_f32_32x32x16_bf16 v[32:47], v[208:211], a[136:139], v[32:47]
    ds_read_b64_tr_b16 v[204:205], v220 offset:20480
    v_mul_f32 v212, v212, v160
    v_mul_f32 v213, v213, v161
    v_mul_f32 v214, v214, v162
    v_mul_f32 v215, v215, v163
    v_lshlrev_b32 v160, 16, v168
    v_mfma_f32_32x32x16_bf16 v[48:63], v[208:211], a[140:143], v[48:63]
    ds_read_b64_tr_b16 v[206:207], v220 offset:20992
    buffer_load_dwordx4 v242, s[36:39], 0 offen lds
    v_and_b32 v161, s99, v168
    v_lshlrev_b32 v162, 16, v169
    v_and_b32 v163, s99, v169
    v_mfma_f32_32x32x16_bf16 v[64:79], v[192:195], a[136:139], v[64:79]
    ds_read_b64_tr_b16 v[208:209], v221 offset:20480
    v_mul_f32 v216, v216, v160
    v_mul_f32 v217, v217, v161
    v_mul_f32 v218, v218, v162
    v_mul_f32 v219, v219, v163
    v_cvt_pk_bf16_f32 v252, v219, v218
    v_mfma_f32_32x32x16_bf16 v[80:95], v[192:195], a[140:143], v[80:95]
    ds_read_b64_tr_b16 v[210:211], v221 offset:20992
    buffer_load_dwordx4 v242, s[36:39], s58 offen offset:1024 lds
    v_cvt_pk_bf16_f32 v253, v217, v216
    v_cvt_pk_bf16_f32 v254, v215, v214
    s_waitcnt lgkmcnt(4)
    v_mfma_f32_32x32x16_bf16 v[96:111], v[196:199], a[136:139], v[96:111]
    ds_read_b64_tr_b16 v[192:193], v222 offset:20480
    s_waitcnt vmcnt(21)
    ds_read_b128 a[160:163], v236
    v_cvt_pk_bf16_f32 v255, v213, v212
    s_mov_b32 s86, 131072
    s_mov_b64 exec, s[78:79]
    buffer_store_dwordx4 v[252:255], v250, s[40:43], s86 offen sc1
    s_mov_b64 exec, -1
    v_mfma_f32_32x32x16_bf16 v[112:127], v[196:199], a[140:143], v[112:127]
    ds_read_b64_tr_b16 v[194:195], v222 offset:20992
    ds_read_b128 a[168:171], v237
    ds_read_b64_tr_b16 v[224:225], v245
    ds_read_b64_tr_b16 v[226:227], v245 offset:1024
    buffer_load_dwordx4 v242, s[36:39], s59 offen offset:2048 lds
    v_mfma_f32_32x32x16_bf16 v[128:143], v[200:203], a[136:139], v[128:143]
    ds_read_b64_tr_b16 v[196:197], v223 offset:20480
    ds_read_b128 a[176:179], v238
    ds_read_b64_tr_b16 v[228:229], v245 offset:32
    ds_read_b64_tr_b16 v[230:231], v245 offset:1056
    v_lshlrev_b32 v233, 16, v190
    v_lshlrev_b32 v234, 16, v191
    v_mfma_f32_32x32x16_bf16 v[144:159], v[200:203], a[140:143], v[144:159]
    ds_read_b64_tr_b16 v[198:199], v223 offset:20992
    ds_read_b128 a[184:187], v239
    v_and_b32 v190, s99, v190
    v_and_b32 v191, s99, v191
    v_lshlrev_b32 v180, 16, v171
    s_waitcnt lgkmcnt(12)
    v_mfma_f32_32x32x16_bf16 v[32:47], v[204:207], a[144:147], v[32:47]
    ds_read_b64_tr_b16 v[200:201], v220 offset:22528
    s_waitcnt vmcnt(19)
    ds_read_b128 a[164:167], v236 offset:4096
    buffer_load_dwordx4 v242, s[36:39], s60 offen offset:3072 lds
    v_accvgpr_write_b32 a248, -1
    v_mfma_f32_32x32x16_bf16 v[48:63], v[204:207], a[148:151], v[48:63]
    ds_read_b64_tr_b16 v[202:203], v220 offset:23040
    ds_read_b128 a[172:175], v237 offset:4096
    v_accvgpr_write_b32 a249, -1
    v_accvgpr_write_b32 a250, -1
    v_accvgpr_write_b32 a251, -1
    v_lshlrev_b32 v181, 16, v172
    v_mfma_f32_32x32x16_bf16 v[64:79], v[208:211], a[144:147], v[64:79]
    ds_read_b64_tr_b16 v[204:205], v221 offset:22528
    ds_read_b128 a[180:183], v238 offset:4096
    s_mov_b64 exec, s[90:91]
    s_waitcnt lgkmcnt(12)
    buffer_store_dwordx4 v[224:227], v244, s[40:43], s89 offen sc1
    s_mov_b64 exec, -1
    v_mfma_f32_32x32x16_bf16 v[80:95], v[208:211], a[148:151], v[80:95]
    ds_read_b64_tr_b16 v[206:207], v221 offset:23040
    ds_read_b128 a[188:191], v239 offset:4096
    ds_read_b64_tr_b16 v[224:225], v245 offset:64
    ds_read_b64_tr_b16 v[226:227], v245 offset:1088
    v_lshlrev_b32 v182, 16, v173
    s_waitcnt lgkmcnt(11)
    v_mfma_f32_32x32x16_bf16 v[96:111], v[192:195], a[144:147], v[96:111]
    ds_read_b64_tr_b16 v[208:209], v222 offset:22528
    s_lshl_b32 s82, s2, 2
    s_add_u32 s82, s82, s52
    s_lshl_b32 s82, s82, 10
    s_add_u32 s82, s82, 28639232
    s_cmp_lt_u32 s2, 64
    s_cselect_b64 exec, -1, 0
    buffer_store_dwordx4 a[248:251], v244, s[40:43], s82 offen sc1
    s_mov_b64 exec, -1
    v_mfma_f32_32x32x16_bf16 v[112:127], v[192:195], a[148:151], v[112:127]
    ds_read_b64_tr_b16 v[210:211], v222 offset:23040
    s_mov_b64 exec, s[90:91]
    buffer_store_dwordx4 v[228:231], v244, s[40:43], s89 offen offset:1024 sc1
    s_mov_b64 exec, -1
    s_nop 0
    ds_read_b64_tr_b16 v[228:229], v245 offset:96
    ds_read_b64_tr_b16 v[230:231], v245 offset:1120
    s_mov_b64 exec, s[90:91]
    s_waitcnt lgkmcnt(4)
    buffer_store_dwordx4 v[224:227], v244, s[40:43], s89 offen offset:2048 sc1
    s_mov_b64 exec, -1
    s_mov_b64 exec, s[90:91]
    s_waitcnt lgkmcnt(0)
    buffer_store_dwordx4 v[228:231], v244, s[40:43], s89 offen offset:3072 sc1
    s_mov_b64 exec, -1
    v_mfma_f32_32x32x16_bf16 v[128:143], v[196:199], a[144:147], v[128:143]
    ds_read_b64_tr_b16 v[192:193], v223 offset:22528
    s_sub_u32 s82, 8, s54
    s_and_b32 s82, s82, 7
    s_add_u32 s82, s82, 1
    s_mul_i32 s82, s82, 128
    v_add_u32 v240, s82, v240
    v_mfma_f32_32x32x16_bf16 v[144:159], v[196:199], a[148:151], v[144:159]
    ds_read_b64_tr_b16 v[194:195], v223 offset:23040
    s_waitcnt vmcnt(21)
    s_barrier
    v_add_u32 v241, s82, v241
    s_add_u32 m0, s57, 65536
    v_lshlrev_b32 v183, 16, v174
    v_mfma_f32_32x32x16_bf16 v[32:47], v[200:203], a[152:155], v[32:47]
    ds_read_b64_tr_b16 v[196:197], v220 offset:32768
    buffer_load_dwordx4 v240, s[32:35], 0 offen lds
    v_lshlrev_b32 v251, 16, v175
    v_and_b32 v170, s99, v170
    v_and_b32 v171, s99, v171
    v_mfma_f32_32x32x16_bf16 v[48:63], v[200:203], a[156:159], v[48:63]
    ds_read_b64_tr_b16 v[198:199], v220 offset:33280
    v_and_b32 v172, s99, v172
    v_and_b32 v173, s99, v173
    v_and_b32 v174, s99, v174
    v_and_b32 v175, s99, v175
    v_mul_f32 v212, v233, v181
    v_mfma_f32_32x32x16_bf16 v[64:79], v[204:207], a[152:155], v[64:79]
    ds_read_b64_tr_b16 v[200:201], v221 offset:32768
    buffer_load_dwordx4 v241, s[32:35], s61 offen offset:1024 lds
    v_mul_f32 v213, v233, v172
    v_mul_f32 v214, v233, v182
    v_mul_f32 v215, v233, v173
    v_mfma_f32_32x32x16_bf16 v[80:95], v[204:207], a[156:159], v[80:95]
    ds_read_b64_tr_b16 v[202:203], v221 offset:33280
    v_mul_f32 v216, v233, v183
    v_mul_f32 v217, v233, v174
    v_mul_f32 v218, v233, v251
    v_mul_f32 v219, v233, v175
    s_waitcnt lgkmcnt(4)
    v_mfma_f32_32x32x16_bf16 v[96:111], v[208:211], a[152:155], v[96:111]
    ds_read_b64_tr_b16 v[204:205], v222 offset:32768
    buffer_load_dwordx4 v240, s[32:35], s62 offen offset:2048 lds
    v_fmac_f32 v212, v190, v171
    v_fmac_f32 v213, v190, v181
    v_fmac_f32 v214, v190, v172
    v_mfma_f32_32x32x16_bf16 v[112:127], v[208:211], a[156:159], v[112:127]
    ds_read_b64_tr_b16 v[206:207], v222 offset:33280
    v_fmac_f32 v215, v190, v182
    v_fmac_f32 v216, v190, v173
    v_fmac_f32 v217, v190, v183
    v_fmac_f32 v218, v190, v174
    v_fmac_f32 v219, v190, v251
    v_mfma_f32_32x32x16_bf16 v[128:143], v[192:195], a[152:155], v[128:143]
    ds_read_b64_tr_b16 v[208:209], v223 offset:32768
    buffer_load_dwordx4 v241, s[32:35], s63 offen offset:3072 lds
    s_add_u32 m0, s57, 69632
    v_fmac_f32 v212, v234, v180
    v_fmac_f32 v213, v234, v171
    v_mfma_f32_32x32x16_bf16 v[144:159], v[192:195], a[156:159], v[144:159]
    ds_read_b64_tr_b16 v[210:211], v223 offset:33280
    v_fmac_f32 v214, v234, v181
    v_fmac_f32 v215, v234, v172
    v_fmac_f32 v216, v234, v182
    v_fmac_f32 v217, v234, v173
    s_waitcnt lgkmcnt(4)
    v_mfma_f32_32x32x16_bf16 v[32:47], v[196:199], a[160:163], v[32:47]
    ds_read_b64_tr_b16 v[192:193], v220 offset:34816
    buffer_load_dwordx4 v240, s[32:35], s64 offen lds
    v_fmac_f32 v218, v234, v183
    v_fmac_f32 v219, v234, v174
    v_fmac_f32 v212, v191, v170
    v_mfma_f32_32x32x16_bf16 v[48:63], v[196:199], a[164:167], v[48:63]
    ds_read_b64_tr_b16 v[194:195], v220 offset:35328
    v_fmac_f32 v213, v191, v180
    v_fmac_f32 v214, v191, v171
    v_fmac_f32 v215, v191, v181
    v_fmac_f32 v216, v191, v172
    v_fmac_f32 v217, v191, v182
    v_mfma_f32_32x32x16_bf16 v[64:79], v[200:203], a[160:163], v[64:79]
    ds_read_b64_tr_b16 v[196:197], v221 offset:34816
    buffer_load_dwordx4 v241, s[32:35], s65 offen offset:1024 lds
    v_fmac_f32 v218, v191, v173
    v_fmac_f32 v219, v191, v183
    v_lshlrev_b32 v170, 16, v176
    v_mfma_f32_32x32x16_bf16 v[80:95], v[200:203], a[164:167], v[80:95]
    ds_read_b64_tr_b16 v[198:199], v221 offset:35328
    v_and_b32 v171, s99, v176
    v_lshlrev_b32 v172, 16, v177
    v_and_b32 v173, s99, v177
    v_mul_f32 v212, v212, v170
    s_waitcnt lgkmcnt(4)
    v_mfma_f32_32x32x16_bf16 v[96:111], v[204:207], a[160:163], v[96:111]
    ds_read_b64_tr_b16 v[200:201], v222 offset:34816
    v_mul_f32 v213, v213, v171
    v_mul_f32 v214, v214, v172
    v_mul_f32 v215, v215, v173
    v_lshlrev_b32 v170, 16, v178
    v_and_b32 v171, s99, v178
    v_lshlrev_b32 v172, 16, v179
    v_and_b32 v173, s99, v179
    v_mul_f32 v216, v216, v170
    v_mul_f32 v217, v217, v171
    v_mul_f32 v218, v218, v172
    v_mul_f32 v219, v219, v173
    v_cvt_pk_bf16_f32 v252, v219, v218
    v_cvt_pk_bf16_f32 v253, v217, v216
    v_cvt_pk_bf16_f32 v254, v215, v214
    v_cvt_pk_bf16_f32 v255, v213, v212
    s_mov_b32 s86, 196608
    s_mov_b64 exec, s[78:79]
    buffer_store_dwordx4 v[252:255], v250, s[40:43], s86 offen sc1
    s_mov_b64 exec, -1
    v_mfma_f32_32x32x16_bf16 v[112:127], v[204:207], a[164:167], v[112:127]
    ds_read_b64_tr_b16 v[202:203], v222 offset:35328
    buffer_load_dwordx4 v240, s[32:35], s66 offen offset:2048 lds
    s_lshl_b32 s83, s2, 2
    s_add_u32 s83, s83, s52
    s_mul_i32 s84, s83, 7282
    v_mfma_f32_32x32x16_bf16 v[128:143], v[208:211], a[160:163], v[128:143]
    ds_read_b64_tr_b16 v[204:205], v223 offset:34816
    s_lshr_b32 s84, s84, 16
    s_mul_i32 s85, s84, 9
    s_sub_u32 s83, s83, s85
    s_mul_i32 s85, s84, 36864
    s_lshl_b32 s88, s83, 7
    v_mfma_f32_32x32x16_bf16 v[144:159], v[208:211], a[164:167], v[144:159]
    ds_read_b64_tr_b16 v[206:207], v223 offset:35328
    buffer_load_dwordx4 v241, s[32:35], s67 offen offset:3072 lds
    s_sub_u32 s82, 8, s54
    s_and_b32 s82, s82, 7
    s_waitcnt lgkmcnt(4)
    v_mfma_f32_32x32x16_bf16 v[32:47], v[192:195], a[168:171], v[32:47]
    ds_read_b64_tr_b16 v[208:209], v220 offset:36864
    s_add_u32 s82, s82, 1
    s_mul_i32 s82, s82, 589824
    v_add_u32 v242, s82, v242
    s_add_u32 m0, s55, 0
    s_add_u32 s19, s85, s88
    v_mfma_f32_32x32x16_bf16 v[48:63], v[192:195], a[172:175], v[48:63]
    ds_read_b64_tr_b16 v[210:211], v220 offset:37376
    buffer_load_dwordx4 v242, s[36:39], 0 offen lds
    s_sub_u32 s85, s19, s92
    v_add_u32 v246, s85, v246
    s_lshl_b32 s92, s52, 12
    v_mfma_f32_32x32x16_bf16 v[64:79], v[196:199], a[168:171], v[64:79]
    ds_read_b64_tr_b16 v[192:193], v221 offset:36864
    s_sub_u32 s85, s92, s80
    v_add_u32 v245, s85, v245
    s_mul_i32 s85, s84, 57
    s_lshr_b32 s85, s85, 11
    s_lshl_b32 s88, s85, 2
    v_mfma_f32_32x32x16_bf16 v[80:95], v[196:199], a[172:175], v[80:95]
    ds_read_b64_tr_b16 v[194:195], v221 offset:37376
    buffer_load_dwordx4 v242, s[36:39], s58 offen offset:1024 lds
    s_sub_u32 s88, 6, s88
    s_and_b32 s88, s88, 14
    s_waitcnt lgkmcnt(4)
    v_mfma_f32_32x32x16_bf16 v[96:111], v[200:203], a[168:171], v[96:111]
    ds_read_b64_tr_b16 v[196:197], v222 offset:36864
    s_waitcnt vmcnt(25)
    ds_read_b128 a[192:195], v236 offset:32768
    s_mul_i32 s85, s85, 36
    s_sub_u32 s84, s84, s85
    s_lshr_b32 s93, s84, 3
    v_mfma_f32_32x32x16_bf16 v[112:127], v[200:203], a[172:175], v[112:127]
    ds_read_b64_tr_b16 v[198:199], v222 offset:37376
    ds_read_b128 a[200:203], v237 offset:32768
    buffer_load_dwordx4 v242, s[36:39], s59 offen offset:2048 lds
    s_and_b32 s93, s93, 2
    s_add_u32 s93, s93, 32
    v_mfma_f32_32x32x16_bf16 v[128:143], v[204:207], a[168:171], v[128:143]
    ds_read_b64_tr_b16 v[200:201], v223 offset:36864
    ds_read_b128 a[208:211], v238 offset:32768
    s_xor_b32 s86, s88, s84
    s_and_b32 s86, s86, 46
    s_cselect_b32 s93, s84, s93
    v_mfma_f32_32x32x16_bf16 v[144:159], v[204:207], a[172:175], v[144:159]
    ds_read_b64_tr_b16 v[202:203], v223 offset:37376
    ds_read_b128 a[216:219], v239 offset:32768
    buffer_load_dwordx4 v242, s[36:39], s60 offen offset:3072 lds
    s_sub_u32 s82, s54, 8
    s_waitcnt lgkmcnt(8)
    v_mfma_f32_32x32x16_bf16 v[32:47], v[208:211], a[176:179], v[32:47]
    ds_read_b64_tr_b16 v[204:205], v220 offset:38912
    s_waitcnt vmcnt(23)
    ds_read_b128 a[196:199], v236 offset:36864
    s_mul_i32 s82, s82, 589824
    v_add_u32 v242, s82, v242
    v_add_u32 v242, s17, v242
    v_mfma_f32_32x32x16_bf16 v[48:63], v[208:211], a[180:183], v[48:63]
    ds_read_b64_tr_b16 v[206:207], v220 offset:39424
    ds_read_b128 a[204:207], v237 offset:36864
    s_add_u32 m0, s55, 131072
    s_nop 0
    buffer_load_dwordx4 v242, s[36:39], 0 offen lds
    v_mfma_f32_32x32x16_bf16 v[64:79], v[192:195], a[176:179], v[64:79]
    ds_read_b64_tr_b16 v[208:209], v221 offset:38912
    ds_read_b128 a[212:215], v238 offset:36864
    s_lshl_b32 s86, s84, 3
    s_and_b32 s86, s86, 16
    s_add_u32 s88, s88, s86
    v_mfma_f32_32x32x16_bf16 v[80:95], v[192:195], a[180:183], v[80:95]
    ds_read_b64_tr_b16 v[210:211], v221 offset:39424
    ds_read_b128 a[220:223], v239 offset:36864
    buffer_load_dwordx4 v242, s[36:39], s58 offen offset:1024 lds
    s_waitcnt lgkmcnt(9)
    v_mfma_f32_32x32x16_bf16 v[96:111], v[196:199], a[176:179], v[96:111]
    ds_read_b64_tr_b16 v[192:193], v222 offset:38912
    s_cmp_ge_u32 s84, 32
    s_cselect_b32 s93, s88, s93
    s_and_b32 s84, s84, 1
    s_or_b32 s84, s84, s93
    s_lshr_b32 s88, s84, 4
    v_mfma_f32_32x32x16_bf16 v[112:127], v[196:199], a[180:183], v[112:127]
    ds_read_b64_tr_b16 v[194:195], v222 offset:39424
    buffer_load_dwordx4 v242, s[36:39], s59 offen offset:2048 lds
    s_lshl_b32 s88, s88, 1
    s_and_b32 s93, s84, 1
    s_add_u32 s93, s93, s88
    v_mfma_f32_32x32x16_bf16 v[128:143], v[200:203], a[176:179], v[128:143]
    ds_read_b64_tr_b16 v[196:197], v223 offset:38912
    s_lshl_b32 s88, s88, 2
    s_xor_b32 s88, s88, s84
    s_bfe_u32 s88, s88, 0x30001
    v_mfma_f32_32x32x16_bf16 v[144:159], v[200:203], a[180:183], v[144:159]
    ds_read_b64_tr_b16 v[198:199], v223 offset:39424
    s_waitcnt vmcnt(21) lgkmcnt(4)
    s_barrier
    buffer_load_dwordx4 v242, s[36:39], s60 offen offset:3072 lds
    v_mfma_f32_32x32x16_bf16 v[32:47], v[204:207], a[184:187], v[32:47]
    ds_read_b64_tr_b16 v[200:201], v220 offset:49152
    s_cmp_eq_u32 s93, 3
    s_cselect_b32 s86, 1, 3
    s_cselect_b32 s93, 24, s93
    s_mul_i32 s88, s88, s86
    s_add_u32 s88, s88, s93
    s_cmp_lt_u32 s84, 32
    s_cselect_b32 s88, s88, s84
    s_add_u32 s88, s88, s85
    s_mul_i32 s88, s88, 9
    s_add_u32 s88, s88, s83
    s_lshl_b32 s88, s88, 12
    s_add_u32 s88, s88, 18874368
    v_mfma_f32_32x32x16_bf16 v[48:63], v[204:207], a[188:191], v[48:63]
    ds_read_b64_tr_b16 v[202:203], v220 offset:49664
    v_add_u32 v242, 589824, v242
    s_add_u32 m0, s55, 147456
    s_nop 0
    buffer_load_dwordx4 v242, s[36:39], 0 offen lds
    v_mfma_f32_32x32x16_bf16 v[64:79], v[208:211], a[184:187], v[64:79]
    ds_read_b64_tr_b16 v[204:205], v221 offset:49152
    v_mfma_f32_32x32x16_bf16 v[80:95], v[208:211], a[188:191], v[80:95]
    ds_read_b64_tr_b16 v[206:207], v221 offset:49664
    buffer_load_dwordx4 v242, s[36:39], s58 offen offset:1024 lds
    s_waitcnt lgkmcnt(4)
    v_mfma_f32_32x32x16_bf16 v[96:111], v[192:195], a[184:187], v[96:111]
    ds_read_b64_tr_b16 v[208:209], v220 offset:51200
    v_mfma_f32_32x32x16_bf16 v[112:127], v[192:195], a[188:191], v[112:127]
    ds_read_b64_tr_b16 v[210:211], v220 offset:51712
    buffer_load_dwordx4 v242, s[36:39], s59 offen offset:2048 lds
    v_mfma_f32_32x32x16_bf16 v[128:143], v[196:199], a[184:187], v[128:143]
    ds_read_b64_tr_b16 v[192:193], v221 offset:51200
    v_mfma_f32_32x32x16_bf16 v[144:159], v[196:199], a[188:191], v[144:159]
    ds_read_b64_tr_b16 v[194:195], v221 offset:51712
    buffer_load_dwordx4 v242, s[36:39], s60 offen offset:3072 lds
    v_mul_u32_u24 v243, 1152, v248
    s_waitcnt lgkmcnt(4)
    v_mfma_f32_32x32x16_bf16 v[32:47], v[200:203], a[192:195], v[32:47]
    ds_read_b64_tr_b16 v[196:197], v220 offset:53248
    v_mfma_f32_32x32x16_bf16 v[48:63], v[200:203], a[196:199], v[48:63]
    ds_read_b64_tr_b16 v[198:199], v220 offset:53760
    s_mov_b32 exec_hi, 0
    buffer_load_dword v243, v243, s[48:51], s19 offen
    s_mov_b64 exec, -1
    v_mfma_f32_32x32x16_bf16 v[64:79], v[204:207], a[192:195], v[64:79]
    ds_read_b64_tr_b16 v[200:201], v221 offset:53248
    v_mfma_f32_32x32x16_bf16 v[80:95], v[204:207], a[196:199], v[80:95]
    ds_read_b64_tr_b16 v[202:203], v221 offset:53760
    s_waitcnt lgkmcnt(4)
    v_mfma_f32_32x32x16_bf16 v[32:47], v[208:211], a[200:203], v[32:47]
    ds_read_b64_tr_b16 v[204:205], v220 offset:55296
    v_mfma_f32_32x32x16_bf16 v[48:63], v[208:211], a[204:207], v[48:63]
    ds_read_b64_tr_b16 v[206:207], v220 offset:55808
    v_mfma_f32_32x32x16_bf16 v[64:79], v[192:195], a[200:203], v[64:79]
    ds_read_b64_tr_b16 v[208:209], v221 offset:55296
    s_waitcnt vmcnt(18)
    ds_read_b128 a[224:227], v236
    v_mfma_f32_32x32x16_bf16 v[80:95], v[192:195], a[204:207], v[80:95]
    ds_read_b64_tr_b16 v[210:211], v221 offset:55808
    ds_read_b128 a[232:235], v237
    s_waitcnt vmcnt(9)
    s_barrier
    s_waitcnt lgkmcnt(6)
    v_mfma_f32_32x32x16_bf16 v[32:47], v[196:199], a[208:211], v[32:47]
    ds_read_b64_tr_b16 v[192:193], v220
    ds_read_b128 a[240:243], v238
    v_accvgpr_read_b32 v249, a254
    v_cmp_eq_u32 vcc, 0, v249
    s_cbranch_vccnz SLOW_N
BACK_N:
    v_readfirstlane_b32 s77, v249
    v_mfma_f32_32x32x16_bf16 v[48:63], v[196:199], a[212:215], v[48:63]
    ds_read_b64_tr_b16 v[194:195], v220 offset:512
    ds_read_b128 a[248:251], v239
    v_mfma_f32_32x32x16_bf16 v[64:79], v[200:203], a[208:211], v[64:79]
    ds_read_b64_tr_b16 v[196:197], v220 offset:2048
    ds_read_b128 a[228:231], v236 offset:4096
    v_mfma_f32_32x32x16_bf16 v[80:95], v[200:203], a[212:215], v[80:95]
    ds_read_b64_tr_b16 v[198:199], v220 offset:2560
    ds_read_b128 a[236:239], v237 offset:4096
    s_lshl_b32 s83, s2, 2
    s_add_u32 s83, s83, 36249600
    v_mov_b32 v249, s77
    s_cmp_eq_u32 s52, 0
    s_cselect_b64 exec, 1, 0
    buffer_store_dword v249, off, s[40:43], s83 sc1
    s_mov_b64 exec, -1
    s_waitcnt lgkmcnt(9)
    v_mfma_f32_32x32x16_bf16 v[32:47], v[204:207], a[216:219], v[32:47]
    ds_read_b64_tr_b16 v[200:201], v220 offset:4096
    ds_read_b128 a[244:247], v238 offset:4096
    v_mfma_f32_32x32x16_bf16 v[48:63], v[204:207], a[220:223], v[48:63]
    ds_read_b64_tr_b16 v[202:203], v220 offset:4608
    ds_read_b128 a[252:255], v239 offset:4096
    v_mfma_f32_32x32x16_bf16 v[64:79], v[208:211], a[216:219], v[64:79]
    ds_read_b64_tr_b16 v[204:205], v220 offset:6144
    v_mfma_f32_32x32x16_bf16 v[80:95], v[208:211], a[220:223], v[80:95]
    ds_read_b64_tr_b16 v[206:207], v220 offset:6656
    s_waitcnt lgkmcnt(2)
    v_mfma_f32_32x32x16_bf16 v[32:47], v[192:195], a[224:227], v[32:47]
    ds_read_b64_tr_b16 v[208:209], v221
    v_add_u32 v228, 131072, v220
    v_mfma_f32_32x32x16_bf16 v[48:63], v[192:195], a[228:231], v[48:63]
    ds_read_b64_tr_b16 v[210:211], v221 offset:512
    v_mfma_f32_32x32x16_bf16 v[32:47], v[196:199], a[232:235], v[32:47]
    ds_read_b64_tr_b16 v[192:193], v221 offset:2048
    v_add_u32 v229, 131072, v221
    v_mfma_f32_32x32x16_bf16 v[48:63], v[196:199], a[236:239], v[48:63]
    ds_read_b64_tr_b16 v[194:195], v221 offset:2560
    s_waitcnt lgkmcnt(4)
    v_mfma_f32_32x32x16_bf16 v[32:47], v[200:203], a[240:243], v[32:47]
    ds_read_b64_tr_b16 v[196:197], v221 offset:4096
    v_mfma_f32_32x32x16_bf16 v[48:63], v[200:203], a[244:247], v[48:63]
    ds_read_b64_tr_b16 v[198:199], v221 offset:4608
    v_add_u32 v230, 131072, v222
    v_mfma_f32_32x32x16_bf16 v[32:47], v[204:207], a[248:251], v[32:47]
    ds_read_b64_tr_b16 v[200:201], v221 offset:6144
    v_mfma_f32_32x32x16_bf16 v[48:63], v[204:207], a[252:255], v[48:63]
    ds_read_b64_tr_b16 v[202:203], v221 offset:6656
    s_waitcnt lgkmcnt(4)
    v_mfma_f32_32x32x16_bf16 v[64:79], v[208:211], a[224:227], v[64:79]
    ds_read_b64_tr_b16 v[204:205], v222 offset:49152
    v_add_u32 v231, 131072, v223
    v_mfma_f32_32x32x16_bf16 v[80:95], v[208:211], a[228:231], v[80:95]
    ds_read_b64_tr_b16 v[206:207], v222 offset:49664
    v_mfma_f32_32x32x16_bf16 v[64:79], v[192:195], a[232:235], v[64:79]
    ds_read_b64_tr_b16 v[208:209], v223 offset:49152
    s_cmp_eq_u32 s54, 6
    s_mov_b32 s82, 589824
    s_cselect_b32 s82, 0xffc10000, s82
    v_add_u32 v242, s82, v242
    s_add_u32 m0, s55, 98304
    v_mfma_f32_32x32x16_bf16 v[80:95], v[192:195], a[236:239], v[80:95]
    ds_read_b64_tr_b16 v[210:211], v223 offset:49664
    buffer_load_dwordx4 v242, s[36:39], 0 offen lds
    v_add_u32 v224, 65536, v220
    v_mul_f32 v212, s76, v32
    s_waitcnt lgkmcnt(4)
    v_mfma_f32_32x32x16_bf16 v[64:79], v[196:199], a[240:243], v[64:79]
    ds_read_b64_tr_b16 v[192:193], v222 offset:51200
    v_mul_f32 v213, s76, v33
    v_mul_f32 v214, s76, v34
    v_mul_f32 v215, s76, v35
    v_exp_f32 v212, v212
    v_mfma_f32_32x32x16_bf16 v[80:95], v[196:199], a[244:247], v[80:95]
    ds_read_b64_tr_b16 v[194:195], v222 offset:51712
    buffer_load_dwordx4 v242, s[36:39], s58 offen offset:1024 lds
    v_add_u32 v225, 65536, v221
    v_exp_f32 v213, v213
    v_mfma_f32_32x32x16_bf16 v[64:79], v[200:203], a[248:251], v[64:79]
    ds_read_b64_tr_b16 v[196:197], v223 offset:51200
    v_exp_f32 v214, v214
    v_exp_f32 v215, v215
    v_mul_f32 v32, v32, v36
    v_mfma_f32_32x32x16_bf16 v[80:95], v[200:203], a[252:255], v[80:95]
    ds_read_b64_tr_b16 v[198:199], v223 offset:51712
    buffer_load_dwordx4 v242, s[36:39], s59 offen offset:2048 lds
    v_mul_f32 v33, v33, v37
    v_mul_f32 v34, v34, v38
    s_waitcnt lgkmcnt(4)
    v_mfma_f32_32x32x16_bf16 v[96:111], v[204:207], a[192:195], v[96:111]
    ds_read_b64_tr_b16 v[200:201], v222 offset:53248
    v_add_u32 v226, 65536, v222
    v_mul_f32 v35, v35, v39
    v_add_f32 v212, 1.0, v212
    v_add_f32 v213, 1.0, v213
    v_add_f32 v214, 1.0, v214
    v_mfma_f32_32x32x16_bf16 v[112:127], v[204:207], a[196:199], v[112:127]
    ds_read_b64_tr_b16 v[202:203], v222 offset:53760
    buffer_load_dwordx4 v242, s[36:39], s60 offen offset:3072 lds
    v_add_f32 v215, 1.0, v215
    v_rcp_f32 v212, v212
    v_mfma_f32_32x32x16_bf16 v[128:143], v[208:211], a[192:195], v[128:143]
    ds_read_b64_tr_b16 v[204:205], v223 offset:53248
    v_rcp_f32 v213, v213
    v_rcp_f32 v214, v214
    v_mul_f32 v32, v32, v212
    v_mfma_f32_32x32x16_bf16 v[144:159], v[208:211], a[196:199], v[144:159]
    ds_read_b64_tr_b16 v[206:207], v223 offset:53760
    v_add_u32 v227, 65536, v223
    v_rcp_f32 v215, v215
    v_mul_f32 v33, v33, v213
    s_waitcnt lgkmcnt(4)
    v_mfma_f32_32x32x16_bf16 v[96:111], v[192:195], a[200:203], v[96:111]
    ds_read_b64_tr_b16 v[208:209], v222 offset:55296
    v_mul_f32 v34, v34, v214
    v_mul_f32 v35, v35, v215
    v_cvt_pk_bf16_f32 v36, v32, v33
    v_cvt_pk_bf16_f32 v37, v34, v35
    v_mul_f32 v216, s76, v40
    v_mfma_f32_32x32x16_bf16 v[112:127], v[192:195], a[204:207], v[112:127]
    ds_read_b64_tr_b16 v[210:211], v222 offset:55808
    v_mul_f32 v217, s76, v41
    v_mul_f32 v218, s76, v42
    v_mul_f32 v219, s76, v43
    v_exp_f32 v216, v216
    v_mfma_f32_32x32x16_bf16 v[128:143], v[196:199], a[200:203], v[128:143]
    ds_read_b64_tr_b16 v[192:193], v223 offset:55296
    v_exp_f32 v217, v217
    v_exp_f32 v218, v218
    v_mul_f32 v40, v40, v44
    v_mfma_f32_32x32x16_bf16 v[144:159], v[196:199], a[204:207], v[144:159]
    ds_read_b64_tr_b16 v[194:195], v223 offset:55808
    v_exp_f32 v219, v219
    v_mul_f32 v41, v41, v45
    v_mul_f32 v42, v42, v46
    s_waitcnt lgkmcnt(4)
    v_mfma_f32_32x32x16_bf16 v[96:111], v[200:203], a[208:211], v[96:111]
    ds_read_b64_tr_b16 v[196:197], v222
    v_mul_f32 v43, v43, v47
    v_add_f32 v216, 1.0, v216
    v_add_f32 v217, 1.0, v217
    v_add_f32 v218, 1.0, v218
    v_add_f32 v219, 1.0, v219
    v_mfma_f32_32x32x16_bf16 v[112:127], v[200:203], a[212:215], v[112:127]
    ds_read_b64_tr_b16 v[198:199], v222 offset:512
    v_rcp_f32 v216, v216
    v_rcp_f32 v217, v217
    v_mul_f32 v40, v40, v216
    v_mfma_f32_32x32x16_bf16 v[128:143], v[204:207], a[208:211], v[128:143]
    ds_read_b64_tr_b16 v[200:201], v223
    v_rcp_f32 v218, v218
    v_rcp_f32 v219, v219
    v_mul_f32 v41, v41, v217
    v_mfma_f32_32x32x16_bf16 v[144:159], v[204:207], a[212:215], v[144:159]
    ds_read_b64_tr_b16 v[202:203], v223 offset:512
    v_mul_f32 v42, v42, v218
    v_mul_f32 v43, v43, v219
    v_cvt_pk_bf16_f32 v38, v40, v41
    v_cvt_pk_bf16_f32 v39, v42, v43
    s_waitcnt lgkmcnt(4)
    v_mfma_f32_32x32x16_bf16 v[96:111], v[208:211], a[216:219], v[96:111]
    ds_read_b64_tr_b16 v[204:205], v222 offset:2048
    v_add_u32 v242, 589824, v242
    s_add_u32 m0, s55, 114688
    s_nop 0
    buffer_load_dwordx4 v242, s[36:39], 0 offen lds
    v_mul_f32 v212, s76, v48
    v_mfma_f32_32x32x16_bf16 v[112:127], v[208:211], a[220:223], v[112:127]
    ds_read_b64_tr_b16 v[206:207], v222 offset:2560
KF_PG3:
    s_cbranch_execz KF_WMID
    v_mul_f32 v213, s76, v49
    v_mul_f32 v214, s76, v50
    v_mul_f32 v215, s76, v51
    v_exp_f32 v212, v212
    v_mfma_f32_32x32x16_bf16 v[128:143], v[192:195], a[216:219], v[128:143]
    ds_read_b64_tr_b16 v[208:209], v223 offset:2048
    buffer_load_dwordx4 v242, s[36:39], s58 offen offset:1024 lds
    v_exp_f32 v213, v213
    v_mul_f32 v48, v48, v52
    v_mfma_f32_32x32x16_bf16 v[144:159], v[192:195], a[220:223], v[144:159]
    ds_read_b64_tr_b16 v[210:211], v223 offset:2560
    buffer_store_dwordx4 v[36:39], v244, s[40:43], s68 offen sc1
    s_waitcnt lgkmcnt(4)
    v_mfma_f32_32x32x16_bf16 v[96:111], v[196:199], a[224:227], v[96:111]
    ds_read_b64_tr_b16 v[192:193], v222 offset:4096
    v_exp_f32 v214, v214
    v_exp_f32 v215, v215
    v_mul_f32 v49, v49, v53
    v_mfma_f32_32x32x16_bf16 v[112:127], v[196:199], a[228:231], v[112:127]
    ds_read_b64_tr_b16 v[194:195], v222 offset:4608
    v_mul_f32 v50, v50, v54
    v_mul_f32 v51, v51, v55
    v_add_f32 v212, 1.0, v212
    v_add_f32 v213, 1.0, v213
    v_add_f32 v214, 1.0, v214
    v_mfma_f32_32x32x16_bf16 v[128:143], v[200:203], a[224:227], v[128:143]
    ds_read_b64_tr_b16 v[196:197], v223 offset:4096
    buffer_load_dwordx4 v242, s[36:39], s59 offen offset:2048 lds
    v_add_f32 v215, 1.0, v215
    v_rcp_f32 v212, v212
    v_mfma_f32_32x32x16_bf16 v[144:159], v[200:203], a[228:231], v[144:159]
    ds_read_b64_tr_b16 v[198:199], v223 offset:4608
    v_rcp_f32 v213, v213
    v_rcp_f32 v214, v214
    s_waitcnt lgkmcnt(4)
    v_mfma_f32_32x32x16_bf16 v[96:111], v[204:207], a[232:235], v[96:111]
    ds_read_b64_tr_b16 v[200:201], v222 offset:6144
    buffer_load_dwordx4 v242, s[36:39], s60 offen offset:3072 lds
    v_rcp_f32 v215, v215
    v_mul_f32 v48, v48, v212
    v_mfma_f32_32x32x16_bf16 v[112:127], v[204:207], a[236:239], v[112:127]
    ds_read_b64_tr_b16 v[202:203], v222 offset:6656
    v_mul_f32 v49, v49, v213
    v_mul_f32 v50, v50, v214
    v_mul_f32 v51, v51, v215
    v_cvt_pk_bf16_f32 v52, v48, v49
    v_cvt_pk_bf16_f32 v53, v50, v51
    v_mfma_f32_32x32x16_bf16 v[128:143], v[208:211], a[232:235], v[128:143]
    ds_read_b64_tr_b16 v[204:205], v223 offset:6144
    v_mul_f32 v216, s76, v56
    v_mul_f32 v217, s76, v57
    v_mul_f32 v218, s76, v58
    v_mul_f32 v219, s76, v59
    v_mul_f32 v56, v56, v60
    v_mfma_f32_32x32x16_bf16 v[144:159], v[208:211], a[236:239], v[144:159]
    ds_read_b64_tr_b16 v[206:207], v223 offset:6656
    s_waitcnt vmcnt(11) lgkmcnt(0)
    s_barrier
    v_exp_f32 v216, v216
    v_mfma_f32_32x32x16_bf16 v[96:111], v[192:195], a[240:243], v[96:111]
    ds_read_b64_tr_b16 v[208:209], v228
    s_mov_b64 s[48:49], s[22:23]
    s_mov_b32 s50, 5308416
    s_mov_b32 m0, s92
    s_nop 0
    buffer_load_dwordx4 v246, s[48:51], 0 offen lds
    v_mfma_f32_32x32x16_bf16 v[112:127], v[192:195], a[244:247], v[112:127]
    ds_read_b64_tr_b16 v[210:211], v228 offset:512
    v_exp_f32 v217, v217
    v_exp_f32 v218, v218
    v_mul_f32 v57, v57, v61
    v_mfma_f32_32x32x16_bf16 v[128:143], v[196:199], a[240:243], v[128:143]
    ds_read_b64_tr_b16 v[192:193], v229
    buffer_load_dwordx4 v246, s[48:51], s61 offen offset:1024 lds
    v_exp_f32 v219, v219
    v_mul_f32 v58, v58, v62
    v_mfma_f32_32x32x16_bf16 v[144:159], v[196:199], a[244:247], v[144:159]
    ds_read_b64_tr_b16 v[194:195], v229 offset:512
    v_mul_f32 v59, v59, v63
    v_add_f32 v216, 1.0, v216
    v_add_f32 v217, 1.0, v217
    v_add_f32 v218, 1.0, v218
    v_add_f32 v219, 1.0, v219
    v_mfma_f32_32x32x16_bf16 v[96:111], v[200:203], a[248:251], v[96:111]
    ds_read_b64_tr_b16 v[196:197], v228 offset:2048
    buffer_load_dwordx4 v246, s[48:51], s62 offen offset:2048 lds
    v_rcp_f32 v216, v216
    v_xor_b32 v233, 128, v232
    v_mfma_f32_32x32x16_bf16 v[112:127], v[200:203], a[252:255], v[112:127]
    ds_read_b64_tr_b16 v[198:199], v228 offset:2560
    v_rcp_f32 v217, v217
    v_rcp_f32 v218, v218
    v_mul_f32 v56, v56, v216
    v_mfma_f32_32x32x16_bf16 v[128:143], v[204:207], a[248:251], v[128:143]
    ds_read_b64_tr_b16 v[200:201], v229 offset:2048
    buffer_load_dwordx4 v246, s[48:51], s63 offen offset:3072 lds
    v_rcp_f32 v219, v219
    v_mul_f32 v57, v57, v217
    v_mfma_f32_32x32x16_bf16 v[144:159], v[204:207], a[252:255], v[144:159]
    ds_read_b64_tr_b16 v[202:203], v229 offset:2560
    v_mul_f32 v58, v58, v218
    v_mul_f32 v59, v59, v219
    v_cvt_pk_bf16_f32 v54, v56, v57
    v_cvt_pk_bf16_f32 v55, v58, v59
    buffer_store_dwordx4 v[52:55], v244, s[40:43], s69 offen sc1
    s_waitcnt lgkmcnt(4)
    v_mfma_f32_32x32x16_bf16 v[160:175], v[208:211], v[0:3], 0
    ds_read_b64_tr_b16 v[204:205], v228 offset:4096
    v_add_u32 v234, 131072, v232
    v_add_u32 v235, 131072, v233
    s_and_b32 s83, s2, 1
    s_lshl_b32 s83, s83, 3
    s_bfe_u32 s84, s2, 0x30003
    v_mfma_f32_32x32x16_bf16 v[176:191], v[208:211], v[4:7], 0
    ds_read_b64_tr_b16 v[206:207], v228 offset:4608
    s_add_u32 s83, s83, s84
    s_lshr_b32 s84, s2, 6
    v_mul_f32 v212, s76, v64
    v_mul_f32 v213, s76, v65
    v_mul_f32 v214, s76, v66
    v_mfma_f32_32x32x16_bf16 v[32:47], v[192:195], v[0:3], 0
    ds_read_b64_tr_b16 v[208:209], v229 offset:4096
    s_lshl_b32 s83, s83, 2
    v_mul_f32 v215, s76, v67
    v_exp_f32 v212, v212
    v_mul_f32 v64, v64, v68
    v_mfma_f32_32x32x16_bf16 v[48:63], v[192:195], v[4:7], 0
    ds_read_b64_tr_b16 v[210:211], v229 offset:4608
    s_add_u32 s83, s83, s84
    v_exp_f32 v213, v213
    v_mul_f32 v65, v65, v69
    s_waitcnt lgkmcnt(4)
    v_mfma_f32_32x32x16_bf16 v[160:175], v[196:199], v[8:11], v[160:175]
    ds_read_b64_tr_b16 v[192:193], v228 offset:6144
    s_cmp_eq_u32 s54, 4
    s_mov_b32 s82, 589824
    s_cselect_b32 s82, 0xffc10000, s82
    v_add_u32 v242, s82, v242
    s_add_u32 m0, s55, 16384
    v_mfma_f32_32x32x16_bf16 v[176:191], v[196:199], v[12:15], v[176:191]
    ds_read_b64_tr_b16 v[194:195], v228 offset:6656
    buffer_load_dwordx4 v242, s[36:39], 0 offen lds
    s_add_u32 s84, s53, 1
    v_exp_f32 v214, v214
    v_mfma_f32_32x32x16_bf16 v[32:47], v[200:203], v[8:11], v[32:47]
    ds_read_b64_tr_b16 v[196:197], v229 offset:6144
    s_and_b32 s84, s84, 3
    v_exp_f32 v215, v215
    v_mul_f32 v66, v66, v70
    v_mul_f32 v67, v67, v71
    v_mfma_f32_32x32x16_bf16 v[48:63], v[200:203], v[12:15], v[48:63]
    ds_read_b64_tr_b16 v[198:199], v229 offset:6656
    buffer_load_dwordx4 v242, s[36:39], s58 offen offset:1024 lds
    s_lshl_b32 s85, s83, 2
    v_add_f32 v212, 1.0, v212
    s_waitcnt lgkmcnt(4)
    v_mfma_f32_32x32x16_bf16 v[160:175], v[204:207], v[16:19], v[160:175]
    ds_read_b64_tr_b16 v[200:201], v228 offset:16384
    v_add_f32 v213, 1.0, v213
    v_add_f32 v214, 1.0, v214
    v_add_f32 v215, 1.0, v215
    v_rcp_f32 v212, v212
    v_mfma_f32_32x32x16_bf16 v[176:191], v[204:207], v[20:23], v[176:191]
    ds_read_b64_tr_b16 v[202:203], v228 offset:16896
    buffer_load_dwordx4 v242, s[36:39], s59 offen offset:2048 lds
    s_add_u32 s84, s84, s85
    v_rcp_f32 v213, v213
    v_mfma_f32_32x32x16_bf16 v[32:47], v[208:211], v[16:19], v[32:47]
    ds_read_b64_tr_b16 v[204:205], v229 offset:16384
    s_lshl_b32 s84, s84, 2
    v_rcp_f32 v214, v214
    v_rcp_f32 v215, v215
    v_mfma_f32_32x32x16_bf16 v[48:63], v[208:211], v[20:23], v[48:63]
    ds_read_b64_tr_b16 v[206:207], v229 offset:16896
    buffer_load_dwordx4 v242, s[36:39], s60 offen offset:3072 lds
    s_add_u32 s84, s84, s52
    v_mul_f32 v64, v64, v212
    s_waitcnt lgkmcnt(4)
    v_mfma_f32_32x32x16_bf16 v[160:175], v[192:195], v[24:27], v[160:175]
    ds_read_b64_tr_b16 v[208:209], v228 offset:18432
    v_mul_f32 v65, v65, v213
    v_mul_f32 v66, v66, v214
    v_mul_f32 v67, v67, v215
    v_cvt_pk_bf16_f32 v68, v64, v65
    v_cvt_pk_bf16_f32 v69, v66, v67
    v_mfma_f32_32x32x16_bf16 v[176:191], v[192:195], v[28:31], v[176:191]
    ds_read_b64_tr_b16 v[210:211], v228 offset:18944
    s_mul_i32 s84, s84, 6144
    v_mul_f32 v216, s76, v72
    v_mul_f32 v217, s76, v73
    v_mul_f32 v218, s76, v74
    v_mul_f32 v219, s76, v75
    v_mfma_f32_32x32x16_bf16 v[32:47], v[196:199], v[24:27], v[32:47]
    ds_read_b64_tr_b16 v[192:193], v229 offset:18432
    s_add_u32 s93, s84, 28909568
    v_exp_f32 v216, v216
    v_exp_f32 v217, v217
    v_mfma_f32_32x32x16_bf16 v[48:63], v[196:199], v[28:31], v[48:63]
    ds_read_b64_tr_b16 v[194:195], v229 offset:18944
    s_add_u32 s84, s53, 2
    v_exp_f32 v218, v218
    v_mul_f32 v72, v72, v76
    s_waitcnt lgkmcnt(4)
    v_mfma_f32_32x32x16_bf16 v[160:175], v[200:203], a[0:3], v[160:175]
    ds_read_b64_tr_b16 v[196:197], v228 offset:20480
    v_exp_f32 v219, v219
    v_mul_f32 v73, v73, v77
    v_mul_f32 v74, v74, v78
    v_mul_f32 v75, v75, v79
    v_mfma_f32_32x32x16_bf16 v[176:191], v[200:203], a[4:7], v[176:191]
    ds_read_b64_tr_b16 v[198:199], v228 offset:20992
    s_waitcnt vmcnt(5)
    ds_read_b64_tr_b16 v[236:237], v245
    ds_read_b64_tr_b16 v[238:239], v245 offset:1024
    s_and_b32 s84, s84, 3
    v_add_f32 v216, 1.0, v216
    v_mfma_f32_32x32x16_bf16 v[32:47], v[204:207], a[0:3], v[32:47]
    ds_read_b64_tr_b16 v[200:201], v229 offset:20480
    v_add_u32 v242, 589824, v242
    s_add_u32 m0, s55, 65536
    s_nop 0
    buffer_load_dwordx4 v242, s[36:39], 0 offen lds
    ds_read_b64_tr_b16 v[252:253], v245 offset:32
    v_mfma_f32_32x32x16_bf16 v[48:63], v[204:207], a[4:7], v[48:63]
    ds_read_b64_tr_b16 v[202:203], v229 offset:20992
    ds_read_b64_tr_b16 v[254:255], v245 offset:1056
    s_lshl_b32 s85, s83, 2
    s_add_u32 s84, s84, s85
    v_add_f32 v217, 1.0, v217
    s_waitcnt lgkmcnt(8)
    v_mfma_f32_32x32x16_bf16 v[160:175], v[208:211], a[8:11], v[160:175]
    ds_read_b64_tr_b16 v[204:205], v228 offset:22528
    buffer_load_dwordx4 v242, s[36:39], s58 offen offset:1024 lds
    v_add_f32 v218, 1.0, v218
    v_add_f32 v219, 1.0, v219
    v_mfma_f32_32x32x16_bf16 v[176:191], v[208:211], a[12:15], v[176:191]
    ds_read_b64_tr_b16 v[206:207], v228 offset:23040
    s_lshl_b32 s84, s84, 2
    v_rcp_f32 v216, v216
    v_rcp_f32 v217, v217
    v_mfma_f32_32x32x16_bf16 v[32:47], v[192:195], a[8:11], v[32:47]
    ds_read_b64_tr_b16 v[208:209], v229 offset:22528
    s_waitcnt lgkmcnt(7)
    buffer_store_dwordx4 v[236:239], v244, s[40:43], s88 offen sc1
    v_mfma_f32_32x32x16_bf16 v[48:63], v[192:195], a[12:15], v[48:63]
    ds_read_b64_tr_b16 v[210:211], v229 offset:23040
    s_barrier
    ds_read_b64_tr_b16 v[236:237], v245 offset:64
    ds_read_b64_tr_b16 v[238:239], v245 offset:1088
    s_add_u32 s84, s84, s52
    s_waitcnt lgkmcnt(7)
    v_mfma_f32_32x32x16_bf16 v[160:175], v[196:199], a[16:19], v[160:175]
    ds_read_b64_tr_b16 v[192:193], v224 offset:32768
    buffer_load_dwordx4 v242, s[36:39], s59 offen offset:2048 lds
    s_mul_i32 s84, s84, 6144
    v_rcp_f32 v218, v218
    v_mfma_f32_32x32x16_bf16 v[176:191], v[196:199], a[20:23], v[176:191]
    ds_read_b64_tr_b16 v[194:195], v224 offset:33280
    s_add_u32 s94, s84, 28911616
    v_rcp_f32 v219, v219
    v_mul_f32 v72, v72, v216
    v_mul_f32 v73, v73, v217
    v_mfma_f32_32x32x16_bf16 v[32:47], v[200:203], a[16:19], v[32:47]
    ds_read_b64_tr_b16 v[196:197], v225 offset:32768
    buffer_load_dwordx4 v242, s[36:39], s60 offen offset:3072 lds
    s_add_u32 s84, s53, 3
    v_mul_f32 v74, v74, v218
    v_mul_f32 v75, v75, v219
    v_mfma_f32_32x32x16_bf16 v[48:63], v[200:203], a[20:23], v[48:63]
    ds_read_b64_tr_b16 v[198:199], v225 offset:33280
    s_and_b32 s84, s84, 3
    v_cvt_pk_bf16_f32 v70, v72, v73
    v_cvt_pk_bf16_f32 v71, v74, v75
    v_mul_f32 v212, s76, v80
    s_waitcnt lgkmcnt(6)
    v_mfma_f32_32x32x16_bf16 v[160:175], v[204:207], a[24:27], v[160:175]
    ds_read_b64_tr_b16 v[200:201], v224 offset:34816
    buffer_store_dwordx4 v[252:255], v244, s[40:43], s88 offen offset:1024 sc1
    v_mfma_f32_32x32x16_bf16 v[176:191], v[204:207], a[28:31], v[176:191]
    ds_read_b64_tr_b16 v[202:203], v224 offset:35328
    ds_read_b64_tr_b16 v[252:253], v245 offset:96
    ds_read_b64_tr_b16 v[254:255], v245 offset:1120
    s_lshl_b32 s85, s83, 2
    v_mul_f32 v213, s76, v81
    v_mul_f32 v214, s76, v82
    v_mfma_f32_32x32x16_bf16 v[32:47], v[208:211], a[24:27], v[32:47]
    ds_read_b64_tr_b16 v[204:205], v225 offset:34816
    s_waitcnt lgkmcnt(9)
    buffer_store_dwordx4 v[236:239], v244, s[40:43], s88 offen offset:2048 sc1
    v_mfma_f32_32x32x16_bf16 v[48:63], v[208:211], a[28:31], v[48:63]
    ds_read_b64_tr_b16 v[206:207], v225 offset:35328
    buffer_store_dwordx4 v[68:71], v244, s[40:43], s68 offen offset:1024 sc1
    s_waitcnt lgkmcnt(6)
    v_mfma_f32_32x32x16_bf16 v[160:175], v[192:195], a[32:35], v[160:175]
    ds_read_b64_tr_b16 v[208:209], v224 offset:36864
    s_add_u32 s84, s84, s85
    s_lshl_b32 s84, s84, 2
    v_mul_f32 v215, s76, v83
    v_exp_f32 v212, v212
    v_mfma_f32_32x32x16_bf16 v[176:191], v[192:195], a[36:39], v[176:191]
    ds_read_b64_tr_b16 v[210:211], v224 offset:37376
    s_add_u32 s84, s84, s52
    v_exp_f32 v213, v213
    v_exp_f32 v214, v214
    v_mfma_f32_32x32x16_bf16 v[32:47], v[196:199], a[32:35], v[32:47]
    ds_read_b64_tr_b16 v[192:193], v225 offset:36864
    s_waitcnt lgkmcnt(5)
    buffer_store_dwordx4 v[252:255], v244, s[40:43], s88 offen offset:3072 sc1
    v_mfma_f32_32x32x16_bf16 v[48:63], v[196:199], a[36:39], v[48:63]
    ds_read_b64_tr_b16 v[194:195], v225 offset:37376
    s_mul_i32 s84, s84, 6144
    s_add_u32 s95, s84, 28913664
    v_exp_f32 v215, v215
    s_waitcnt lgkmcnt(4)
    v_mfma_f32_32x32x16_bf16 v[160:175], v[200:203], a[40:43], v[160:175]
    ds_read_b64_tr_b16 v[196:197], v224 offset:38912
    v_mul_f32 v80, v80, v84
    v_mul_f32 v81, v81, v85
    v_mul_f32 v82, v82, v86
    v_mul_f32 v83, v83, v87
    v_add_f32 v212, 1.0, v212
    v_mfma_f32_32x32x16_bf16 v[176:191], v[200:203], a[44:47], v[176:191]
    ds_read_b64_tr_b16 v[198:199], v224 offset:39424
    s_cmp_eq_u32 s54, 2
    s_mov_b32 s82, 589824
    s_cselect_b32 s82, 0xffc10000, s82
    v_add_u32 v242, s82, v242
    s_add_u32 m0, s55, 81920
    v_mfma_f32_32x32x16_bf16 v[32:47], v[204:207], a[40:43], v[32:47]
    ds_read_b64_tr_b16 v[200:201], v225 offset:38912
    buffer_load_dwordx4 v242, s[36:39], 0 offen lds
    s_lshl_b32 s84, s83, 2
    s_add_u32 s84, s84, s52
    v_add_f32 v213, 1.0, v213
    v_mfma_f32_32x32x16_bf16 v[48:63], v[204:207], a[44:47], v[48:63]
    ds_read_b64_tr_b16 v[202:203], v225 offset:39424
    s_lshl_b32 s84, s84, 12
    v_add_f32 v214, 1.0, v214
    v_add_f32 v215, 1.0, v215
    s_waitcnt lgkmcnt(4)
    v_mfma_f32_32x32x16_bf16 v[160:175], v[208:211], a[48:51], v[160:175]
    ds_read_b64_tr_b16 v[204:205], v224 offset:49152
    buffer_load_dwordx4 v242, s[36:39], s58 offen offset:1024 lds
    v_rcp_f32 v212, v212
    v_mfma_f32_32x32x16_bf16 v[176:191], v[208:211], a[52:55], v[176:191]
    ds_read_b64_tr_b16 v[206:207], v224 offset:49664
    s_lshl_b32 s85, s53, 10
    v_mov_b32 v236, -1
    v_rcp_f32 v213, v213
    v_mul_f32 v80, v80, v212
    v_mfma_f32_32x32x16_bf16 v[32:47], v[192:195], a[48:51], v[32:47]
    ds_read_b64_tr_b16 v[208:209], v225 offset:49152
    buffer_load_dwordx4 v242, s[36:39], s59 offen offset:2048 lds
    s_add_u32 s84, s84, s85
    v_rcp_f32 v214, v214
    v_mfma_f32_32x32x16_bf16 v[48:63], v[192:195], a[52:55], v[48:63]
    ds_read_b64_tr_b16 v[210:211], v225 offset:49664
    s_add_u32 s96, s84, 35201024
    v_rcp_f32 v215, v215
    v_mul_f32 v81, v81, v213
    s_waitcnt lgkmcnt(4)
    v_mfma_f32_32x32x16_bf16 v[160:175], v[196:199], a[56:59], v[160:175]
    ds_read_b64_tr_b16 v[192:193], v224 offset:51200
    buffer_load_dwordx4 v242, s[36:39], s60 offen offset:3072 lds
    v_mul_f32 v82, v82, v214
    v_mul_f32 v83, v83, v215
    v_cvt_pk_bf16_f32 v84, v80, v81
    v_mfma_f32_32x32x16_bf16 v[176:191], v[196:199], a[60:63], v[176:191]
    ds_read_b64_tr_b16 v[194:195], v224 offset:51712
    v_cvt_pk_bf16_f32 v85, v82, v83
    v_mul_f32 v216, s76, v88
    v_mul_f32 v217, s76, v89
    v_mul_f32 v218, s76, v90
    v_mul_f32 v219, s76, v91
    v_mfma_f32_32x32x16_bf16 v[32:47], v[200:203], a[56:59], v[32:47]
    ds_read_b64_tr_b16 v[196:197], v225 offset:51200
    v_exp_f32 v216, v216
    v_exp_f32 v217, v217
    v_mul_f32 v88, v88, v92
    v_mfma_f32_32x32x16_bf16 v[48:63], v[200:203], a[60:63], v[48:63]
    ds_read_b64_tr_b16 v[198:199], v225 offset:51712
    v_exp_f32 v218, v218
    v_exp_f32 v219, v219
    s_waitcnt lgkmcnt(4)
    v_mfma_f32_32x32x16_bf16 v[160:175], v[204:207], a[64:67], v[160:175]
    ds_read_b64_tr_b16 v[200:201], v224 offset:53248
    v_mov_b32 v237, -1
    v_mul_f32 v89, v89, v93
    v_mul_f32 v90, v90, v94
    v_mul_f32 v91, v91, v95
    v_add_f32 v216, 1.0, v216
    v_mfma_f32_32x32x16_bf16 v[176:191], v[204:207], a[68:71], v[176:191]
    ds_read_b64_tr_b16 v[202:203], v224 offset:53760
    v_add_f32 v217, 1.0, v217
    v_add_f32 v218, 1.0, v218
    v_add_f32 v219, 1.0, v219
    v_rcp_f32 v216, v216
    v_mfma_f32_32x32x16_bf16 v[32:47], v[208:211], a[64:67], v[32:47]
    ds_read_b64_tr_b16 v[204:205], v225 offset:53248
    v_rcp_f32 v217, v217
    v_rcp_f32 v218, v218
    v_mul_f32 v88, v88, v216
    v_mfma_f32_32x32x16_bf16 v[48:63], v[208:211], a[68:71], v[48:63]
    ds_read_b64_tr_b16 v[206:207], v225 offset:53760
    v_rcp_f32 v219, v219
    v_mul_f32 v89, v89, v217
    v_mul_f32 v90, v90, v218
    s_waitcnt lgkmcnt(4)
    v_mfma_f32_32x32x16_bf16 v[160:175], v[192:195], a[72:75], v[160:175]
    ds_read_b64_tr_b16 v[208:209], v224 offset:55296
    v_add_u32 v242, 589824, v242
    s_add_u32 m0, s55, 32768
    s_nop 0
    buffer_load_dwordx4 v242, s[36:39], 0 offen lds
    v_mul_f32 v91, v91, v219
    v_mfma_f32_32x32x16_bf16 v[176:191], v[192:195], a[76:79], v[176:191]
    ds_read_b64_tr_b16 v[210:211], v224 offset:55808
    v_cvt_pk_bf16_f32 v86, v88, v89
    v_cvt_pk_bf16_f32 v87, v90, v91
    v_mul_f32 v212, s76, v96
    v_mul_f32 v213, s76, v97
    v_mul_f32 v214, s76, v98
    v_mfma_f32_32x32x16_bf16 v[32:47], v[196:199], a[72:75], v[32:47]
    ds_read_b64_tr_b16 v[192:193], v225 offset:55296
    buffer_load_dwordx4 v242, s[36:39], s58 offen offset:1024 lds
    v_mul_f32 v215, s76, v99
    v_exp_f32 v212, v212
    v_mfma_f32_32x32x16_bf16 v[48:63], v[196:199], a[76:79], v[48:63]
    ds_read_b64_tr_b16 v[194:195], v225 offset:55808
    s_waitcnt vmcnt(6)
    s_barrier
    v_exp_f32 v213, v213
    s_waitcnt lgkmcnt(4)
    v_mfma_f32_32x32x16_bf16 v[160:175], v[200:203], a[80:83], v[160:175]
    ds_read_b64_tr_b16 v[196:197], v220 offset:16384
    s_lshl_b32 s83, s2, 2
    s_add_u32 s83, s83, 36249600
    v_mov_b32 v249, s77
    s_cmp_eq_u32 s52, 0
    s_cselect_b64 exec, 1, 0
    buffer_store_dword v249, off, s[40:43], s83 offset:2048 sc1
    s_mov_b64 exec, -1
    v_mfma_f32_32x32x16_bf16 v[176:191], v[200:203], a[84:87], v[176:191]
    ds_read_b64_tr_b16 v[198:199], v220 offset:16896
    buffer_store_dwordx4 v[84:87], v244, s[40:43], s69 offen offset:1024 sc1
    v_mfma_f32_32x32x16_bf16 v[32:47], v[204:207], a[80:83], v[32:47]
    ds_read_b64_tr_b16 v[200:201], v221 offset:16384
    v_mov_b32 v238, -1
    v_exp_f32 v214, v214
    v_exp_f32 v215, v215
    v_mfma_f32_32x32x16_bf16 v[48:63], v[204:207], a[84:87], v[48:63]
    ds_read_b64_tr_b16 v[202:203], v221 offset:16896
    buffer_load_dwordx4 v242, s[36:39], s59 offen offset:2048 lds
    v_mul_f32 v96, v96, v100
    v_mul_f32 v97, v97, v101
    s_waitcnt lgkmcnt(4)
    v_mfma_f32_32x32x16_bf16 v[160:175], v[208:211], a[88:91], v[160:175]
    ds_read_b64_tr_b16 v[204:205], v220 offset:18432
    v_mul_f32 v98, v98, v102
    v_mul_f32 v99, v99, v103
    v_add_f32 v212, 1.0, v212
    v_add_f32 v213, 1.0, v213
    v_add_f32 v214, 1.0, v214
    v_mfma_f32_32x32x16_bf16 v[176:191], v[208:211], a[92:95], v[176:191]
    ds_read_b64_tr_b16 v[206:207], v220 offset:18944
    buffer_load_dwordx4 v242, s[36:39], s60 offen offset:3072 lds
    v_add_f32 v215, 1.0, v215
    v_rcp_f32 v212, v212
    v_mfma_f32_32x32x16_bf16 v[32:47], v[192:195], a[88:91], v[32:47]
    ds_read_b64_tr_b16 v[208:209], v221 offset:18432
    v_rcp_f32 v213, v213
    v_rcp_f32 v214, v214
    v_mul_f32 v96, v96, v212
    v_mfma_f32_32x32x16_bf16 v[48:63], v[192:195], a[92:95], v[48:63]
    ds_read_b64_tr_b16 v[210:211], v221 offset:18944
    v_rcp_f32 v215, v215
    v_mul_f32 v97, v97, v213
    v_mul_f32 v98, v98, v214
    s_waitcnt lgkmcnt(4)
    v_mfma_f32_32x32x16_bf16 v[160:175], v[196:199], a[96:99], v[160:175]
    ds_read_b64_tr_b16 v[192:193], v220 offset:20480
    s_sub_u32 s82, 8, s54
    s_and_b32 s82, s82, 7
    s_add_u32 s82, s82, 1
    s_mul_i32 s82, s82, 589824
    v_add_u32 v242, s82, v242
    v_mfma_f32_32x32x16_bf16 v[176:191], v[196:199], a[100:103], v[176:191]
    ds_read_b64_tr_b16 v[194:195], v220 offset:20992
    s_add_u32 m0, s55, 49152
    s_nop 0
    buffer_load_dwordx4 v242, s[36:39], 0 offen lds
    v_mov_b32 v239, -1
    v_mul_f32 v99, v99, v215
    v_mfma_f32_32x32x16_bf16 v[32:47], v[200:203], a[96:99], v[32:47]
    ds_read_b64_tr_b16 v[196:197], v221 offset:20480
    v_cvt_pk_bf16_f32 v100, v96, v97
    v_cvt_pk_bf16_f32 v101, v98, v99
    v_mul_f32 v216, s76, v104
    v_mul_f32 v217, s76, v105
    v_mul_f32 v218, s76, v106
    v_mfma_f32_32x32x16_bf16 v[48:63], v[200:203], a[100:103], v[48:63]
    ds_read_b64_tr_b16 v[198:199], v221 offset:20992
    buffer_load_dwordx4 v242, s[36:39], s58 offen offset:1024 lds
    v_mul_f32 v219, s76, v107
    v_mul_f32 v104, v104, v108
    s_waitcnt lgkmcnt(4)
    v_mfma_f32_32x32x16_bf16 v[160:175], v[204:207], a[104:107], v[160:175]
    ds_read_b64_tr_b16 v[200:201], v220 offset:22528
    v_exp_f32 v216, v216
    v_exp_f32 v217, v217
    v_mul_f32 v105, v105, v109
    v_mfma_f32_32x32x16_bf16 v[176:191], v[204:207], a[108:111], v[176:191]
    ds_read_b64_tr_b16 v[202:203], v220 offset:23040
    buffer_load_dwordx4 v242, s[36:39], s59 offen offset:2048 lds
    v_exp_f32 v218, v218
    v_mul_f32 v106, v106, v110
    v_mfma_f32_32x32x16_bf16 v[32:47], v[208:211], a[104:107], v[32:47]
    ds_read_b64_tr_b16 v[204:205], v221 offset:22528
    v_exp_f32 v219, v219
    v_mul_f32 v107, v107, v111
    v_add_f32 v216, 1.0, v216
    v_add_f32 v217, 1.0, v217
    v_mfma_f32_32x32x16_bf16 v[48:63], v[208:211], a[108:111], v[48:63]
    ds_read_b64_tr_b16 v[206:207], v221 offset:23040
    buffer_load_dwordx4 v242, s[36:39], s60 offen offset:3072 lds
    v_add_f32 v218, 1.0, v218
    v_add_f32 v219, 1.0, v219
    s_waitcnt lgkmcnt(4)
    v_mfma_f32_32x32x16_bf16 v[160:175], v[192:195], a[112:115], v[160:175]
    ds_read_b64_tr_b16 v[208:209], v224
    v_rcp_f32 v216, v216
    v_rcp_f32 v217, v217
    v_mul_f32 v104, v104, v216
    v_mfma_f32_32x32x16_bf16 v[176:191], v[192:195], a[116:119], v[176:191]
    ds_read_b64_tr_b16 v[210:211], v224 offset:512
    s_lshl_b32 s81, s2, 2
    s_add_u32 s81, s81, s52
    s_lshl_b32 s81, s81, 11
    s_add_u32 s81, s81, 26542080
    buffer_store_dwordx4 v[236:239], v244, s[40:43], s81 offen sc1
    v_mfma_f32_32x32x16_bf16 v[32:47], v[196:199], a[112:115], v[32:47]
    ds_read_b64_tr_b16 v[192:193], v225
    v_rcp_f32 v218, v218
    v_rcp_f32 v219, v219
    v_mul_f32 v105, v105, v217
    v_mfma_f32_32x32x16_bf16 v[48:63], v[196:199], a[116:119], v[48:63]
    ds_read_b64_tr_b16 v[194:195], v225 offset:512
    v_mul_f32 v106, v106, v218
    v_mul_f32 v107, v107, v219
    v_cvt_pk_bf16_f32 v102, v104, v105
    v_cvt_pk_bf16_f32 v103, v106, v107
    s_waitcnt lgkmcnt(4)
    v_mfma_f32_32x32x16_bf16 v[160:175], v[200:203], a[120:123], v[160:175]
    ds_read_b64_tr_b16 v[196:197], v224 offset:2048
    buffer_store_dwordx4 v[100:103], v244, s[40:43], s68 offen offset:2048 sc1
    v_mfma_f32_32x32x16_bf16 v[176:191], v[200:203], a[124:127], v[176:191]
    ds_read_b64_tr_b16 v[198:199], v224 offset:2560
    v_mul_f32 v212, s76, v112
    v_mul_f32 v213, s76, v113
    v_mul_f32 v214, s76, v114
    v_mul_f32 v215, s76, v115
    v_mul_f32 v112, v112, v116
    v_mfma_f32_32x32x16_bf16 v[32:47], v[204:207], a[120:123], v[32:47]
    ds_read_b64_tr_b16 v[200:201], v225 offset:2048
    v_exp_f32 v212, v212
    v_exp_f32 v213, v213
    v_mul_f32 v113, v113, v117
    v_mfma_f32_32x32x16_bf16 v[48:63], v[204:207], a[124:127], v[48:63]
    ds_read_b64_tr_b16 v[202:203], v225 offset:2560
    v_exp_f32 v214, v214
    v_exp_f32 v215, v215
    s_waitcnt lgkmcnt(4)
    v_mfma_f32_32x32x16_bf16 v[160:175], v[208:211], a[128:131], v[160:175]
    ds_read_b64_tr_b16 v[204:205], v224 offset:4096
    v_mul_f32 v114, v114, v118
    v_mul_f32 v115, v115, v119
    v_add_f32 v212, 1.0, v212
    v_add_f32 v213, 1.0, v213
    v_add_f32 v214, 1.0, v214
    v_mfma_f32_32x32x16_bf16 v[176:191], v[208:211], a[132:135], v[176:191]
    ds_read_b64_tr_b16 v[206:207], v224 offset:4608
    v_add_f32 v215, 1.0, v215
    v_rcp_f32 v212, v212
    v_rcp_f32 v213, v213
    v_mfma_f32_32x32x16_bf16 v[32:47], v[192:195], a[128:131], v[32:47]
    ds_read_b64_tr_b16 v[208:209], v225 offset:4096
    v_rcp_f32 v214, v214
    v_rcp_f32 v215, v215
    v_mul_f32 v112, v112, v212
    v_mfma_f32_32x32x16_bf16 v[48:63], v[192:195], a[132:135], v[48:63]
    ds_read_b64_tr_b16 v[210:211], v225 offset:4608
    v_mul_f32 v113, v113, v213
    v_mul_f32 v114, v114, v214
    v_mul_f32 v115, v115, v215
    v_cvt_pk_bf16_f32 v116, v112, v113
    s_waitcnt lgkmcnt(4)
    v_mfma_f32_32x32x16_bf16 v[160:175], v[196:199], a[136:139], v[160:175]
    ds_read_b64_tr_b16 v[192:193], v224 offset:6144
    v_cvt_pk_bf16_f32 v117, v114, v115
    v_mul_f32 v216, s76, v120
    v_mul_f32 v217, s76, v121
    v_mul_f32 v218, s76, v122
    v_mul_f32 v219, s76, v123
    v_mfma_f32_32x32x16_bf16 v[176:191], v[196:199], a[140:143], v[176:191]
    ds_read_b64_tr_b16 v[194:195], v224 offset:6656
    v_exp_f32 v216, v216
    v_exp_f32 v217, v217
    v_mul_f32 v120, v120, v124
    v_mfma_f32_32x32x16_bf16 v[32:47], v[200:203], a[136:139], v[32:47]
    ds_read_b64_tr_b16 v[196:197], v225 offset:6144
    v_exp_f32 v218, v218
    v_exp_f32 v219, v219
    v_mul_f32 v121, v121, v125
    v_mfma_f32_32x32x16_bf16 v[48:63], v[200:203], a[140:143], v[48:63]
    ds_read_b64_tr_b16 v[198:199], v225 offset:6656
    s_waitcnt vmcnt(12)
    s_barrier
    v_mul_f32 v122, v122, v126
    v_mul_f32 v123, v123, v127
    s_waitcnt lgkmcnt(4)
    v_mfma_f32_32x32x16_bf16 v[160:175], v[204:207], a[144:147], v[160:175]
    ds_read_b64_tr_b16 v[200:201], v224 offset:16384
    v_add_f32 v216, 1.0, v216
    v_add_f32 v217, 1.0, v217
    v_add_f32 v218, 1.0, v218
    v_add_f32 v219, 1.0, v219
    s_lshr_b32 s83, s52, 1
    v_mfma_f32_32x32x16_bf16 v[176:191], v[204:207], a[148:151], v[176:191]
    ds_read_b64_tr_b16 v[202:203], v224 offset:16896
    v_rcp_f32 v216, v216
    v_rcp_f32 v217, v217
    v_mul_f32 v120, v120, v216
    v_mfma_f32_32x32x16_bf16 v[32:47], v[208:211], a[144:147], v[32:47]
    ds_read_b64_tr_b16 v[204:205], v225 offset:16384
    v_rcp_f32 v218, v218
    v_rcp_f32 v219, v219
    v_mul_f32 v121, v121, v217
    v_mfma_f32_32x32x16_bf16 v[48:63], v[208:211], a[148:151], v[48:63]
    ds_read_b64_tr_b16 v[206:207], v225 offset:16896
    v_mul_f32 v122, v122, v218
    v_mul_f32 v123, v123, v219
    v_cvt_pk_bf16_f32 v118, v120, v121
    v_cvt_pk_bf16_f32 v119, v122, v123
    s_waitcnt lgkmcnt(4)
    v_mfma_f32_32x32x16_bf16 v[160:175], v[192:195], a[152:155], v[160:175]
    ds_read_b64_tr_b16 v[208:209], v224 offset:18432
    buffer_store_dwordx4 v[116:119], v244, s[40:43], s69 offen offset:2048 sc1
    v_mfma_f32_32x32x16_bf16 v[176:191], v[192:195], a[156:159], v[176:191]
    ds_read_b64_tr_b16 v[210:211], v224 offset:18944
    s_mul_i32 s97, s83, 12928
    s_add_u32 s97, s97, 98304
    v_mul_f32 v212, s76, v128
    v_mul_f32 v213, s76, v129
    v_mul_f32 v214, s76, v130
    v_mfma_f32_32x32x16_bf16 v[32:47], v[196:199], a[152:155], v[32:47]
    ds_read_b64_tr_b16 v[192:193], v225 offset:18432
    v_mul_f32 v215, s76, v131
    v_exp_f32 v212, v212
    v_exp_f32 v213, v213
    v_mfma_f32_32x32x16_bf16 v[48:63], v[196:199], a[156:159], v[48:63]
    ds_read_b64_tr_b16 v[194:195], v225 offset:18944
    v_exp_f32 v214, v214
    v_exp_f32 v215, v215
    s_waitcnt lgkmcnt(4)
    v_mfma_f32_32x32x16_bf16 v[160:175], v[200:203], a[160:163], v[160:175]
    ds_read_b64_tr_b16 v[196:197], v224 offset:20480
    s_lshl_b32 s84, s2, 1
    v_mul_f32 v128, v128, v132
    v_mul_f32 v129, v129, v133
    v_mul_f32 v130, v130, v134
    v_mul_f32 v131, v131, v135
    v_mfma_f32_32x32x16_bf16 v[176:191], v[200:203], a[164:167], v[176:191]
    ds_read_b64_tr_b16 v[198:199], v224 offset:20992
    v_add_f32 v212, 1.0, v212
    v_add_f32 v213, 1.0, v213
    v_add_f32 v214, 1.0, v214
    v_add_f32 v215, 1.0, v215
    v_mfma_f32_32x32x16_bf16 v[32:47], v[204:207], a[160:163], v[32:47]
    ds_read_b64_tr_b16 v[200:201], v225 offset:20480
    v_rcp_f32 v212, v212
    v_rcp_f32 v213, v213
    v_mul_f32 v128, v128, v212
    v_mfma_f32_32x32x16_bf16 v[48:63], v[204:207], a[164:167], v[48:63]
    ds_read_b64_tr_b16 v[202:203], v225 offset:20992
    v_rcp_f32 v214, v214
    v_rcp_f32 v215, v215
    s_waitcnt lgkmcnt(4)
    v_mfma_f32_32x32x16_bf16 v[160:175], v[208:211], a[168:171], v[160:175]
    ds_read_b64_tr_b16 v[204:205], v224 offset:22528
KF_PG4:
    s_cbranch_execz KF_WMID
    v_mul_f32 v129, v129, v213
    v_mul_f32 v130, v130, v214
    v_mul_f32 v131, v131, v215
    v_cvt_pk_bf16_f32 v132, v128, v129
    v_cvt_pk_bf16_f32 v133, v130, v131
    v_mfma_f32_32x32x16_bf16 v[176:191], v[208:211], a[172:175], v[176:191]
    ds_read_b64_tr_b16 v[206:207], v224 offset:23040
    buffer_store_dwordx4 v[236:239], v244, s[40:43], s81 offen offset:1024 sc1
    v_mfma_f32_32x32x16_bf16 v[32:47], v[192:195], a[168:171], v[32:47]
    ds_read_b64_tr_b16 v[208:209], v225 offset:22528
    s_mov_b64 s[48:49], s[12:13]
    s_mov_b32 s50, 2359296
    v_lshlrev_b32 v251, 7, v248
    v_mul_f32 v216, s76, v136
    v_mul_f32 v217, s76, v137
    v_mfma_f32_32x32x16_bf16 v[48:63], v[192:195], a[172:175], v[48:63]
    ds_read_b64_tr_b16 v[210:211], v225 offset:23040
    s_waitcnt vmcnt(4)
    s_barrier
    v_mul_f32 v218, s76, v138
    v_mul_f32 v219, s76, v139
    s_waitcnt lgkmcnt(4)
    v_mfma_f32_32x32x16_bf16 v[160:175], v[196:199], a[176:179], v[160:175]
    ds_read_b64_tr_b16 v[192:193], v220 offset:32768
    s_lshl_b32 s82, s2, 2
    s_add_u32 s82, s82, s52
    s_lshl_b32 s82, s82, 11
    s_mov_b64 exec, 0xffff
    buffer_load_dword v250, v251, s[48:51], s82 offen
    s_mov_b64 exec, -1
    v_mfma_f32_32x32x16_bf16 v[176:191], v[196:199], a[180:183], v[176:191]
    ds_read_b64_tr_b16 v[194:195], v220 offset:33280
    s_lshr_b32 s82, s82, 1
    s_add_u32 s82, s82, 2097152
    s_cmp_lt_u32 s2, 64
    s_cselect_b64 exec, 0xff, 0
    buffer_load_dword v250, v251, s[48:51], s82 offen
    s_mov_b64 exec, -1
    v_mfma_f32_32x32x16_bf16 v[32:47], v[200:203], a[176:179], v[32:47]
    ds_read_b64_tr_b16 v[196:197], v220 offset:34816
    v_exp_f32 v216, v216
    v_exp_f32 v217, v217
    v_mul_f32 v136, v136, v140
    v_mfma_f32_32x32x16_bf16 v[48:63], v[200:203], a[180:183], v[48:63]
    ds_read_b64_tr_b16 v[198:199], v220 offset:35328
    s_add_u32 s84, s84, s83
    v_exp_f32 v218, v218
    v_mul_f32 v137, v137, v141
    s_waitcnt lgkmcnt(4)
    v_mfma_f32_32x32x16_bf16 v[160:175], v[204:207], a[184:187], v[160:175]
    ds_read_b64_tr_b16 v[200:201], v220 offset:36864
    v_exp_f32 v219, v219
    v_mul_f32 v138, v138, v142
    v_mul_f32 v139, v139, v143
    v_add_f32 v216, 1.0, v216
    v_mfma_f32_32x32x16_bf16 v[176:191], v[204:207], a[188:191], v[176:191]
    ds_read_b64_tr_b16 v[202:203], v220 offset:37376
    v_add_f32 v217, 1.0, v217
    v_add_f32 v218, 1.0, v218
    v_add_f32 v219, 1.0, v219
    v_rcp_f32 v216, v216
    v_mfma_f32_32x32x16_bf16 v[32:47], v[208:211], a[184:187], v[32:47]
    ds_read_b64_tr_b16 v[204:205], v220 offset:38912
    v_rcp_f32 v217, v217
    v_rcp_f32 v218, v218
    v_mul_f32 v136, v136, v216
    v_mfma_f32_32x32x16_bf16 v[48:63], v[208:211], a[188:191], v[48:63]
    ds_read_b64_tr_b16 v[206:207], v220 offset:39424
    v_rcp_f32 v219, v219
    v_mul_f32 v137, v137, v217
    v_mul_f32 v138, v138, v218
    s_waitcnt lgkmcnt(4)
    v_mfma_f32_32x32x16_bf16 v[160:175], v[192:195], a[192:195], v[160:175]
    ds_read_b64_tr_b16 v[208:209], v220 offset:49152
    v_mul_f32 v139, v139, v219
    v_cvt_pk_bf16_f32 v134, v136, v137
    v_cvt_pk_bf16_f32 v135, v138, v139
    v_mul_f32 v212, s76, v144
    v_mul_f32 v213, s76, v145
    v_mfma_f32_32x32x16_bf16 v[176:191], v[192:195], a[196:199], v[176:191]
    ds_read_b64_tr_b16 v[210:211], v220 offset:49664
    buffer_store_dwordx4 v[132:135], v244, s[40:43], s68 offen offset:3072 sc1
    v_mfma_f32_32x32x16_bf16 v[160:175], v[196:199], a[200:203], v[160:175]
    ds_read_b64_tr_b16 v[192:193], v220 offset:51200
    v_mul_f32 v214, s76, v146
    v_mul_f32 v215, s76, v147
    v_exp_f32 v212, v212
    v_mul_f32 v144, v144, v148
    v_mfma_f32_32x32x16_bf16 v[176:191], v[196:199], a[204:207], v[176:191]
    ds_read_b64_tr_b16 v[194:195], v220 offset:51712
    v_exp_f32 v213, v213
    v_exp_f32 v214, v214
    s_waitcnt lgkmcnt(4)
    v_mfma_f32_32x32x16_bf16 v[160:175], v[200:203], a[208:211], v[160:175]
    ds_read_b64_tr_b16 v[196:197], v220 offset:53248
    v_exp_f32 v215, v215
    v_mul_f32 v145, v145, v149
    v_mul_f32 v146, v146, v150
    v_mul_f32 v147, v147, v151
    v_mfma_f32_32x32x16_bf16 v[176:191], v[200:203], a[212:215], v[176:191]
    ds_read_b64_tr_b16 v[198:199], v220 offset:53760
    s_and_b32 s85, s52, 1
    v_add_f32 v212, 1.0, v212
    v_add_f32 v213, 1.0, v213
    v_add_f32 v214, 1.0, v214
    v_add_f32 v215, 1.0, v215
    v_mfma_f32_32x32x16_bf16 v[160:175], v[204:207], a[216:219], v[160:175]
    ds_read_b64_tr_b16 v[200:201], v220 offset:55296
    v_rcp_f32 v212, v212
    v_rcp_f32 v213, v213
    v_mul_f32 v144, v144, v212
    v_mfma_f32_32x32x16_bf16 v[176:191], v[204:207], a[220:223], v[176:191]
    ds_read_b64_tr_b16 v[202:203], v220 offset:55808
    v_rcp_f32 v214, v214
    v_rcp_f32 v215, v215
    s_waitcnt lgkmcnt(4)
    v_mfma_f32_32x32x16_bf16 v[160:175], v[208:211], a[224:227], v[160:175]
    ds_read_b64_tr_b16 v[204:205], v221 offset:32768
    v_mul_f32 v145, v145, v213
    v_mul_f32 v146, v146, v214
    v_mul_f32 v147, v147, v215
    v_cvt_pk_bf16_f32 v148, v144, v145
    v_cvt_pk_bf16_f32 v149, v146, v147
    v_mfma_f32_32x32x16_bf16 v[176:191], v[208:211], a[228:231], v[176:191]
    ds_read_b64_tr_b16 v[206:207], v221 offset:33280
    v_mul_f32 v216, s76, v152
    v_mul_f32 v217, s76, v153
    v_mul_f32 v218, s76, v154
    v_mul_f32 v219, s76, v155
    v_mul_f32 v152, v152, v156
    v_mfma_f32_32x32x16_bf16 v[160:175], v[192:195], a[232:235], v[160:175]
    ds_read_b64_tr_b16 v[208:209], v221 offset:34816
    v_exp_f32 v216, v216
    v_exp_f32 v217, v217
    v_mul_f32 v153, v153, v157
    v_mfma_f32_32x32x16_bf16 v[176:191], v[192:195], a[236:239], v[176:191]
    ds_read_b64_tr_b16 v[210:211], v221 offset:35328
    v_exp_f32 v218, v218
    v_exp_f32 v219, v219
    s_waitcnt lgkmcnt(4)
    v_mfma_f32_32x32x16_bf16 v[160:175], v[196:199], a[240:243], v[160:175]
    ds_read_b64_tr_b16 v[192:193], v221 offset:36864
    v_mul_f32 v154, v154, v158
    v_mul_f32 v155, v155, v159
    v_add_f32 v216, 1.0, v216
    v_add_f32 v217, 1.0, v217
    v_add_f32 v218, 1.0, v218
    v_mfma_f32_32x32x16_bf16 v[176:191], v[196:199], a[244:247], v[176:191]
    ds_read_b64_tr_b16 v[194:195], v221 offset:37376
    v_add_f32 v219, 1.0, v219
    v_rcp_f32 v216, v216
    v_rcp_f32 v217, v217
    v_mfma_f32_32x32x16_bf16 v[160:175], v[200:203], a[248:251], v[160:175]
    ds_read_b64_tr_b16 v[196:197], v221 offset:38912
    v_rcp_f32 v218, v218
    v_rcp_f32 v219, v219
    v_mul_f32 v152, v152, v216
    v_mfma_f32_32x32x16_bf16 v[176:191], v[200:203], a[252:255], v[176:191]
    ds_read_b64_tr_b16 v[198:199], v221 offset:39424
    v_mul_f32 v153, v153, v217
    v_mul_f32 v154, v154, v218
    v_mul_f32 v155, v155, v219
    v_cvt_pk_bf16_f32 v150, v152, v153
    s_waitcnt lgkmcnt(4)
    v_mfma_f32_32x32x16_bf16 v[32:47], v[204:207], a[192:195], v[32:47]
    ds_read_b64_tr_b16 v[200:201], v221 offset:49152
    s_lshl_b32 s78, s84, 12
    v_cvt_pk_bf16_f32 v151, v154, v155
    v_mfma_f32_32x32x16_bf16 v[48:63], v[204:207], a[196:199], v[48:63]
    ds_read_b64_tr_b16 v[202:203], v221 offset:49664
    buffer_store_dwordx4 v[148:151], v244, s[40:43], s69 offen offset:3072 sc1
    v_mfma_f32_32x32x16_bf16 v[32:47], v[208:211], a[200:203], v[32:47]
    ds_read_b64_tr_b16 v[204:205], v221 offset:51200
    v_mfma_f32_32x32x16_bf16 v[48:63], v[208:211], a[204:207], v[48:63]
    ds_read_b64_tr_b16 v[206:207], v221 offset:51712
    v_mul_f32 v212, s76, v160
    v_mul_f32 v213, s76, v161
    v_mul_f32 v214, s76, v162
    v_mul_f32 v215, s76, v163
    s_waitcnt lgkmcnt(4)
    v_mfma_f32_32x32x16_bf16 v[32:47], v[192:195], a[208:211], v[32:47]
    ds_read_b64_tr_b16 v[208:209], v221 offset:53248
    buffer_store_dwordx4 v[236:239], v244, s[40:43], s93 offen sc1
    v_mfma_f32_32x32x16_bf16 v[48:63], v[192:195], a[212:215], v[48:63]
    ds_read_b64_tr_b16 v[210:211], v221 offset:53760
    v_exp_f32 v212, v212
    v_exp_f32 v213, v213
    v_mul_f32 v160, v160, v164
    v_mfma_f32_32x32x16_bf16 v[32:47], v[196:199], a[216:219], v[32:47]
    ds_read_b64_tr_b16 v[192:193], v221 offset:55296
    v_exp_f32 v214, v214
    v_exp_f32 v215, v215
    v_mul_f32 v161, v161, v165
    v_mfma_f32_32x32x16_bf16 v[48:63], v[196:199], a[220:223], v[48:63]
    ds_read_b64_tr_b16 v[194:195], v221 offset:55808
    v_mul_f32 v162, v162, v166
    v_mul_f32 v163, v163, v167
    v_add_f32 v212, 1.0, v212
    v_add_f32 v213, 1.0, v213
    s_waitcnt lgkmcnt(4)
    v_mfma_f32_32x32x16_bf16 v[32:47], v[200:203], a[224:227], v[32:47]
    ds_read_b64_tr_b16 v[196:197], v230
    v_add_f32 v214, 1.0, v214
    v_add_f32 v215, 1.0, v215
    v_rcp_f32 v212, v212
    v_mfma_f32_32x32x16_bf16 v[48:63], v[200:203], a[228:231], v[48:63]
    ds_read_b64_tr_b16 v[198:199], v230 offset:512
    v_rcp_f32 v213, v213
    v_rcp_f32 v214, v214
    v_mul_f32 v160, v160, v212
    v_mfma_f32_32x32x16_bf16 v[32:47], v[204:207], a[232:235], v[32:47]
    ds_read_b64_tr_b16 v[200:201], v230 offset:2048
    s_lshl_b32 s79, s85, 11
    v_rcp_f32 v215, v215
    v_mul_f32 v161, v161, v213
    v_mul_f32 v162, v162, v214
    v_mfma_f32_32x32x16_bf16 v[48:63], v[204:207], a[236:239], v[48:63]
    ds_read_b64_tr_b16 v[202:203], v230 offset:2560
    v_mul_f32 v163, v163, v215
    v_cvt_pk_bf16_f32 v164, v160, v161
    v_cvt_pk_bf16_f32 v165, v162, v163
    v_mul_f32 v216, s76, v168
    s_waitcnt lgkmcnt(4)
    v_mfma_f32_32x32x16_bf16 v[32:47], v[208:211], a[240:243], v[32:47]
    ds_read_b64_tr_b16 v[204:205], v230 offset:4096
    v_mul_f32 v217, s76, v169
    v_mul_f32 v218, s76, v170
    v_mul_f32 v219, s76, v171
    v_exp_f32 v216, v216
    v_mfma_f32_32x32x16_bf16 v[48:63], v[208:211], a[244:247], v[48:63]
    ds_read_b64_tr_b16 v[206:207], v230 offset:4608
    v_exp_f32 v217, v217
    v_exp_f32 v218, v218
    v_mfma_f32_32x32x16_bf16 v[32:47], v[192:195], a[248:251], v[32:47]
    ds_read_b64_tr_b16 v[208:209], v230 offset:6144
    v_exp_f32 v219, v219
    v_mul_f32 v168, v168, v172
    v_mul_f32 v169, v169, v173
    v_mul_f32 v170, v170, v174
    v_mfma_f32_32x32x16_bf16 v[48:63], v[192:195], a[252:255], v[48:63]
    ds_read_b64_tr_b16 v[210:211], v230 offset:6656
    v_mul_f32 v171, v171, v175
    v_add_f32 v216, 1.0, v216
    v_add_f32 v217, 1.0, v217
    v_add_f32 v218, 1.0, v218
    s_waitcnt lgkmcnt(4)
    v_mfma_f32_32x32x16_bf16 v[64:79], v[196:199], v[0:3], 0
    ds_read_b64_tr_b16 v[192:193], v230 offset:16384
    v_add_f32 v219, 1.0, v219
    v_rcp_f32 v216, v216
    v_rcp_f32 v217, v217
    v_mfma_f32_32x32x16_bf16 v[80:95], v[196:199], v[4:7], 0
    ds_read_b64_tr_b16 v[194:195], v230 offset:16896
    v_rcp_f32 v218, v218
    v_rcp_f32 v219, v219
    v_mfma_f32_32x32x16_bf16 v[64:79], v[200:203], v[8:11], v[64:79]
    ds_read_b64_tr_b16 v[196:197], v230 offset:18432
    v_mul_f32 v168, v168, v216
    v_mul_f32 v169, v169, v217
    v_mul_f32 v170, v170, v218
    v_mfma_f32_32x32x16_bf16 v[80:95], v[200:203], v[12:15], v[80:95]
    ds_read_b64_tr_b16 v[198:199], v230 offset:18944
    v_mul_f32 v171, v171, v219
    v_cvt_pk_bf16_f32 v166, v168, v169
    v_cvt_pk_bf16_f32 v167, v170, v171
    s_waitcnt lgkmcnt(4)
    v_mfma_f32_32x32x16_bf16 v[64:79], v[204:207], v[16:19], v[64:79]
    ds_read_b64_tr_b16 v[200:201], v230 offset:20480
    buffer_store_dwordx4 v[164:167], v244, s[40:43], s70 offen sc1
    v_mfma_f32_32x32x16_bf16 v[80:95], v[204:207], v[20:23], v[80:95]
    ds_read_b64_tr_b16 v[202:203], v230 offset:20992
    s_add_u32 s78, s78, s79
    v_mul_f32 v212, s76, v176
    v_mul_f32 v213, s76, v177
    v_mul_f32 v214, s76, v178
    v_mul_f32 v215, s76, v179
    v_mfma_f32_32x32x16_bf16 v[64:79], v[208:211], v[24:27], v[64:79]
    ds_read_b64_tr_b16 v[204:205], v230 offset:22528
    v_exp_f32 v212, v212
    v_exp_f32 v213, v213
    v_mfma_f32_32x32x16_bf16 v[80:95], v[208:211], v[28:31], v[80:95]
    ds_read_b64_tr_b16 v[206:207], v230 offset:23040
    v_exp_f32 v214, v214
    v_exp_f32 v215, v215
    s_waitcnt lgkmcnt(4)
    v_mfma_f32_32x32x16_bf16 v[64:79], v[192:195], a[0:3], v[64:79]
    ds_read_b64_tr_b16 v[208:209], v226 offset:32768
    v_mul_f32 v176, v176, v180
    v_mul_f32 v177, v177, v181
    v_mul_f32 v178, v178, v182
    v_mul_f32 v179, v179, v183
    v_add_f32 v212, 1.0, v212
    v_mfma_f32_32x32x16_bf16 v[80:95], v[192:195], a[4:7], v[80:95]
    ds_read_b64_tr_b16 v[210:211], v226 offset:33280
    v_add_f32 v213, 1.0, v213
    v_add_f32 v214, 1.0, v214
    v_add_f32 v215, 1.0, v215
    v_rcp_f32 v212, v212
    v_mfma_f32_32x32x16_bf16 v[64:79], v[196:199], a[8:11], v[64:79]
    ds_read_b64_tr_b16 v[192:193], v226 offset:34816
    v_rcp_f32 v213, v213
    v_rcp_f32 v214, v214
    v_mfma_f32_32x32x16_bf16 v[80:95], v[196:199], a[12:15], v[80:95]
    ds_read_b64_tr_b16 v[194:195], v226 offset:35328
    v_rcp_f32 v215, v215
    v_mul_f32 v176, v176, v212
    s_waitcnt lgkmcnt(4)
    v_mfma_f32_32x32x16_bf16 v[64:79], v[200:203], a[16:19], v[64:79]
    ds_read_b64_tr_b16 v[196:197], v226 offset:36864
    v_mul_f32 v177, v177, v213
    v_mul_f32 v178, v178, v214
    v_mul_f32 v179, v179, v215
    v_cvt_pk_bf16_f32 v180, v176, v177
    v_mfma_f32_32x32x16_bf16 v[80:95], v[200:203], a[20:23], v[80:95]
    ds_read_b64_tr_b16 v[198:199], v226 offset:37376
    v_cvt_pk_bf16_f32 v181, v178, v179
    v_mul_f32 v216, s76, v184
    v_mul_f32 v217, s76, v185
    v_mul_f32 v218, s76, v186
    v_mfma_f32_32x32x16_bf16 v[64:79], v[204:207], a[24:27], v[64:79]
    ds_read_b64_tr_b16 v[200:201], v226 offset:38912
    v_mul_f32 v219, s76, v187
    v_exp_f32 v216, v216
    v_exp_f32 v217, v217
    v_mfma_f32_32x32x16_bf16 v[80:95], v[204:207], a[28:31], v[80:95]
    ds_read_b64_tr_b16 v[202:203], v226 offset:39424
    s_add_u32 s100, s78, 26542080
    v_exp_f32 v218, v218
    s_waitcnt lgkmcnt(4)
    v_mfma_f32_32x32x16_bf16 v[64:79], v[208:211], a[32:35], v[64:79]
    ds_read_b64_tr_b16 v[204:205], v226 offset:49152
    buffer_store_dwordx4 v[236:239], v244, s[40:43], s93 offen offset:1024 sc1
    v_mfma_f32_32x32x16_bf16 v[80:95], v[208:211], a[36:39], v[80:95]
    ds_read_b64_tr_b16 v[206:207], v226 offset:49664
    v_exp_f32 v219, v219
    v_mul_f32 v184, v184, v188
    v_mul_f32 v185, v185, v189
    v_mul_f32 v186, v186, v190
    v_mfma_f32_32x32x16_bf16 v[64:79], v[192:195], a[40:43], v[64:79]
    ds_read_b64_tr_b16 v[208:209], v226 offset:51200
    v_mul_f32 v187, v187, v191
    v_add_f32 v216, 1.0, v216
    v_add_f32 v217, 1.0, v217
    v_add_f32 v218, 1.0, v218
    v_add_f32 v219, 1.0, v219
    v_mfma_f32_32x32x16_bf16 v[80:95], v[192:195], a[44:47], v[80:95]
    ds_read_b64_tr_b16 v[210:211], v226 offset:51712
    v_rcp_f32 v216, v216
    v_rcp_f32 v217, v217
    s_waitcnt lgkmcnt(4)
    v_mfma_f32_32x32x16_bf16 v[64:79], v[196:199], a[48:51], v[64:79]
    ds_read_b64_tr_b16 v[192:193], v226 offset:53248
    v_rcp_f32 v218, v218
    v_rcp_f32 v219, v219
    v_mul_f32 v184, v184, v216
    v_mfma_f32_32x32x16_bf16 v[80:95], v[196:199], a[52:55], v[80:95]
    ds_read_b64_tr_b16 v[194:195], v226 offset:53760
    v_mul_f32 v185, v185, v217
    v_mul_f32 v186, v186, v218
    v_mul_f32 v187, v187, v219
    v_cvt_pk_bf16_f32 v182, v184, v185
    v_cvt_pk_bf16_f32 v183, v186, v187
    v_mfma_f32_32x32x16_bf16 v[64:79], v[200:203], a[56:59], v[64:79]
    ds_read_b64_tr_b16 v[196:197], v226 offset:55296
    buffer_store_dwordx4 v[180:183], v244, s[40:43], s71 offen sc1
    v_mfma_f32_32x32x16_bf16 v[80:95], v[200:203], a[60:63], v[80:95]
    ds_read_b64_tr_b16 v[198:199], v226 offset:55808
    v_mul_f32 v212, s76, v32
    v_mul_f32 v213, s76, v33
    v_mul_f32 v214, s76, v34
    v_mul_f32 v215, s76, v35
    s_waitcnt lgkmcnt(4)
    v_mfma_f32_32x32x16_bf16 v[64:79], v[204:207], a[64:67], v[64:79]
    ds_read_b64_tr_b16 v[200:201], v222 offset:16384
    s_mov_b32 s58, 36249600
    buffer_load_dwordx4 v[252:255], v244, s[40:43], s58 offen sc1
    v_exp_f32 v212, v212
    v_mfma_f32_32x32x16_bf16 v[80:95], v[204:207], a[68:71], v[80:95]
    ds_read_b64_tr_b16 v[202:203], v222 offset:16896
    v_exp_f32 v213, v213
    v_exp_f32 v214, v214
    v_mfma_f32_32x32x16_bf16 v[64:79], v[208:211], a[72:75], v[64:79]
    ds_read_b64_tr_b16 v[204:205], v222 offset:18432
    s_lshl_b32 s83, s2, 2
    v_exp_f32 v215, v215
    v_mul_f32 v32, v32, v36
    v_mul_f32 v33, v33, v37
    v_mfma_f32_32x32x16_bf16 v[80:95], v[208:211], a[76:79], v[80:95]
    ds_read_b64_tr_b16 v[206:207], v222 offset:18944
    v_mul_f32 v34, v34, v38
    v_mul_f32 v35, v35, v39
    v_add_f32 v212, 1.0, v212
    v_add_f32 v213, 1.0, v213
    s_waitcnt lgkmcnt(4)
    v_mfma_f32_32x32x16_bf16 v[64:79], v[192:195], a[80:83], v[64:79]
    ds_read_b64_tr_b16 v[208:209], v222 offset:20480
    v_mov_b32 v246, 1
    v_add_f32 v214, 1.0, v214
    v_add_f32 v215, 1.0, v215
    v_rcp_f32 v212, v212
    v_mfma_f32_32x32x16_bf16 v[80:95], v[192:195], a[84:87], v[80:95]
    ds_read_b64_tr_b16 v[210:211], v222 offset:20992
    s_cmp_eq_u32 s52, 0
    s_cselect_b64 exec, 1, 0
    global_atomic_add v246, v244, v246, s[28:29] offset:64 sc0 sc1
    s_mov_b64 exec, -1
    v_mfma_f32_32x32x16_bf16 v[64:79], v[196:199], a[88:91], v[64:79]
    ds_read_b64_tr_b16 v[192:193], v222 offset:22528
    v_rcp_f32 v213, v213
    v_rcp_f32 v214, v214
    v_mul_f32 v32, v32, v212
    v_mfma_f32_32x32x16_bf16 v[80:95], v[196:199], a[92:95], v[80:95]
    ds_read_b64_tr_b16 v[194:195], v222 offset:23040
    v_rcp_f32 v215, v215
    v_mul_f32 v33, v33, v213
    v_mul_f32 v34, v34, v214
    s_waitcnt lgkmcnt(4)
    v_mfma_f32_32x32x16_bf16 v[64:79], v[200:203], a[96:99], v[64:79]
    ds_read_b64_tr_b16 v[196:197], v226
    v_mul_f32 v35, v35, v215
    v_cvt_pk_bf16_f32 v36, v32, v33
    v_cvt_pk_bf16_f32 v37, v34, v35
    v_mul_f32 v216, s76, v40
    v_mul_f32 v217, s76, v41
    v_mfma_f32_32x32x16_bf16 v[80:95], v[200:203], a[100:103], v[80:95]
    ds_read_b64_tr_b16 v[198:199], v226 offset:512
    v_mul_f32 v218, s76, v42
    v_mul_f32 v219, s76, v43
    v_exp_f32 v216, v216
    v_mfma_f32_32x32x16_bf16 v[64:79], v[204:207], a[104:107], v[64:79]
    ds_read_b64_tr_b16 v[200:201], v226 offset:2048
    v_exp_f32 v217, v217
    v_exp_f32 v218, v218
    v_mfma_f32_32x32x16_bf16 v[80:95], v[204:207], a[108:111], v[80:95]
    ds_read_b64_tr_b16 v[202:203], v226 offset:2560
    v_exp_f32 v219, v219
    v_mul_f32 v40, v40, v44
    v_mul_f32 v41, v41, v45
    s_waitcnt lgkmcnt(4)
    v_mfma_f32_32x32x16_bf16 v[64:79], v[208:211], a[112:115], v[64:79]
    ds_read_b64_tr_b16 v[204:205], v226 offset:4096
    s_load_dword s98, s[14:15], s83
    v_mul_f32 v42, v42, v46
    v_mul_f32 v43, v43, v47
    v_add_f32 v216, 1.0, v216
    v_add_f32 v217, 1.0, v217
    v_mfma_f32_32x32x16_bf16 v[80:95], v[208:211], a[116:119], v[80:95]
    ds_read_b64_tr_b16 v[206:207], v226 offset:4608
    v_add_f32 v218, 1.0, v218
    v_add_f32 v219, 1.0, v219
    v_rcp_f32 v216, v216
    v_mfma_f32_32x32x16_bf16 v[64:79], v[192:195], a[120:123], v[64:79]
    ds_read_b64_tr_b16 v[208:209], v226 offset:6144
    v_rcp_f32 v217, v217
    v_rcp_f32 v218, v218
    v_mfma_f32_32x32x16_bf16 v[80:95], v[192:195], a[124:127], v[80:95]
    ds_read_b64_tr_b16 v[210:211], v226 offset:6656
    v_rcp_f32 v219, v219
    v_mul_f32 v40, v40, v216
    s_waitcnt lgkmcnt(4)
    v_mfma_f32_32x32x16_bf16 v[64:79], v[196:199], a[128:131], v[64:79]
    ds_read_b64_tr_b16 v[192:193], v226 offset:16384
    v_mul_f32 v41, v41, v217
    v_mul_f32 v42, v42, v218
    v_mul_f32 v43, v43, v219
    v_mfma_f32_32x32x16_bf16 v[80:95], v[196:199], a[132:135], v[80:95]
    ds_read_b64_tr_b16 v[194:195], v226 offset:16896
    v_cvt_pk_bf16_f32 v38, v40, v41
    v_cvt_pk_bf16_f32 v39, v42, v43
    v_mfma_f32_32x32x16_bf16 v[64:79], v[200:203], a[136:139], v[64:79]
    ds_read_b64_tr_b16 v[196:197], v226 offset:18432
    buffer_store_dwordx4 v[36:39], v244, s[40:43], s70 offen offset:1024 sc1
    v_mfma_f32_32x32x16_bf16 v[80:95], v[200:203], a[140:143], v[80:95]
    ds_read_b64_tr_b16 v[198:199], v226 offset:18944
    v_mul_f32 v212, s76, v48
    v_mul_f32 v213, s76, v49
    v_mul_f32 v214, s76, v50
    v_mul_f32 v215, s76, v51
    s_waitcnt lgkmcnt(4)
    v_mfma_f32_32x32x16_bf16 v[64:79], v[204:207], a[144:147], v[64:79]
    ds_read_b64_tr_b16 v[200:201], v226 offset:20480
    v_exp_f32 v212, v212
    v_exp_f32 v213, v213
    v_mfma_f32_32x32x16_bf16 v[80:95], v[204:207], a[148:151], v[80:95]
    ds_read_b64_tr_b16 v[202:203], v226 offset:20992
    v_exp_f32 v214, v214
    v_exp_f32 v215, v215
    v_mfma_f32_32x32x16_bf16 v[64:79], v[208:211], a[152:155], v[64:79]
    ds_read_b64_tr_b16 v[204:205], v226 offset:22528
    buffer_store_dwordx4 v[236:239], v244, s[40:43], s94 offen sc1
    v_mfma_f32_32x32x16_bf16 v[80:95], v[208:211], a[156:159], v[80:95]
    ds_read_b64_tr_b16 v[206:207], v226 offset:23040
    s_lshl_b32 s80, s85, 8
    v_mul_f32 v48, v48, v52
    v_mul_f32 v49, v49, v53
    v_mul_f32 v50, v50, v54
    s_waitcnt lgkmcnt(4)
    v_mfma_f32_32x32x16_bf16 v[64:79], v[192:195], a[160:163], v[64:79]
    ds_read_b64_tr_b16 v[208:209], v222 offset:32768
    v_mul_f32 v51, v51, v55
    v_add_f32 v212, 1.0, v212
    v_add_f32 v213, 1.0, v213
    v_add_f32 v214, 1.0, v214
    v_add_f32 v215, 1.0, v215
    v_mfma_f32_32x32x16_bf16 v[80:95], v[192:195], a[164:167], v[80:95]
    ds_read_b64_tr_b16 v[210:211], v222 offset:33280
    v_rcp_f32 v212, v212
    v_rcp_f32 v213, v213
    v_mfma_f32_32x32x16_bf16 v[64:79], v[196:199], a[168:171], v[64:79]
    ds_read_b64_tr_b16 v[192:193], v222 offset:34816
    v_rcp_f32 v214, v214
    v_rcp_f32 v215, v215
    v_mul_f32 v48, v48, v212
    v_mfma_f32_32x32x16_bf16 v[80:95], v[196:199], a[172:175], v[80:95]
    ds_read_b64_tr_b16 v[194:195], v222 offset:35328
    v_mul_f32 v49, v49, v213
    v_mul_f32 v50, v50, v214
    v_mul_f32 v51, v51, v215
    v_cvt_pk_bf16_f32 v52, v48, v49
    s_waitcnt lgkmcnt(4)
    v_mfma_f32_32x32x16_bf16 v[64:79], v[200:203], a[176:179], v[64:79]
    ds_read_b64_tr_b16 v[196:197], v222 offset:36864
    v_cvt_pk_bf16_f32 v53, v50, v51
    v_mul_f32 v216, s76, v56
    v_mul_f32 v217, s76, v57
    v_mul_f32 v218, s76, v58
    v_mfma_f32_32x32x16_bf16 v[80:95], v[200:203], a[180:183], v[80:95]
    ds_read_b64_tr_b16 v[198:199], v222 offset:37376
    v_mul_f32 v219, s76, v59
    v_exp_f32 v216, v216
    v_exp_f32 v217, v217
    v_mfma_f32_32x32x16_bf16 v[64:79], v[204:207], a[184:187], v[64:79]
    ds_read_b64_tr_b16 v[200:201], v222 offset:38912
    v_exp_f32 v218, v218
    v_mfma_f32_32x32x16_bf16 v[80:95], v[204:207], a[188:191], v[80:95]
    ds_read_b64_tr_b16 v[202:203], v222 offset:39424
    v_exp_f32 v219, v219
    v_mul_f32 v56, v56, v60
    v_mul_f32 v57, v57, v61
    s_waitcnt lgkmcnt(4)
    v_mfma_f32_32x32x16_bf16 v[64:79], v[208:211], a[192:195], v[64:79]
    ds_read_b64_tr_b16 v[204:205], v222 offset:49152
    v_mul_f32 v58, v58, v62
    v_mul_f32 v59, v59, v63
    v_add_f32 v216, 1.0, v216
    v_add_f32 v217, 1.0, v217
    v_mfma_f32_32x32x16_bf16 v[80:95], v[208:211], a[196:199], v[80:95]
    ds_read_b64_tr_b16 v[206:207], v222 offset:49664
    s_add_u32 s80, s80, s97
    v_add_f32 v218, 1.0, v218
    v_add_f32 v219, 1.0, v219
    v_rcp_f32 v216, v216
    v_mfma_f32_32x32x16_bf16 v[64:79], v[192:195], a[200:203], v[64:79]
    ds_read_b64_tr_b16 v[208:209], v222 offset:51200
    v_rcp_f32 v217, v217
    v_rcp_f32 v218, v218
    v_mfma_f32_32x32x16_bf16 v[80:95], v[192:195], a[204:207], v[80:95]
    ds_read_b64_tr_b16 v[210:211], v222 offset:51712
    v_rcp_f32 v219, v219
    v_mul_f32 v56, v56, v216
    s_waitcnt lgkmcnt(4)
    v_mfma_f32_32x32x16_bf16 v[64:79], v[196:199], a[208:211], v[64:79]
    ds_read_b64_tr_b16 v[192:193], v222 offset:53248
    v_mul_f32 v57, v57, v217
    v_mul_f32 v58, v58, v218
    v_mul_f32 v59, v59, v219
    v_mfma_f32_32x32x16_bf16 v[80:95], v[196:199], a[212:215], v[80:95]
    ds_read_b64_tr_b16 v[194:195], v222 offset:53760
    v_cvt_pk_bf16_f32 v54, v56, v57
    v_cvt_pk_bf16_f32 v55, v58, v59
    v_mfma_f32_32x32x16_bf16 v[64:79], v[200:203], a[216:219], v[64:79]
    ds_read_b64_tr_b16 v[196:197], v222 offset:55296
    buffer_store_dwordx4 v[52:55], v244, s[40:43], s71 offen offset:1024 sc1
    v_mfma_f32_32x32x16_bf16 v[80:95], v[200:203], a[220:223], v[80:95]
    ds_read_b64_tr_b16 v[198:199], v222 offset:55808
    s_waitcnt lgkmcnt(4)
    v_mfma_f32_32x32x16_bf16 v[64:79], v[204:207], a[224:227], v[64:79]
    ds_read_b64_tr_b16 v[200:201], v231
    v_mfma_f32_32x32x16_bf16 v[80:95], v[204:207], a[228:231], v[80:95]
    ds_read_b64_tr_b16 v[202:203], v231 offset:512
    v_mfma_f32_32x32x16_bf16 v[64:79], v[208:211], a[232:235], v[64:79]
    ds_read_b64_tr_b16 v[204:205], v231 offset:2048
    v_mfma_f32_32x32x16_bf16 v[80:95], v[208:211], a[236:239], v[80:95]
    ds_read_b64_tr_b16 v[206:207], v231 offset:2560
    s_waitcnt lgkmcnt(4)
    v_mfma_f32_32x32x16_bf16 v[64:79], v[192:195], a[240:243], v[64:79]
    ds_read_b64_tr_b16 v[208:209], v231 offset:4096
    s_waitcnt vmcnt(4)
    v_cmp_ne_u32 vcc, s77, v252
    v_cmp_ne_u32 s[86:87], s77, v253
    s_nop 0
    s_or_b64 vcc, vcc, s[86:87]
    v_cmp_ne_u32 s[86:87], s77, v254
    s_nop 0
    s_or_b64 vcc, vcc, s[86:87]
    v_cmp_ne_u32 s[86:87], s77, v255
    s_nop 0
    s_or_b64 vcc, vcc, s[86:87]
    s_cbranch_vccnz SLOW_J1
BACK_J1:
    v_mfma_f32_32x32x16_bf16 v[80:95], v[192:195], a[244:247], v[80:95]
    ds_read_b64_tr_b16 v[210:211], v231 offset:4608
    v_add_u32 v243, s16, v244
    s_add_u32 m0, s56, 0
    s_nop 0
    buffer_load_dwordx4 v243, s[40:43], 0 offen sc1 lds
    v_add_u32 v243, 4096, v243
    v_mfma_f32_32x32x16_bf16 v[64:79], v[196:199], a[248:251], v[64:79]
    ds_read_b64_tr_b16 v[192:193], v231 offset:6144
    s_add_u32 m0, s56, 4096
    v_mfma_f32_32x32x16_bf16 v[80:95], v[196:199], a[252:255], v[80:95]
    ds_read_b64_tr_b16 v[194:195], v231 offset:6656
    buffer_load_dwordx4 v243, s[40:43], 0 offen sc1 lds
    s_waitcnt lgkmcnt(4)
    v_mfma_f32_32x32x16_bf16 v[96:111], v[200:203], v[0:3], 0
    ds_read_b64_tr_b16 v[196:197], v231 offset:16384
    s_cmp_eq_u32 s54, 6
    s_mov_b32 s82, 4096
    s_cselect_b32 s82, 0xffff9000, s82
    v_add_u32 v243, s82, v243
    s_add_u32 m0, s56, 8192
    v_mfma_f32_32x32x16_bf16 v[112:127], v[200:203], v[4:7], 0
    ds_read_b64_tr_b16 v[198:199], v231 offset:16896
    buffer_load_dwordx4 v243, s[40:43], 0 offen sc1 lds
    v_add_u32 v243, 4096, v243
    s_add_u32 m0, s56, 12288
    v_mfma_f32_32x32x16_bf16 v[96:111], v[204:207], v[8:11], v[96:111]
    ds_read_b64_tr_b16 v[200:201], v231 offset:18432
    v_mfma_f32_32x32x16_bf16 v[112:127], v[204:207], v[12:15], v[112:127]
    ds_read_b64_tr_b16 v[202:203], v231 offset:18944
    buffer_load_dwordx4 v243, s[40:43], 0 offen sc1 lds
    v_mul_f32 v212, s76, v64
    v_mul_f32 v213, s76, v65
    s_waitcnt lgkmcnt(4)
    v_mfma_f32_32x32x16_bf16 v[96:111], v[208:211], v[16:19], v[96:111]
    ds_read_b64_tr_b16 v[204:205], v231 offset:20480
    v_mul_f32 v214, s76, v66
    v_mul_f32 v215, s76, v67
    v_exp_f32 v212, v212
    v_mfma_f32_32x32x16_bf16 v[112:127], v[208:211], v[20:23], v[112:127]
    ds_read_b64_tr_b16 v[206:207], v231 offset:20992
    buffer_store_dwordx4 v[236:239], v244, s[40:43], s94 offen offset:1024 sc1
    v_mfma_f32_32x32x16_bf16 v[96:111], v[192:195], v[24:27], v[96:111]
    ds_read_b64_tr_b16 v[208:209], v231 offset:22528
    v_exp_f32 v213, v213
    v_exp_f32 v214, v214
    v_mul_f32 v64, v64, v68
    v_mfma_f32_32x32x16_bf16 v[112:127], v[192:195], v[28:31], v[112:127]
    ds_read_b64_tr_b16 v[210:211], v231 offset:23040
    s_barrier
    v_exp_f32 v215, v215
    v_mul_f32 v65, v65, v69
    s_waitcnt lgkmcnt(4)
    v_mfma_f32_32x32x16_bf16 v[96:111], v[196:199], a[0:3], v[96:111]
    ds_read_b64_tr_b16 v[192:193], v227 offset:32768
    s_cmp_eq_u32 s54, 4
    s_mov_b32 s82, 4096
    s_cselect_b32 s82, 0xffff9000, s82
    v_add_u32 v243, s82, v243
    s_add_u32 m0, s56, 131072
    v_mfma_f32_32x32x16_bf16 v[112:127], v[196:199], a[4:7], v[112:127]
    ds_read_b64_tr_b16 v[194:195], v227 offset:33280
    buffer_load_dwordx4 v243, s[40:43], 0 offen sc1 lds
    v_add_u32 v243, 4096, v243
    s_add_u32 m0, s56, 135168
    v_mul_f32 v66, v66, v70
    v_mfma_f32_32x32x16_bf16 v[96:111], v[200:203], a[8:11], v[96:111]
    ds_read_b64_tr_b16 v[196:197], v227 offset:34816
    v_mul_f32 v67, v67, v71
    v_add_f32 v212, 1.0, v212
    v_add_f32 v213, 1.0, v213
    v_add_f32 v214, 1.0, v214
    v_add_f32 v215, 1.0, v215
    v_mfma_f32_32x32x16_bf16 v[112:127], v[200:203], a[12:15], v[112:127]
    ds_read_b64_tr_b16 v[198:199], v227 offset:35328
    buffer_load_dwordx4 v243, s[40:43], 0 offen sc1 lds
    v_rcp_f32 v212, v212
    s_waitcnt lgkmcnt(4)
    v_mfma_f32_32x32x16_bf16 v[96:111], v[204:207], a[16:19], v[96:111]
    ds_read_b64_tr_b16 v[200:201], v227 offset:36864
    s_cmp_eq_u32 s54, 2
    s_mov_b32 s82, 4096
    s_cselect_b32 s82, 0xffff9000, s82
    v_add_u32 v243, s82, v243
    s_add_u32 m0, s56, 139264
    v_mfma_f32_32x32x16_bf16 v[112:127], v[204:207], a[20:23], v[112:127]
    ds_read_b64_tr_b16 v[202:203], v227 offset:37376
    buffer_load_dwordx4 v243, s[40:43], 0 offen sc1 lds
    v_add_u32 v243, 4096, v243
    s_add_u32 m0, s56, 143360
    v_lshrrev_b32 v180, 4, v248
    v_mfma_f32_32x32x16_bf16 v[96:111], v[208:211], a[24:27], v[96:111]
KF_PG5:
    s_cbranch_execz KF_WEND
    ds_read_b64_tr_b16 v[204:205], v227 offset:38912
    v_and_b32 v181, 15, v248
    v_rcp_f32 v213, v213
    v_rcp_f32 v214, v214
    v_mfma_f32_32x32x16_bf16 v[112:127], v[208:211], a[28:31], v[112:127]
    ds_read_b64_tr_b16 v[206:207], v227 offset:39424
    buffer_load_dwordx4 v243, s[40:43], 0 offen sc1 lds
    s_mov_b64 s[48:49], s[12:13]
    s_mov_b32 s50, 2359296
    s_waitcnt lgkmcnt(4)
    v_mfma_f32_32x32x16_bf16 v[96:111], v[192:195], a[32:35], v[96:111]
    ds_read_b64_tr_b16 v[208:209], v227 offset:49152
    v_lshlrev_b32 v250, 9, v180
    v_lshl_add_u32 v250, v181, 4, v250
    v_rcp_f32 v215, v215
    v_mul_f32 v64, v64, v212
    v_mfma_f32_32x32x16_bf16 v[112:127], v[192:195], a[36:39], v[112:127]
    ds_read_b64_tr_b16 v[210:211], v227 offset:49664
    buffer_load_dwordx4 v[160:163], v244, s[48:51], s78 offen
    v_lshlrev_b32 v182, 5, v181
    v_mul_f32 v65, v65, v213
    v_mul_f32 v66, v66, v214
    v_mfma_f32_32x32x16_bf16 v[96:111], v[196:199], a[40:43], v[96:111]
    ds_read_b64_tr_b16 v[192:193], v227 offset:51200
    v_lshlrev_b32 v183, 4, v180
    v_mul_f32 v67, v67, v215
    v_cvt_pk_bf16_f32 v68, v64, v65
    v_cvt_pk_bf16_f32 v69, v66, v67
    v_mul_f32 v216, s76, v72
    v_mfma_f32_32x32x16_bf16 v[112:127], v[196:199], a[44:47], v[112:127]
    ds_read_b64_tr_b16 v[194:195], v227 offset:51712
    buffer_load_dwordx4 v[168:171], v244, s[48:51], s78 offen offset:4
    v_sub_u32 v183, v183, v182
    v_mul_f32 v217, s76, v73
    s_waitcnt lgkmcnt(4)
    v_mfma_f32_32x32x16_bf16 v[96:111], v[200:203], a[48:51], v[96:111]
    ds_read_b64_tr_b16 v[196:197], v227 offset:53248
    v_mul_f32 v218, s76, v74
    v_mul_f32 v219, s76, v75
    v_exp_f32 v216, v216
    v_mul_f32 v72, v72, v76
    v_mfma_f32_32x32x16_bf16 v[112:127], v[200:203], a[52:55], v[112:127]
    ds_read_b64_tr_b16 v[198:199], v227 offset:53760
    buffer_load_dwordx4 v[164:167], v244, s[48:51], s78 offen offset:1024
    s_add_u32 s83, s80, 8800
    v_exp_f32 v217, v217
    v_mfma_f32_32x32x16_bf16 v[96:111], v[204:207], a[56:59], v[96:111]
    ds_read_b64_tr_b16 v[200:201], v227 offset:55296
    v_add_u32 v240, s83, v183
    v_exp_f32 v218, v218
    v_exp_f32 v219, v219
    v_mfma_f32_32x32x16_bf16 v[112:127], v[204:207], a[60:63], v[112:127]
    ds_read_b64_tr_b16 v[202:203], v227 offset:55808
    buffer_load_dwordx4 v[172:175], v244, s[48:51], s78 offen offset:1028
    v_lshl_add_u32 v249, v180, 3, v182
    v_mul_f32 v73, v73, v77
    s_waitcnt lgkmcnt(4)
    v_mfma_f32_32x32x16_bf16 v[96:111], v[208:211], a[64:67], v[96:111]
    ds_read_b64_tr_b16 v[204:205], v223 offset:16384
    s_waitcnt vmcnt(13)
    v_mov_b32 v188, s77
    s_mov_b64 exec, 1
    buffer_store_dword v188, off, s[40:43], s101 sc1
    s_mov_b64 exec, -1
    v_mfma_f32_32x32x16_bf16 v[112:127], v[208:211], a[68:71], v[112:127]
    ds_read_b64_tr_b16 v[206:207], v223 offset:16896
    s_add_u32 s83, s97, 8824
    s_sub_u32 s83, s83, s79
    v_mul_f32 v74, v74, v78
    v_mul_f32 v75, v75, v79
    v_add_f32 v216, 1.0, v216
    v_mfma_f32_32x32x16_bf16 v[96:111], v[192:195], a[72:75], v[96:111]
    ds_read_b64_tr_b16 v[208:209], v223 offset:18432
    v_sub_u32 v241, s83, v249
    v_add_f32 v217, 1.0, v217
    v_add_f32 v218, 1.0, v218
    v_add_f32 v219, 1.0, v219
    v_mfma_f32_32x32x16_bf16 v[112:127], v[192:195], a[76:79], v[112:127]
    ds_read_b64_tr_b16 v[210:211], v223 offset:18944
    v_rcp_f32 v216, v216
    v_rcp_f32 v217, v217
    s_waitcnt lgkmcnt(4)
    v_mfma_f32_32x32x16_bf16 v[96:111], v[196:199], a[80:83], v[96:111]
    ds_read_b64_tr_b16 v[192:193], v223 offset:20480
    v_add_u32 v251, 65536, v244
    v_rcp_f32 v218, v218
    v_rcp_f32 v219, v219
    v_mfma_f32_32x32x16_bf16 v[112:127], v[196:199], a[84:87], v[112:127]
    ds_read_b64_tr_b16 v[194:195], v223 offset:20992
    v_add_u32 v252, 131072, v244
    v_mul_f32 v72, v72, v216
    v_mul_f32 v73, v73, v217
    v_mul_f32 v74, v74, v218
    v_mul_f32 v75, v75, v219
    v_mfma_f32_32x32x16_bf16 v[96:111], v[200:203], a[88:91], v[96:111]
    ds_read_b64_tr_b16 v[196:197], v223 offset:22528
    s_lshl_b32 s83, s52, 12
    v_cvt_pk_bf16_f32 v70, v72, v73
    v_cvt_pk_bf16_f32 v71, v74, v75
    v_mul_f32 v212, s76, v80
    v_mul_f32 v213, s76, v81
    v_mfma_f32_32x32x16_bf16 v[112:127], v[200:203], a[92:95], v[112:127]
    ds_read_b64_tr_b16 v[198:199], v223 offset:23040
    s_barrier
    v_add_u32 v253, s83, v244
    v_mul_f32 v214, s76, v82
    v_mul_f32 v215, s76, v83
    s_waitcnt lgkmcnt(4)
    v_mfma_f32_32x32x16_bf16 v[96:111], v[204:207], a[96:99], v[96:111]
    ds_read_b64_tr_b16 v[200:201], v227
    s_sub_u32 s82, 8, s54
    s_and_b32 s82, s82, 7
    s_add_u32 s82, s82, 1
    s_mul_i32 s82, s82, 4096
    v_add_u32 v243, s82, v243
    v_mfma_f32_32x32x16_bf16 v[112:127], v[204:207], a[100:103], v[112:127]
    ds_read_b64_tr_b16 v[202:203], v227 offset:512
    s_add_u32 m0, s56, 147456
    s_nop 0
    buffer_load_dwordx4 v243, s[40:43], 0 offen sc1 lds
    s_add_u32 s82, s97, s79
    s_add_u32 m0, s82, 32
    v_mfma_f32_32x32x16_bf16 v[96:111], v[208:211], a[104:107], v[96:111]
    ds_read_b64_tr_b16 v[204:205], v227 offset:2048
    buffer_store_dwordx4 v[68:71], v244, s[40:43], s72 offen sc1
    v_mfma_f32_32x32x16_bf16 v[112:127], v[208:211], a[108:111], v[112:127]
    ds_read_b64_tr_b16 v[206:207], v227 offset:2560
    v_xor_b32 v254, 4096, v253
    v_and_b32 v255, 7, v248
    v_lshlrev_b32 v255, 2, v255
    v_mul_f32 v80, v80, v84
    s_waitcnt lgkmcnt(4)
    v_mfma_f32_32x32x16_bf16 v[96:111], v[192:195], a[112:115], v[96:111]
    ds_read_b64_tr_b16 v[208:209], v227 offset:4096
    v_lshl_add_u32 v182, v180, 3, v181
    v_exp_f32 v212, v212
    v_exp_f32 v213, v213
    v_mfma_f32_32x32x16_bf16 v[112:127], v[192:195], a[116:119], v[112:127]
    ds_read_b64_tr_b16 v[210:211], v227 offset:4608
    buffer_store_dwordx4 v[236:239], v244, s[40:43], s95 offen sc1
    v_mfma_f32_32x32x16_bf16 v[96:111], v[196:199], a[120:123], v[96:111]
    ds_read_b64_tr_b16 v[192:193], v227 offset:6144
    v_add_u32 v182, 1, v182
    v_and_b32 v183, 1, v182
    v_exp_f32 v214, v214
    v_mul_f32 v81, v81, v85
    v_mfma_f32_32x32x16_bf16 v[112:127], v[196:199], a[124:127], v[112:127]
    ds_read_b64_tr_b16 v[194:195], v227 offset:6656
    buffer_load_dwordx4 v244, s[48:51], s78 offen lds
    v_lshrrev_b32 v182, 1, v182
    v_mul_f32 v82, v82, v86
    s_waitcnt lgkmcnt(4)
    v_mfma_f32_32x32x16_bf16 v[96:111], v[200:203], a[128:131], v[96:111]
    ds_read_b64_tr_b16 v[196:197], v227 offset:16384
    v_mul_u32_u24 v183, 4160, v183
    v_exp_f32 v215, v215
    v_mul_f32 v83, v83, v87
    v_add_f32 v212, 1.0, v212
    v_mfma_f32_32x32x16_bf16 v[112:127], v[200:203], a[132:135], v[112:127]
    ds_read_b64_tr_b16 v[198:199], v227 offset:16896
    buffer_load_dwordx4 v244, s[48:51], s78 offen offset:1024 lds
    v_lshl_add_u32 v183, v182, 2, v183
    v_add_f32 v213, 1.0, v213
    v_add_f32 v214, 1.0, v214
    v_mfma_f32_32x32x16_bf16 v[96:111], v[204:207], a[136:139], v[96:111]
    ds_read_b64_tr_b16 v[200:201], v227 offset:18432
    s_add_u32 s82, s97, s79
    s_add_u32 m0, s82, 8320
    s_add_u32 s82, s78, 24182784
    v_add_f32 v215, 1.0, v215
    v_mfma_f32_32x32x16_bf16 v[112:127], v[204:207], a[140:143], v[112:127]
    ds_read_b64_tr_b16 v[202:203], v227 offset:18944
    buffer_load_dwordx4 v244, s[40:43], s82 offen sc1 lds
    v_rcp_f32 v212, v212
    s_waitcnt lgkmcnt(4)
    v_mfma_f32_32x32x16_bf16 v[96:111], v[208:211], a[144:147], v[96:111]
    ds_read_b64_tr_b16 v[204:205], v227 offset:20480
    v_rcp_f32 v213, v213
    v_rcp_f32 v214, v214
    v_mul_f32 v80, v80, v212
    v_mfma_f32_32x32x16_bf16 v[112:127], v[208:211], a[148:151], v[112:127]
    ds_read_b64_tr_b16 v[206:207], v227 offset:20992
    buffer_load_dwordx4 v244, s[40:43], s82 offen offset:1024 sc1 lds
    v_rcp_f32 v215, v215
    v_mul_f32 v81, v81, v213
    v_mfma_f32_32x32x16_bf16 v[96:111], v[192:195], a[152:155], v[96:111]
    ds_read_b64_tr_b16 v[208:209], v227 offset:22528
    v_mul_f32 v82, v82, v214
    v_mul_f32 v83, v83, v215
    v_cvt_pk_bf16_f32 v84, v80, v81
    v_cvt_pk_bf16_f32 v85, v82, v83
    v_mul_f32 v216, s76, v88
    v_mfma_f32_32x32x16_bf16 v[112:127], v[192:195], a[156:159], v[112:127]
    ds_read_b64_tr_b16 v[210:211], v227 offset:23040
    s_and_b32 s83, s2, 1
    s_lshl_b32 s83, s83, 3
    s_bfe_u32 s84, s2, 0x30003
    v_mul_f32 v217, s76, v89
    s_waitcnt lgkmcnt(4)
    v_mfma_f32_32x32x16_bf16 v[96:111], v[196:199], a[160:163], v[96:111]
    ds_read_b64_tr_b16 v[192:193], v223 offset:32768
    s_add_u32 s83, s83, s84
    s_lshr_b32 s84, s2, 6
    s_add_u32 s85, s83, s84
    v_mul_f32 v218, s76, v90
    v_mul_f32 v219, s76, v91
    v_mfma_f32_32x32x16_bf16 v[112:127], v[196:199], a[164:167], v[112:127]
    ds_read_b64_tr_b16 v[194:195], v223 offset:33280
    s_and_b32 s85, s85, 3
    s_mul_i32 s55, s85, 3
    s_add_u32 s55, s55, 1
    v_exp_f32 v216, v216
    v_mfma_f32_32x32x16_bf16 v[96:111], v[200:203], a[168:171], v[96:111]
    ds_read_b64_tr_b16 v[196:197], v223 offset:34816
    s_lshr_b32 s61, s55, 1
    s_add_u32 s62, s61, 1
    s_cmp_eq_u32 s62, 6
    s_cselect_b32 s62, 0, s62
    v_mul_f32 v88, v88, v92
    v_mfma_f32_32x32x16_bf16 v[112:127], v[200:203], a[172:175], v[112:127]
    ds_read_b64_tr_b16 v[198:199], v223 offset:35328
    s_add_u32 s63, s62, 1
    s_cmp_eq_u32 s63, 6
    s_cselect_b32 s63, 0, s63
    v_mul_f32 v89, v89, v93
    s_waitcnt lgkmcnt(4)
    v_mfma_f32_32x32x16_bf16 v[96:111], v[204:207], a[176:179], v[96:111]
    ds_read_b64_tr_b16 v[200:201], v223 offset:36864
    buffer_load_dwordx4 v[176:179], v244, s[40:43], s58 offen offset:2048 sc1
    s_add_u32 s64, s63, 1
    v_exp_f32 v217, v217
    v_mfma_f32_32x32x16_bf16 v[112:127], v[204:207], a[180:183], v[112:127]
    ds_read_b64_tr_b16 v[202:203], v223 offset:37376
    s_cmp_eq_u32 s64, 6
    s_cselect_b32 s64, 0, s64
    s_add_u32 s65, s64, 1
    v_exp_f32 v218, v218
    v_mfma_f32_32x32x16_bf16 v[96:111], v[208:211], a[184:187], v[96:111]
    ds_read_b64_tr_b16 v[204:205], v223 offset:38912
    s_cmp_eq_u32 s65, 6
    s_cselect_b32 s65, 0, s65
    s_add_u32 s66, s65, 1
    v_exp_f32 v219, v219
    v_mfma_f32_32x32x16_bf16 v[112:127], v[208:211], a[188:191], v[112:127]
    ds_read_b64_tr_b16 v[206:207], v223 offset:39424
    s_cmp_eq_u32 s66, 6
    s_cselect_b32 s66, 0, s66
    s_cmp_eq_u32 s85, 3
    s_cselect_b32 s85, 0, s85
    s_waitcnt lgkmcnt(4)
    v_mfma_f32_32x32x16_bf16 v[96:111], v[192:195], a[192:195], v[96:111]
    ds_read_b64_tr_b16 v[208:209], v223 offset:49152
    s_add_u32 s67, s85, 6
    s_add_u32 s4, s67, 1
    v_mul_f32 v90, v90, v94
    v_mul_f32 v91, v91, v95
    v_add_f32 v216, 1.0, v216
    v_mfma_f32_32x32x16_bf16 v[112:127], v[192:195], a[196:199], v[112:127]
    ds_read_b64_tr_b16 v[210:211], v223 offset:49664
    s_cmp_eq_u32 s4, 9
    s_cselect_b32 s4, 6, s4
    v_add_f32 v217, 1.0, v217
    v_add_f32 v218, 1.0, v218
    v_add_f32 v219, 1.0, v219
    v_mfma_f32_32x32x16_bf16 v[96:111], v[196:199], a[200:203], v[96:111]
    ds_read_b64_tr_b16 v[192:193], v223 offset:51200
    s_add_u32 s5, s4, 1
    s_cmp_eq_u32 s5, 9
    s_cselect_b32 s5, 6, s5
    v_rcp_f32 v216, v216
    v_mfma_f32_32x32x16_bf16 v[112:127], v[196:199], a[204:207], v[112:127]
    ds_read_b64_tr_b16 v[194:195], v223 offset:51712
    s_mul_i32 s85, s53, 1296
    s_mul_i32 s84, s84, 9
    s_add_u32 s85, s85, s84
    v_mul_f32 v88, v88, v216
    s_waitcnt lgkmcnt(4)
    v_mfma_f32_32x32x16_bf16 v[96:111], v[200:203], a[208:211], v[96:111]
    ds_read_b64_tr_b16 v[196:197], v223 offset:53248
    s_lshl_b32 s88, s85, 10
    s_lshl_b32 s84, s83, 2
    s_add_u32 s84, s84, s52
    v_rcp_f32 v217, v217
    v_mfma_f32_32x32x16_bf16 v[112:127], v[200:203], a[212:215], v[112:127]
    ds_read_b64_tr_b16 v[198:199], v223 offset:53760
    s_mul_i32 s84, s84, 288
    s_mul_i32 s85, s53, 72
    s_add_u32 s84, s84, s85
    v_rcp_f32 v218, v218
    v_mfma_f32_32x32x16_bf16 v[96:111], v[204:207], a[216:219], v[96:111]
    ds_read_b64_tr_b16 v[200:201], v223 offset:55296
    buffer_store_dwordx4 v[236:239], v244, s[40:43], s95 offen offset:1024 sc1
    v_mfma_f32_32x32x16_bf16 v[112:127], v[204:207], a[220:223], v[112:127]
    ds_read_b64_tr_b16 v[202:203], v223 offset:55808
    s_waitcnt vmcnt(19)
    s_barrier
    s_lshl_b32 s90, s84, 10
    s_mul_i32 s16, s61, 147456
    s_waitcnt lgkmcnt(4)
    v_mfma_f32_32x32x16_bf16 v[96:111], v[208:211], a[224:227], v[96:111]
    ds_read_b64_tr_b16 v[204:205], v232
    s_add_u32 s16, s16, s88
    s_lshl_b32 s61, s61, 13
    s_add_u32 s61, s61, s90
    s_mul_i32 s17, s62, 147456
    s_add_u32 s17, s17, s88
    v_mfma_f32_32x32x16_bf16 v[112:127], v[208:211], a[228:231], v[112:127]
    ds_read_b64_tr_b16 v[206:207], v233
    s_lshl_b32 s62, s62, 13
    s_add_u32 s62, s62, s90
    s_mul_i32 s18, s63, 147456
    s_add_u32 s18, s18, s88
    v_mul_f32 v89, v89, v217
    v_mfma_f32_32x32x16_bf16 v[96:111], v[192:195], a[232:235], v[96:111]
    ds_read_b64_tr_b16 v[208:209], v232 offset:512
    s_lshl_b32 s63, s63, 13
    s_add_u32 s63, s63, s90
    s_mul_i32 s19, s64, 147456
    v_rcp_f32 v219, v219
    v_mfma_f32_32x32x16_bf16 v[112:127], v[192:195], a[236:239], v[112:127]
    ds_read_b64_tr_b16 v[210:211], v233 offset:512
    s_add_u32 s19, s19, s88
    s_lshl_b32 s64, s64, 13
    s_add_u32 s64, s64, s90
    v_mul_f32 v90, v90, v218
    s_waitcnt lgkmcnt(4)
    v_mfma_f32_32x32x16_bf16 v[96:111], v[196:199], a[240:243], v[96:111]
    ds_read_b64_tr_b16 v[192:193], v232 offset:1024
    s_mul_i32 s20, s65, 147456
    s_add_u32 s20, s20, s88
    v_mul_f32 v91, v91, v219
    v_cvt_pk_bf16_f32 v86, v88, v89
    v_cvt_pk_bf16_f32 v87, v90, v91
    v_mfma_f32_32x32x16_bf16 v[112:127], v[196:199], a[244:247], v[112:127]
    ds_read_b64_tr_b16 v[194:195], v233 offset:1024
    s_lshl_b32 s65, s65, 13
    s_add_u32 s65, s65, s90
    s_mul_i32 s21, s66, 147456
    v_mfma_f32_32x32x16_bf16 v[96:111], v[200:203], a[248:251], v[96:111]
    ds_read_b64_tr_b16 v[196:197], v232 offset:1536
    s_add_u32 s21, s21, s88
    s_lshl_b32 s66, s66, 13
    s_add_u32 s66, s66, s90
    v_mfma_f32_32x32x16_bf16 v[112:127], v[200:203], a[252:255], v[112:127]
    ds_read_b64_tr_b16 v[198:199], v233 offset:1536
    s_cmp_eq_u32 s52, 0
    s_cselect_b64 exec, 1, 0
    ds_write_b32 v234, v246 offset:28672
    s_mov_b64 exec, -1
    s_waitcnt lgkmcnt(5)
    v_mfma_f32_32x32x16_bf16 v[128:143], v[204:207], v[0:3], 0
    ds_read_b64_tr_b16 v[200:201], v232 offset:4096
    buffer_store_dwordx4 v[84:87], v244, s[40:43], s73 offen sc1
    v_mfma_f32_32x32x16_bf16 v[144:159], v[204:207], v[4:7], 0
    ds_read_b64_tr_b16 v[202:203], v233 offset:4096
    s_mul_i32 s30, s67, 147456
    s_add_u32 s30, s30, s88
    s_lshl_b32 s67, s67, 13
    s_add_u32 s67, s67, s90
    s_mul_i32 s31, s4, 147456
    v_mfma_f32_32x32x16_bf16 v[128:143], v[208:211], v[8:11], v[128:143]
    ds_read_b64_tr_b16 v[204:205], v232 offset:4608
    s_add_u32 s31, s31, s88
    s_lshl_b32 s4, s4, 13
    s_add_u32 s4, s4, s90
    s_mul_i32 s89, s5, 147456
    s_add_u32 s89, s89, s88
    v_mfma_f32_32x32x16_bf16 v[144:159], v[208:211], v[12:15], v[144:159]
    ds_read_b64_tr_b16 v[206:207], v233 offset:4608
    s_lshl_b32 s5, s5, 13
    s_add_u32 s5, s5, s90
    s_lshr_b32 s84, s83, 1
    s_lshl_b32 s84, s84, 2
    s_waitcnt lgkmcnt(5)
    v_mfma_f32_32x32x16_bf16 v[128:143], v[192:195], v[16:19], v[128:143]
    ds_read_b64_tr_b16 v[208:209], v232 offset:5120
    s_add_u32 s84, s84, s53
    s_lshl_b32 s84, s84, 2
    s_and_b32 s85, s83, 1
    v_mul_f32 v212, s76, v96
    v_mul_f32 v213, s76, v97
    v_mfma_f32_32x32x16_bf16 v[144:159], v[192:195], v[20:23], v[144:159]
    ds_read_b64_tr_b16 v[210:211], v233 offset:5120
    s_lshl_b32 s85, s85, 1
    s_add_u32 s84, s84, s85
    s_lshr_b32 s85, s52, 1
    v_mul_f32 v214, s76, v98
    v_mul_f32 v215, s76, v99
    v_mfma_f32_32x32x16_bf16 v[128:143], v[196:199], v[24:27], v[128:143]
    ds_read_b64_tr_b16 v[192:193], v232 offset:5632
    s_add_u32 s84, s84, s85
    s_lshl_b32 s84, s84, 7
    s_add_u32 s57, s84, 36282368
    v_exp_f32 v212, v212
    v_mfma_f32_32x32x16_bf16 v[144:159], v[196:199], v[28:31], v[144:159]
    ds_read_b64_tr_b16 v[194:195], v233 offset:5632
    s_lshl_b32 s92, s52, 10
    s_lshl_b32 s91, s52, 12
    v_exp_f32 v213, v213
    s_waitcnt lgkmcnt(4)
    v_mfma_f32_32x32x16_bf16 v[128:143], v[200:203], a[0:3], v[128:143]
    ds_read_b64_tr_b16 v[196:197], v232 offset:8192
    v_exp_f32 v214, v214
    v_exp_f32 v215, v215
    v_mul_f32 v96, v96, v100
    v_mfma_f32_32x32x16_bf16 v[144:159], v[200:203], a[4:7], v[144:159]
    ds_read_b64_tr_b16 v[198:199], v233 offset:8192
    s_mul_i32 s83, s52, 36864
    s_add_u32 s83, s83, 18874368
    s_add_u32 s84, s53, 0
    v_mul_f32 v97, v97, v101
    v_mul_f32 v98, v98, v102
    v_mfma_f32_32x32x16_bf16 v[128:143], v[204:207], a[8:11], v[128:143]
    ds_read_b64_tr_b16 v[200:201], v232 offset:8704
    s_and_b32 s84, s84, 3
    s_lshl_b32 s84, s84, 11
    v_mul_f32 v99, v99, v103
    v_add_f32 v212, 1.0, v212
    v_add_f32 v213, 1.0, v213
    v_mfma_f32_32x32x16_bf16 v[144:159], v[204:207], a[12:15], v[144:159]
    ds_read_b64_tr_b16 v[202:203], v233 offset:8704
    s_add_u32 s84, s84, s83
    v_add_u32 v221, s84, v244
    v_add_f32 v214, 1.0, v214
    v_add_f32 v215, 1.0, v215
    s_waitcnt lgkmcnt(4)
    v_mfma_f32_32x32x16_bf16 v[128:143], v[208:211], a[16:19], v[128:143]
    ds_read_b64_tr_b16 v[204:205], v232 offset:9216
    s_add_u32 s84, s53, 1
    s_and_b32 s84, s84, 3
    v_rcp_f32 v212, v212
    v_mfma_f32_32x32x16_bf16 v[144:159], v[208:211], a[20:23], v[144:159]
    ds_read_b64_tr_b16 v[206:207], v233 offset:9216
    s_lshl_b32 s84, s84, 11
    s_add_u32 s84, s84, s83
    v_rcp_f32 v213, v213
    v_mul_f32 v96, v96, v212
    v_mfma_f32_32x32x16_bf16 v[128:143], v[192:195], a[24:27], v[128:143]
    ds_read_b64_tr_b16 v[208:209], v232 offset:9728
    v_add_u32 v222, s84, v244
    s_add_u32 s84, s53, 2
    v_rcp_f32 v214, v214
    v_mul_f32 v97, v97, v213
    v_mfma_f32_32x32x16_bf16 v[144:159], v[192:195], a[28:31], v[144:159]
    ds_read_b64_tr_b16 v[210:211], v233 offset:9728
    s_and_b32 s84, s84, 3
    s_lshl_b32 s84, s84, 11
    s_add_u32 s84, s84, s83
    v_mul_f32 v98, v98, v214
    s_waitcnt lgkmcnt(4)
    v_mfma_f32_32x32x16_bf16 v[128:143], v[196:199], a[32:35], v[128:143]
    ds_read_b64_tr_b16 v[192:193], v232 offset:12288
    s_sub_u32 s84, s84, 2048
    v_add_u32 v223, s84, v244
    v_rcp_f32 v215, v215
    v_cvt_pk_bf16_f32 v100, v96, v97
    v_mfma_f32_32x32x16_bf16 v[144:159], v[196:199], a[36:39], v[144:159]
    ds_read_b64_tr_b16 v[194:195], v233 offset:12288
    s_add_u32 s84, s53, 3
    s_and_b32 s84, s84, 3
    v_mul_f32 v99, v99, v215
    v_cvt_pk_bf16_f32 v101, v98, v99
    v_mul_f32 v216, s76, v104
    v_mfma_f32_32x32x16_bf16 v[128:143], v[200:203], a[40:43], v[128:143]
    ds_read_b64_tr_b16 v[196:197], v232 offset:12800
    s_lshl_b32 s84, s84, 11
    s_add_u32 s84, s84, s83
    v_mul_f32 v217, s76, v105
    v_mul_f32 v218, s76, v106
    v_mul_f32 v219, s76, v107
    v_mfma_f32_32x32x16_bf16 v[144:159], v[200:203], a[44:47], v[144:159]
    ds_read_b64_tr_b16 v[198:199], v233 offset:12800
    v_add_u32 v224, s84, v244
    s_add_u32 s84, s83, 6144
    v_exp_f32 v216, v216
    s_waitcnt lgkmcnt(4)
    v_mfma_f32_32x32x16_bf16 v[128:143], v[204:207], a[48:51], v[128:143]
    ds_read_b64_tr_b16 v[200:201], v232 offset:13312
    v_add_u32 v225, s84, v244
    v_add_u32 v226, 4096, v250
    v_exp_f32 v217, v217
    v_mul_f32 v104, v104, v108
    v_mfma_f32_32x32x16_bf16 v[144:159], v[204:207], a[52:55], v[144:159]
    ds_read_b64_tr_b16 v[202:203], v233 offset:13312
    buffer_store_dwordx4 v[236:239], v244, s[40:43], s96 offen sc1
    v_mfma_f32_32x32x16_bf16 v[128:143], v[208:211], a[56:59], v[128:143]
    ds_read_b64_tr_b16 v[204:205], v232 offset:13824
    v_exp_f32 v218, v218
    v_exp_f32 v219, v219
    v_mul_f32 v105, v105, v109
    v_mfma_f32_32x32x16_bf16 v[144:159], v[208:211], a[60:63], v[144:159]
    ds_read_b64_tr_b16 v[206:207], v233 offset:13824
    s_waitcnt vmcnt(10)
    s_barrier
    v_mul_f32 v106, v106, v110
    v_mul_f32 v107, v107, v111
    s_waitcnt lgkmcnt(4)
    v_mfma_f32_32x32x16_bf16 v[128:143], v[192:195], a[64:67], v[128:143]
    ds_read_b64_tr_b16 v[208:209], v234
    s_waitcnt vmcnt(3)
    v_cmp_ne_u32 vcc, s77, v176
    v_cmp_ne_u32 s[86:87], s77, v177
    s_nop 0
    s_or_b64 vcc, vcc, s[86:87]
    v_cmp_ne_u32 s[86:87], s77, v178
    s_nop 0
    s_or_b64 vcc, vcc, s[86:87]
    v_cmp_ne_u32 s[86:87], s77, v179
    s_nop 0
    s_or_b64 vcc, vcc, s[86:87]
    s_cbranch_vccnz SLOW_J3
BACK_J3:
    v_mfma_f32_32x32x16_bf16 v[144:159], v[192:195], a[68:71], v[144:159]
    ds_read_b64_tr_b16 v[210:211], v235
    s_add_u32 m0, s91, 32768
    s_nop 0
    buffer_load_dwordx4 v222, s[40:43], s16 offen sc1 lds
    v_mov_b32 v184, 0
    v_mov_b32 v185, 0
    v_mfma_f32_32x32x16_bf16 v[128:143], v[196:199], a[72:75], v[128:143]
    ds_read_b64_tr_b16 v[192:193], v234 offset:512
    ds_read_b32 v246, v234 offset:28672
    v_lshrrev_b32 v186, 1, v244
    v_add_f32 v216, 1.0, v216
    v_add_f32 v217, 1.0, v217
    v_add_f32 v218, 1.0, v218
    v_mfma_f32_32x32x16_bf16 v[144:159], v[196:199], a[76:79], v[144:159]
    ds_read_b64_tr_b16 v[194:195], v235 offset:512
    s_add_u32 s83, s97, 12416
    v_add_f32 v219, 1.0, v219
    v_rcp_f32 v216, v216
    s_waitcnt lgkmcnt(5)
    v_mfma_f32_32x32x16_bf16 v[128:143], v[200:203], a[80:83], v[128:143]
    ds_read_b64_tr_b16 v[196:197], v234 offset:1024
    buffer_load_dwordx4 v222, s[40:43], s16 offen offset:1024 sc1 lds
    v_add_u32 v186, s83, v186
    v_add_u32 v236, s80, v183
    v_mul_f32 v104, v104, v216
    v_mfma_f32_32x32x16_bf16 v[144:159], v[200:203], a[84:87], v[144:159]
    ds_read_b64_tr_b16 v[198:199], v235 offset:1024
    ds_write_b64 v186, v[184:185]
    v_rcp_f32 v217, v217
    v_rcp_f32 v218, v218
    v_mfma_f32_32x32x16_bf16 v[128:143], v[204:207], a[88:91], v[128:143]
    ds_read_b64_tr_b16 v[200:201], v234 offset:1536
    s_cmp_eq_u32 s79, 0
    s_cselect_b32 s83, 0, 4128
    v_rcp_f32 v219, v219
    v_mul_f32 v105, v105, v217
    v_mfma_f32_32x32x16_bf16 v[144:159], v[204:207], a[92:95], v[144:159]
    ds_read_b64_tr_b16 v[202:203], v235 offset:1536
    buffer_load_dwordx4 v223, s[40:43], s16 offen offset:2048 sc1 lds
    v_mul_f32 v106, v106, v218
    v_mul_f32 v107, v107, v219
    s_waitcnt lgkmcnt(5)
    v_mfma_f32_32x32x16_bf16 v[128:143], v[208:211], a[96:99], v[128:143]
    ds_read_b64_tr_b16 v[204:205], v234 offset:4096
    s_add_u32 s83, s83, s97
    v_cvt_pk_bf16_f32 v102, v104, v105
    v_cvt_pk_bf16_f32 v103, v106, v107
    v_mul_f32 v212, s76, v112
    v_mul_f32 v213, s76, v113
    v_mfma_f32_32x32x16_bf16 v[144:159], v[208:211], a[100:103], v[144:159]
    ds_read_b64_tr_b16 v[206:207], v235 offset:4096
    v_add_u32 v186, s83, v255
    v_add_u32 v237, 1024, v236
    v_mul_f32 v214, s76, v114
    v_mul_f32 v215, s76, v115
    v_mul_f32 v112, v112, v116
    v_mfma_f32_32x32x16_bf16 v[128:143], v[192:195], a[104:107], v[128:143]
    ds_read_b64_tr_b16 v[208:209], v234 offset:4608
    buffer_load_dwordx4 v223, s[40:43], s16 offen offset:3072 sc1 lds
    v_readfirstlane_b32 s6, v246
    ds_write_b32 v186, v184
    v_mul_f32 v113, v113, v117
    v_mfma_f32_32x32x16_bf16 v[144:159], v[192:195], a[108:111], v[144:159]
    ds_read_b64_tr_b16 v[210:211], v235 offset:4608
    s_add_u32 s83, s97, s79
    v_exp_f32 v212, v212
    v_mul_f32 v114, v114, v118
    s_waitcnt lgkmcnt(5)
    v_mfma_f32_32x32x16_bf16 v[128:143], v[196:199], a[112:115], v[128:143]
    ds_read_b64_tr_b16 v[192:193], v234 offset:5120
    buffer_store_dwordx4 v[100:103], v244, s[40:43], s72 offen offset:1024 sc1
    v_mfma_f32_32x32x16_bf16 v[144:159], v[196:199], a[116:119], v[144:159]
    ds_read_b64_tr_b16 v[194:195], v235 offset:5120
    s_add_u32 m0, s91, 49152
    s_add_u32 s83, s83, 4192
    v_add_u32 v187, s83, v244
    v_exp_f32 v213, v213
    v_mfma_f32_32x32x16_bf16 v[128:143], v[200:203], a[120:123], v[128:143]
    ds_read_b64_tr_b16 v[196:197], v234 offset:5632
    buffer_load_dwordx4 v224, s[40:43], s16 offen sc1 lds
    v_alignbit_b32 v168, v168, v160, 16
    v_add_u32 v238, 2048, v236
    v_mul_f32 v115, v115, v119
    v_mfma_f32_32x32x16_bf16 v[144:159], v[200:203], a[124:127], v[144:159]
    ds_read_b64_tr_b16 v[198:199], v235 offset:5632
    v_alignbit_b32 v169, v169, v161, 16
    v_exp_f32 v214, v214
    v_add_f32 v212, 1.0, v212
    s_waitcnt lgkmcnt(4)
    v_mfma_f32_32x32x16_bf16 v[128:143], v[204:207], a[128:131], v[128:143]
    ds_read_b64_tr_b16 v[200:201], v234 offset:8192
    buffer_load_dwordx4 v224, s[40:43], s16 offen offset:1024 sc1 lds
    s_and_b32 s6, s6, 255
    v_alignbit_b32 v170, v170, v162, 16
    v_add_f32 v213, 1.0, v213
    v_mfma_f32_32x32x16_bf16 v[144:159], v[204:207], a[132:135], v[144:159]
    ds_read_b64_tr_b16 v[202:203], v235 offset:8192
    v_alignbit_b32 v171, v171, v163, 16
    v_exp_f32 v215, v215
    v_add_f32 v214, 1.0, v214
    v_add_f32 v215, 1.0, v215
    v_mfma_f32_32x32x16_bf16 v[128:143], v[208:211], a[136:139], v[128:143]
    ds_read_b64_tr_b16 v[204:205], v234 offset:8704
    v_alignbit_b32 v172, v172, v164, 16
    v_rcp_f32 v212, v212
    v_rcp_f32 v213, v213
    v_mfma_f32_32x32x16_bf16 v[144:159], v[208:211], a[140:143], v[144:159]
    ds_read_b64_tr_b16 v[206:207], v235 offset:8704
    buffer_load_dword v220, v255, s[40:43], s57 offen sc1
    v_alignbit_b32 v173, v173, v165, 16
    v_add_u32 v239, 3072, v236
    s_waitcnt lgkmcnt(4)
    v_mfma_f32_32x32x16_bf16 v[128:143], v[192:195], a[144:147], v[128:143]
    ds_read_b64_tr_b16 v[208:209], v234 offset:9216
    buffer_load_dwordx4 v225, s[40:43], s16 offen offset:2048 sc1 lds
    v_alignbit_b32 v174, v174, v166, 16
    v_rcp_f32 v214, v214
    v_mfma_f32_32x32x16_bf16 v[144:159], v[192:195], a[148:151], v[144:159]
    ds_read_b64_tr_b16 v[210:211], v235 offset:9216
    v_alignbit_b32 v175, v175, v167, 16
    v_rcp_f32 v215, v215
    v_mul_f32 v112, v112, v212
    v_mul_f32 v113, v113, v213
    v_mfma_f32_32x32x16_bf16 v[128:143], v[196:199], a[152:155], v[128:143]
    ds_read_b64_tr_b16 v[192:193], v234 offset:9728
    v_readfirstlane_b32 s84, v160
    v_mul_f32 v114, v114, v214
    v_mul_f32 v115, v115, v215
    v_cvt_pk_bf16_f32 v116, v112, v113
    v_cvt_pk_bf16_f32 v117, v114, v115
    v_mfma_f32_32x32x16_bf16 v[144:159], v[196:199], a[156:159], v[144:159]
    ds_read_b64_tr_b16 v[194:195], v235 offset:9728
    s_add_u32 m0, s91, 65536
    s_nop 0
    buffer_load_dwordx4 v222, s[40:43], s17 offen sc1 lds
    ds_write_b128 v187, v[168:171]
    s_waitcnt lgkmcnt(5)
    v_mfma_f32_32x32x16_bf16 v[128:143], v[200:203], a[160:163], v[128:143]
    ds_read_b64_tr_b16 v[196:197], v234 offset:12288
    ds_write_b128 v187, v[172:175] offset:1024
    v_mul_f32 v216, s76, v120
    v_mul_f32 v217, s76, v121
    v_mul_f32 v218, s76, v122
    v_mul_f32 v219, s76, v123
    v_mfma_f32_32x32x16_bf16 v[144:159], v[200:203], a[164:167], v[144:159]
    ds_read_b64_tr_b16 v[198:199], v235 offset:12288
    s_lshl_b32 s84, s84, 16
    v_exp_f32 v216, v216
    v_exp_f32 v217, v217
    v_mfma_f32_32x32x16_bf16 v[128:143], v[204:207], a[168:171], v[128:143]
    ds_read_b64_tr_b16 v[200:201], v234 offset:12800
    buffer_load_dwordx4 v222, s[40:43], s17 offen offset:1024 sc1 lds
    v_mov_b32 v185, s84
    v_exp_f32 v218, v218
    v_mfma_f32_32x32x16_bf16 v[144:159], v[204:207], a[172:175], v[144:159]
    ds_read_b64_tr_b16 v[202:203], v235 offset:12800
    v_cmp_eq_u32 vcc, 28, v255
    s_nop 1
    v_cndmask_b32 v185, v184, v185, vcc
    v_exp_f32 v219, v219
    s_waitcnt lgkmcnt(6)
    v_mfma_f32_32x32x16_bf16 v[128:143], v[208:211], a[176:179], v[128:143]
    ds_read_b64_tr_b16 v[204:205], v234 offset:13312
    v_mul_f32 v120, v120, v124
    v_mul_f32 v121, v121, v125
    v_mul_f32 v122, v122, v126
    v_mul_f32 v123, v123, v127
    v_add_f32 v216, 1.0, v216
    v_mfma_f32_32x32x16_bf16 v[144:159], v[208:211], a[180:183], v[144:159]
    ds_read_b64_tr_b16 v[206:207], v235 offset:13312
    buffer_load_dwordx4 v223, s[40:43], s17 offen offset:2048 sc1 lds
    ds_write_b32 v186, v185 offset:4160
    v_add_f32 v217, 1.0, v217
    v_add_f32 v218, 1.0, v218
    v_mfma_f32_32x32x16_bf16 v[128:143], v[192:195], a[184:187], v[128:143]
    ds_read_b64_tr_b16 v[208:209], v234 offset:13824
    v_add_f32 v219, 1.0, v219
    v_rcp_f32 v216, v216
    v_rcp_f32 v217, v217
    v_mfma_f32_32x32x16_bf16 v[144:159], v[192:195], a[188:191], v[144:159]
KF_PG6:
    s_cbranch_execz KF_WEND
    ds_read_b64_tr_b16 v[210:211], v235 offset:13824
    v_rcp_f32 v218, v218
    v_rcp_f32 v219, v219
    s_waitcnt lgkmcnt(5)
    v_mfma_f32_32x32x16_bf16 v[128:143], v[196:199], a[192:195], v[128:143]
    ds_read_b64_tr_b16 v[192:193], v234 offset:16384
    buffer_load_dwordx4 v223, s[40:43], s17 offen offset:3072 sc1 lds
    v_mul_f32 v120, v120, v216
    v_mul_f32 v121, v121, v217
    v_mul_f32 v122, v122, v218
    v_mfma_f32_32x32x16_bf16 v[144:159], v[196:199], a[196:199], v[144:159]
    ds_read_b64_tr_b16 v[194:195], v235 offset:16384
    v_mul_f32 v123, v123, v219
    v_cvt_pk_bf16_f32 v118, v120, v121
    v_cvt_pk_bf16_f32 v119, v122, v123
    v_mfma_f32_32x32x16_bf16 v[128:143], v[200:203], a[200:203], v[128:143]
    s_waitcnt lgkmcnt(0)
    s_lshl_b32 s83, s98, 16
    s_and_b32 s98, s98, s99
    s_cmp_lt_u32 s52, 2
    s_cselect_b32 s98, s83, s98
    s_barrier
    ds_read_b64_tr_b16 v[196:197], v234 offset:16896
    v_mfma_f32_32x32x16_bf16 v[144:159], v[200:203], a[204:207], v[144:159]
    ds_read_b64_tr_b16 v[198:199], v235 offset:16896
    s_add_u32 m0, s91, 81920
    s_nop 0
    buffer_load_dwordx4 v224, s[40:43], s17 offen sc1 lds
    ds_read2_b32 v[32:33], v236 offset0:0 offset1:1
    ds_read2_b32 v[34:35], v236 offset0:2 offset1:3
    v_mfma_f32_32x32x16_bf16 v[128:143], v[204:207], a[208:211], v[128:143]
    ds_read_b64_tr_b16 v[200:201], v234 offset:17408
    ds_read_b128 v[64:67], v240 offset:3584
    ds_read_b128 v[68:71], v240 offset:3072
    ds_read_b128 v[72:75], v240 offset:2560
    v_mfma_f32_32x32x16_bf16 v[144:159], v[204:207], a[212:215], v[144:159]
    ds_read_b64_tr_b16 v[202:203], v235 offset:17408
    buffer_store_dwordx4 v[116:119], v244, s[40:43], s73 offen offset:1024 sc1
    v_mfma_f32_32x32x16_bf16 v[128:143], v[208:211], a[216:219], v[128:143]
    ds_read_b64_tr_b16 v[204:205], v234 offset:17920
    ds_read_b128 v[76:79], v240 offset:2048
    ds_read_b128 v[80:83], v240 offset:1536
    ds_read_b128 v[84:87], v240 offset:1024
    ds_read_b128 v[88:91], v240 offset:512
    v_mfma_f32_32x32x16_bf16 v[144:159], v[208:211], a[220:223], v[144:159]
    ds_read_b64_tr_b16 v[206:207], v235 offset:17920
    buffer_load_dwordx4 v224, s[40:43], s17 offen offset:1024 sc1 lds
    ds_read_b128 v[92:95], v240
    ds_read2_b32 v[36:37], v236 offset0:128 offset1:129
    s_waitcnt lgkmcnt(15)
    v_mfma_f32_32x32x16_bf16 v[128:143], v[192:195], a[224:227], v[128:143]
    ds_read2_b32 v[38:39], v236 offset0:130 offset1:131
    ds_read2_b32 v[40:41], v237 offset0:0 offset1:1
    ds_read2_b32 v[42:43], v237 offset0:2 offset1:3
    v_mfma_f32_32x32x16_bf16 v[144:159], v[192:195], a[228:231], v[144:159]
    buffer_load_dwordx4 v225, s[40:43], s17 offen offset:2048 sc1 lds
    ds_read2_b32 v[44:45], v237 offset0:128 offset1:129
    ds_read2_b32 v[46:47], v237 offset0:130 offset1:131
    v_mfma_f32_32x32x16_bf16 v[128:143], v[196:199], a[232:235], v[128:143]
    ds_read2_b32 v[48:49], v238 offset0:0 offset1:1
    ds_read2_b32 v[50:51], v238 offset0:2 offset1:3
    v_mfma_f32_32x32x16_bf16 v[144:159], v[196:199], a[236:239], v[144:159]
    ds_read2_b32 v[52:53], v238 offset0:128 offset1:129
    ds_read2_b32 v[54:55], v238 offset0:130 offset1:131
    s_waitcnt lgkmcnt(11)
    v_mfma_f32_32x32x16_bf16 v[128:143], v[200:203], a[240:243], v[128:143]
    ds_read2_b32 v[56:57], v239 offset0:0 offset1:1
    ds_read2_b32 v[58:59], v239 offset0:2 offset1:3
    v_mfma_f32_32x32x16_bf16 v[144:159], v[200:203], a[244:247], v[144:159]
    ds_read2_b32 v[60:61], v239 offset0:128 offset1:129
    ds_read2_b32 v[62:63], v239 offset0:130 offset1:131
    v_mfma_f32_32x32x16_bf16 v[128:143], v[204:207], a[248:251], v[128:143]
    v_mfma_f32_32x32x16_bf16 v[144:159], v[204:207], a[252:255], v[144:159]
    s_cmp_lt_u32 s6, 64
    s_cbranch_scc1 KF_THREE
    s_waitcnt lgkmcnt(0)
    v_mfma_f32_16x16x32_bf16 v[160:163], v[32:35], v[64:67], 0
    v_mfma_f32_16x16x32_bf16 v[164:167], v[32:35], v[68:71], 0
    s_add_u32 m0, s91, 16384
    v_mfma_f32_16x16x32_bf16 v[168:171], v[32:35], v[72:75], 0
    buffer_load_dwordx4 v222, s[40:43], s18 offen sc1 lds
    v_mfma_f32_16x16x32_bf16 v[172:175], v[32:35], v[76:79], 0
    s_nop 1
    v_mul_f32 v212, s76, v128
    v_mul_f32 v213, s76, v129
    v_mfma_f32_16x16x32_bf16 v[176:179], v[32:35], v[80:83], 0
    s_waitcnt vmcnt(18)
    s_barrier
    v_mfma_f32_16x16x32_bf16 v[180:183], v[32:35], v[84:87], 0
    s_lshl_b32 s83, s2, 2
    s_add_u32 s83, s83, 36249600
    v_mov_b32 v243, s77
    s_cmp_eq_u32 s52, 0
    s_cselect_b64 exec, 1, 0
    buffer_store_dword v243, off, s[40:43], s83 offset:1024 sc1
    s_mov_b64 exec, -1
    v_mfma_f32_16x16x32_bf16 v[184:187], v[32:35], v[88:91], 0
    buffer_load_dwordx4 v222, s[40:43], s18 offen offset:1024 sc1 lds
    v_mfma_f32_16x16x32_bf16 v[188:191], v[32:35], v[92:95], 0
    ds_read2_b32 a[192:193], v236 offset0:16 offset1:17
    ds_read2_b32 a[194:195], v236 offset0:18 offset1:19
    v_mfma_f32_16x16x32_bf16 v[164:167], v[36:39], v[64:67], v[164:167]
    ds_read_b128 a[224:227], v240 offset:3648
    ds_read_b128 a[228:231], v240 offset:3136
    v_mfma_f32_16x16x32_bf16 v[168:171], v[36:39], v[68:71], v[168:171]
    buffer_load_dwordx4 v223, s[40:43], s18 offen offset:2048 sc1 lds
    v_mfma_f32_16x16x32_bf16 v[172:175], v[36:39], v[72:75], v[172:175]
    ds_read_b128 a[232:235], v240 offset:2624
    ds_read_b128 a[236:239], v240 offset:2112
    v_mfma_f32_16x16x32_bf16 v[176:179], v[36:39], v[76:79], v[176:179]
    ds_read_b128 a[240:243], v240 offset:1600
    ds_read_b128 a[244:247], v240 offset:1088
    v_mfma_f32_16x16x32_bf16 v[180:183], v[36:39], v[80:83], v[180:183]
    v_mul_f32 v214, s76, v130
    v_mul_f32 v215, s76, v131
    v_mfma_f32_16x16x32_bf16 v[184:187], v[36:39], v[84:87], v[184:187]
    s_waitcnt vmcnt(13)
    v_cmp_ne_u32 vcc, s77, v220
    s_cbranch_vccnz SLOW_HED
BACK_HED:
    v_mfma_f32_16x16x32_bf16 v[188:191], v[36:39], v[88:91], v[188:191]
    buffer_load_dwordx4 v[0:3], v250, s[40:43], s61 offen sc1
    v_mfma_f32_16x16x32_bf16 v[168:171], v[40:43], v[64:67], v[168:171]
    ds_read_b128 a[248:251], v240 offset:576
    ds_read_b128 a[252:255], v240 offset:64
    v_mfma_f32_16x16x32_bf16 v[172:175], v[40:43], v[68:71], v[172:175]
    ds_read2_b32 a[196:197], v236 offset0:144 offset1:145
    ds_read2_b32 a[198:199], v236 offset0:146 offset1:147
    v_mfma_f32_16x16x32_bf16 v[176:179], v[40:43], v[72:75], v[176:179]
    buffer_load_dwordx4 v[4:7], v250, s[40:43], s61 offen offset:256 sc1
    v_mfma_f32_16x16x32_bf16 v[180:183], v[40:43], v[76:79], v[180:183]
    ds_read2_b32 a[200:201], v237 offset0:16 offset1:17
    ds_read2_b32 a[202:203], v237 offset0:18 offset1:19
    v_mfma_f32_16x16x32_bf16 v[184:187], v[40:43], v[80:83], v[184:187]
    v_exp_f32 v212, v212
    v_mfma_f32_16x16x32_bf16 v[188:191], v[40:43], v[84:87], v[188:191]
    ds_read2_b32 a[204:205], v237 offset0:144 offset1:145
    ds_read2_b32 a[206:207], v237 offset0:146 offset1:147
    v_mfma_f32_16x16x32_bf16 v[172:175], v[44:47], v[64:67], v[172:175]
    buffer_load_dwordx4 v[8:11], v250, s[40:43], s61 offen offset:2048 sc1
    v_mfma_f32_16x16x32_bf16 v[176:179], v[44:47], v[68:71], v[176:179]
    ds_read2_b32 a[208:209], v238 offset0:16 offset1:17
    ds_read2_b32 a[210:211], v238 offset0:18 offset1:19
    v_mfma_f32_16x16x32_bf16 v[180:183], v[44:47], v[72:75], v[180:183]
    v_exp_f32 v213, v213
    v_mfma_f32_16x16x32_bf16 v[184:187], v[44:47], v[76:79], v[184:187]
    ds_read2_b32 a[212:213], v238 offset0:144 offset1:145
    ds_read2_b32 a[214:215], v238 offset0:146 offset1:147
    v_mfma_f32_16x16x32_bf16 v[188:191], v[44:47], v[80:83], v[188:191]
    buffer_load_dwordx4 v[12:15], v250, s[40:43], s61 offen offset:2304 sc1
    v_mfma_f32_16x16x32_bf16 v[176:179], v[48:51], v[64:67], v[176:179]
    ds_read2_b32 a[216:217], v239 offset0:16 offset1:17
    ds_read2_b32 a[218:219], v239 offset0:18 offset1:19
    v_mfma_f32_16x16x32_bf16 v[180:183], v[48:51], v[68:71], v[180:183]
    v_exp_f32 v214, v214
    v_mfma_f32_16x16x32_bf16 v[184:187], v[48:51], v[72:75], v[184:187]
    ds_read2_b32 a[220:221], v239 offset0:144 offset1:145
    ds_read2_b32 a[222:223], v239 offset0:146 offset1:147
    v_mfma_f32_16x16x32_bf16 v[188:191], v[48:51], v[76:79], v[188:191]
    buffer_load_dwordx4 v[16:19], v226, s[40:43], s61 offen sc1
    v_mfma_f32_16x16x32_bf16 v[180:183], v[52:55], v[64:67], v[180:183]
    v_exp_f32 v215, v215
    v_mfma_f32_16x16x32_bf16 v[184:187], v[52:55], v[68:71], v[184:187]
    v_mul_f32 v128, v128, v132
    v_mul_f32 v129, v129, v133
    v_mfma_f32_16x16x32_bf16 v[188:191], v[52:55], v[72:75], v[188:191]
    v_mul_f32 v130, v130, v134
    v_mul_f32 v131, v131, v135
    v_mfma_f32_16x16x32_bf16 v[184:187], v[56:59], v[64:67], v[184:187]
    buffer_load_dwordx4 v[20:23], v226, s[40:43], s61 offen offset:256 sc1
    v_mfma_f32_16x16x32_bf16 v[188:191], v[56:59], v[68:71], v[188:191]
    v_add_f32 v212, 1.0, v212
    v_add_f32 v213, 1.0, v213
    v_mfma_f32_16x16x32_bf16 v[188:191], v[60:63], v[64:67], v[188:191]
    v_add_f32 v214, 1.0, v214
    s_waitcnt lgkmcnt(0)
    v_mfma_f32_16x16x32_bf16 v[160:163], a[192:195], a[224:227], v[160:163]
    v_add_f32 v215, 1.0, v215
    v_mfma_f32_16x16x32_bf16 v[164:167], a[192:195], a[228:231], v[164:167]
    buffer_load_dwordx4 v[24:27], v226, s[40:43], s61 offen offset:2048 sc1
    v_mfma_f32_16x16x32_bf16 v[168:171], a[192:195], a[232:235], v[168:171]
    ds_read2_b32 v[32:33], v236 offset0:32 offset1:33
    ds_read2_b32 v[34:35], v236 offset0:34 offset1:35
    v_mfma_f32_16x16x32_bf16 v[172:175], a[192:195], a[236:239], v[172:175]
    ds_read_b128 v[64:67], v240 offset:3712
    ds_read_b128 v[68:71], v240 offset:3200
    v_mfma_f32_16x16x32_bf16 v[176:179], a[192:195], a[240:243], v[176:179]
    v_rcp_f32 v212, v212
    v_mfma_f32_16x16x32_bf16 v[180:183], a[192:195], a[244:247], v[180:183]
    buffer_load_dwordx4 v[28:31], v226, s[40:43], s61 offen offset:2304 sc1
    v_mfma_f32_16x16x32_bf16 v[184:187], a[192:195], a[248:251], v[184:187]
    ds_read_b128 v[72:75], v240 offset:2688
    ds_read_b128 v[76:79], v240 offset:2176
    v_mfma_f32_16x16x32_bf16 v[188:191], a[192:195], a[252:255], v[188:191]
    v_rcp_f32 v213, v213
    v_mfma_f32_16x16x32_bf16 v[164:167], a[196:199], a[224:227], v[164:167]
    ds_read_b128 v[80:83], v240 offset:1664
    ds_read_b128 v[84:87], v240 offset:1152
    v_mfma_f32_16x16x32_bf16 v[168:171], a[196:199], a[228:231], v[168:171]
    buffer_load_dwordx4 a[0:3], v250, s[40:43], s62 offen sc1
    v_rcp_f32 v214, v214
    v_rcp_f32 v215, v215
    v_mul_f32 v128, v128, v212
    v_mul_f32 v129, v129, v213
    v_mul_f32 v130, v130, v214
    v_mul_f32 v131, v131, v215
    v_cvt_pk_bf16_f32 v132, v128, v129
    v_cvt_pk_bf16_f32 v133, v130, v131
    v_mfma_f32_16x16x32_bf16 v[172:175], a[196:199], a[232:235], v[172:175]
    v_mul_f32 v216, s76, v136
    v_mul_f32 v217, s76, v137
    v_mfma_f32_16x16x32_bf16 v[176:179], a[196:199], a[236:239], v[176:179]
    ds_read_b128 v[88:91], v240 offset:640
    ds_read_b128 v[92:95], v240 offset:128
    v_mfma_f32_16x16x32_bf16 v[180:183], a[196:199], a[240:243], v[180:183]
    v_mul_f32 v218, s76, v138
    v_mul_f32 v219, s76, v139
    v_mfma_f32_16x16x32_bf16 v[184:187], a[196:199], a[244:247], v[184:187]
    buffer_load_dwordx4 a[4:7], v250, s[40:43], s62 offen offset:256 sc1
    v_mfma_f32_16x16x32_bf16 v[188:191], a[196:199], a[248:251], v[188:191]
    ds_read2_b32 v[36:37], v236 offset0:160 offset1:161
    ds_read2_b32 v[38:39], v236 offset0:162 offset1:163
    v_mfma_f32_16x16x32_bf16 v[168:171], a[200:203], a[224:227], v[168:171]
    v_exp_f32 v216, v216
    v_mfma_f32_16x16x32_bf16 v[172:175], a[200:203], a[228:231], v[172:175]
    ds_read2_b32 v[40:41], v237 offset0:32 offset1:33
    ds_read2_b32 v[42:43], v237 offset0:34 offset1:35
    v_mfma_f32_16x16x32_bf16 v[176:179], a[200:203], a[232:235], v[176:179]
    buffer_load_dwordx4 a[8:11], v250, s[40:43], s62 offen offset:2048 sc1
    v_mfma_f32_16x16x32_bf16 v[180:183], a[200:203], a[236:239], v[180:183]
    ds_read2_b32 v[44:45], v237 offset0:160 offset1:161
    ds_read2_b32 v[46:47], v237 offset0:162 offset1:163
    v_mfma_f32_16x16x32_bf16 v[184:187], a[200:203], a[240:243], v[184:187]
    v_exp_f32 v217, v217
    v_mfma_f32_16x16x32_bf16 v[188:191], a[200:203], a[244:247], v[188:191]
    v_exp_f32 v218, v218
    v_mfma_f32_16x16x32_bf16 v[172:175], a[204:207], a[224:227], v[172:175]
    buffer_load_dwordx4 a[12:15], v250, s[40:43], s62 offen offset:2304 sc1
    v_mfma_f32_16x16x32_bf16 v[176:179], a[204:207], a[228:231], v[176:179]
    ds_read2_b32 v[48:49], v238 offset0:32 offset1:33
    ds_read2_b32 v[50:51], v238 offset0:34 offset1:35
    v_mfma_f32_16x16x32_bf16 v[180:183], a[204:207], a[232:235], v[180:183]
    ds_read2_b32 v[52:53], v238 offset0:160 offset1:161
    ds_read2_b32 v[54:55], v238 offset0:162 offset1:163
    v_mfma_f32_16x16x32_bf16 v[184:187], a[204:207], a[236:239], v[184:187]
    v_exp_f32 v219, v219
    v_mfma_f32_16x16x32_bf16 v[188:191], a[204:207], a[240:243], v[188:191]
    buffer_load_dwordx4 a[16:19], v226, s[40:43], s62 offen sc1
    v_mfma_f32_16x16x32_bf16 v[176:179], a[208:211], a[224:227], v[176:179]
    ds_read2_b32 v[56:57], v239 offset0:32 offset1:33
    ds_read2_b32 v[58:59], v239 offset0:34 offset1:35
    v_mfma_f32_16x16x32_bf16 v[180:183], a[208:211], a[228:231], v[180:183]
    v_mul_f32 v136, v136, v140
    v_mul_f32 v137, v137, v141
    v_mfma_f32_16x16x32_bf16 v[184:187], a[208:211], a[232:235], v[184:187]
    ds_read2_b32 v[60:61], v239 offset0:160 offset1:161
    ds_read2_b32 v[62:63], v239 offset0:162 offset1:163
    v_mfma_f32_16x16x32_bf16 v[188:191], a[208:211], a[236:239], v[188:191]
    buffer_load_dwordx4 a[20:23], v226, s[40:43], s62 offen offset:256 sc1
    v_mfma_f32_16x16x32_bf16 v[180:183], a[212:215], a[224:227], v[180:183]
    v_mul_f32 v138, v138, v142
    v_mul_f32 v139, v139, v143
    v_mfma_f32_16x16x32_bf16 v[184:187], a[212:215], a[228:231], v[184:187]
    v_add_f32 v216, 1.0, v216
    v_add_f32 v217, 1.0, v217
    v_mfma_f32_16x16x32_bf16 v[188:191], a[212:215], a[232:235], v[188:191]
    v_add_f32 v218, 1.0, v218
    v_add_f32 v219, 1.0, v219
    v_mfma_f32_16x16x32_bf16 v[184:187], a[216:219], a[224:227], v[184:187]
    buffer_load_dwordx4 a[24:27], v226, s[40:43], s62 offen offset:2048 sc1
    v_mfma_f32_16x16x32_bf16 v[188:191], a[216:219], a[228:231], v[188:191]
    v_rcp_f32 v216, v216
    v_mfma_f32_16x16x32_bf16 v[188:191], a[220:223], a[224:227], v[188:191]
    v_mul_f32 v136, v136, v216
    s_waitcnt lgkmcnt(0)
    v_mfma_f32_16x16x32_bf16 v[160:163], v[32:35], v[64:67], v[160:163]
    v_rcp_f32 v217, v217
    v_mfma_f32_16x16x32_bf16 v[164:167], v[32:35], v[68:71], v[164:167]
    buffer_load_dwordx4 a[28:31], v226, s[40:43], s62 offen offset:2304 sc1
    v_mfma_f32_16x16x32_bf16 v[168:171], v[32:35], v[72:75], v[168:171]
    ds_read2_b32 a[192:193], v236 offset0:48 offset1:49
    ds_read2_b32 a[194:195], v236 offset0:50 offset1:51
    v_mfma_f32_16x16x32_bf16 v[172:175], v[32:35], v[76:79], v[172:175]
    ds_read_b128 a[224:227], v240 offset:3776
    ds_read_b128 a[228:231], v240 offset:3264
    v_mfma_f32_16x16x32_bf16 v[176:179], v[32:35], v[80:83], v[176:179]
    v_rcp_f32 v218, v218
    v_rcp_f32 v219, v219
    v_mul_f32 v137, v137, v217
    v_mul_f32 v138, v138, v218
    v_mul_f32 v139, v139, v219
    v_cvt_pk_bf16_f32 v134, v136, v137
    v_cvt_pk_bf16_f32 v135, v138, v139
    buffer_store_dwordx4 v[132:135], v244, s[40:43], s74 offen sc1
    v_mfma_f32_16x16x32_bf16 v[180:183], v[32:35], v[84:87], v[180:183]
    buffer_load_dwordx4 v223, s[40:43], s18 offen offset:3072 sc1 lds
    v_mfma_f32_16x16x32_bf16 v[184:187], v[32:35], v[88:91], v[184:187]
    ds_read_b128 a[232:235], v240 offset:2752
    ds_read_b128 a[236:239], v240 offset:2240
    v_mfma_f32_16x16x32_bf16 v[188:191], v[32:35], v[92:95], v[188:191]
    v_mul_f32 v212, s76, v144
    v_mul_f32 v213, s76, v145
    v_mfma_f32_16x16x32_bf16 v[164:167], v[36:39], v[64:67], v[164:167]
    ds_read_b128 a[240:243], v240 offset:1728
    ds_read_b128 a[244:247], v240 offset:1216
    v_mfma_f32_16x16x32_bf16 v[168:171], v[36:39], v[68:71], v[168:171]
    s_add_u32 m0, s91, 131072
    v_mul_f32 v214, s76, v146
    v_mfma_f32_16x16x32_bf16 v[172:175], v[36:39], v[72:75], v[172:175]
    buffer_load_dwordx4 v224, s[40:43], s18 offen sc1 lds
    v_mfma_f32_16x16x32_bf16 v[176:179], v[36:39], v[76:79], v[176:179]
    ds_read_b128 a[248:251], v240 offset:704
    ds_read_b128 a[252:255], v240 offset:192
    v_mfma_f32_16x16x32_bf16 v[180:183], v[36:39], v[80:83], v[180:183]
    v_mul_f32 v215, s76, v147
    v_mul_f32 v144, v144, v148
    v_mfma_f32_16x16x32_bf16 v[184:187], v[36:39], v[84:87], v[184:187]
    buffer_load_dwordx4 v224, s[40:43], s18 offen offset:1024 sc1 lds
    v_mfma_f32_16x16x32_bf16 v[188:191], v[36:39], v[88:91], v[188:191]
    ds_read2_b32 a[196:197], v236 offset0:176 offset1:177
    ds_read2_b32 a[198:199], v236 offset0:178 offset1:179
    v_mfma_f32_16x16x32_bf16 v[168:171], v[40:43], v[64:67], v[168:171]
    v_exp_f32 v212, v212
    v_mfma_f32_16x16x32_bf16 v[172:175], v[40:43], v[68:71], v[172:175]
    ds_read2_b32 a[200:201], v237 offset0:48 offset1:49
    ds_read2_b32 a[202:203], v237 offset0:50 offset1:51
    v_mfma_f32_16x16x32_bf16 v[176:179], v[40:43], v[72:75], v[176:179]
    buffer_load_dwordx4 v225, s[40:43], s18 offen offset:2048 sc1 lds
    v_mfma_f32_16x16x32_bf16 v[180:183], v[40:43], v[76:79], v[180:183]
    ds_read2_b32 a[204:205], v237 offset0:176 offset1:177
    ds_read2_b32 a[206:207], v237 offset0:178 offset1:179
    v_mfma_f32_16x16x32_bf16 v[184:187], v[40:43], v[80:83], v[184:187]
    v_exp_f32 v213, v213
    v_mfma_f32_16x16x32_bf16 v[188:191], v[40:43], v[84:87], v[188:191]
    v_exp_f32 v214, v214
    v_mfma_f32_16x16x32_bf16 v[172:175], v[44:47], v[64:67], v[172:175]
    buffer_load_dwordx4 a[32:35], v250, s[40:43], s63 offen sc1
    v_mfma_f32_16x16x32_bf16 v[176:179], v[44:47], v[68:71], v[176:179]
    ds_read2_b32 a[208:209], v238 offset0:48 offset1:49
    ds_read2_b32 a[210:211], v238 offset0:50 offset1:51
    v_mfma_f32_16x16x32_bf16 v[180:183], v[44:47], v[72:75], v[180:183]
    ds_read2_b32 a[212:213], v238 offset0:176 offset1:177
    ds_read2_b32 a[214:215], v238 offset0:178 offset1:179
    v_mfma_f32_16x16x32_bf16 v[184:187], v[44:47], v[76:79], v[184:187]
    v_exp_f32 v215, v215
    v_mfma_f32_16x16x32_bf16 v[188:191], v[44:47], v[80:83], v[188:191]
    buffer_load_dwordx4 a[36:39], v250, s[40:43], s63 offen offset:256 sc1
    v_mfma_f32_16x16x32_bf16 v[176:179], v[48:51], v[64:67], v[176:179]
    ds_read2_b32 a[216:217], v239 offset0:48 offset1:49
    ds_read2_b32 a[218:219], v239 offset0:50 offset1:51
    v_mfma_f32_16x16x32_bf16 v[180:183], v[48:51], v[68:71], v[180:183]
    v_mul_f32 v145, v145, v149
    v_mul_f32 v146, v146, v150
    v_mfma_f32_16x16x32_bf16 v[184:187], v[48:51], v[72:75], v[184:187]
    ds_read2_b32 a[220:221], v239 offset0:176 offset1:177
    ds_read2_b32 a[222:223], v239 offset0:178 offset1:179
    v_mfma_f32_16x16x32_bf16 v[188:191], v[48:51], v[76:79], v[188:191]
    buffer_load_dwordx4 a[40:43], v250, s[40:43], s63 offen offset:2048 sc1
    v_mfma_f32_16x16x32_bf16 v[180:183], v[52:55], v[64:67], v[180:183]
    v_mul_f32 v147, v147, v151
    v_add_f32 v212, 1.0, v212
    v_mfma_f32_16x16x32_bf16 v[184:187], v[52:55], v[68:71], v[184:187]
    v_add_f32 v213, 1.0, v213
    v_add_f32 v214, 1.0, v214
    v_mfma_f32_16x16x32_bf16 v[188:191], v[52:55], v[72:75], v[188:191]
    v_add_f32 v215, 1.0, v215
    v_mfma_f32_16x16x32_bf16 v[184:187], v[56:59], v[64:67], v[184:187]
    buffer_load_dwordx4 a[44:47], v250, s[40:43], s63 offen offset:2304 sc1
    v_mfma_f32_16x16x32_bf16 v[188:191], v[56:59], v[68:71], v[188:191]
    v_rcp_f32 v212, v212
    v_mfma_f32_16x16x32_bf16 v[188:191], v[60:63], v[64:67], v[188:191]
    v_rcp_f32 v213, v213
    v_rcp_f32 v214, v214
    v_rcp_f32 v215, v215
    v_mul_f32 v144, v144, v212
    v_mul_f32 v145, v145, v213
    v_mul_f32 v146, v146, v214
    v_mul_f32 v147, v147, v215
    v_cvt_pk_bf16_f32 v148, v144, v145
    v_cvt_pk_bf16_f32 v149, v146, v147
    s_waitcnt lgkmcnt(0)
    v_mfma_f32_16x16x32_bf16 v[160:163], a[192:195], a[224:227], v[160:163]
    v_mul_f32 v216, s76, v152
    v_mul_f32 v217, s76, v153
    v_mfma_f32_16x16x32_bf16 v[164:167], a[192:195], a[228:231], v[164:167]
    buffer_load_dwordx4 a[48:51], v226, s[40:43], s63 offen sc1
    v_mfma_f32_16x16x32_bf16 v[168:171], a[192:195], a[232:235], v[168:171]
    v_mul_f32 v218, s76, v154
    v_mul_f32 v219, s76, v155
    v_mfma_f32_16x16x32_bf16 v[172:175], a[192:195], a[236:239], v[172:175]
    v_exp_f32 v216, v216
    v_mfma_f32_16x16x32_bf16 v[176:179], a[192:195], a[240:243], v[176:179]
    v_exp_f32 v217, v217
    v_mfma_f32_16x16x32_bf16 v[180:183], a[192:195], a[244:247], v[180:183]
    buffer_load_dwordx4 a[52:55], v226, s[40:43], s63 offen offset:256 sc1
    v_mfma_f32_16x16x32_bf16 v[184:187], a[192:195], a[248:251], v[184:187]
    v_exp_f32 v218, v218
    v_mfma_f32_16x16x32_bf16 v[188:191], a[192:195], a[252:255], v[188:191]
    v_exp_f32 v219, v219
    v_mfma_f32_16x16x32_bf16 v[164:167], a[196:199], a[224:227], v[164:167]
    v_mul_f32 v152, v152, v156
    v_mul_f32 v153, v153, v157
    v_mfma_f32_16x16x32_bf16 v[168:171], a[196:199], a[228:231], v[168:171]
    buffer_load_dwordx4 a[56:59], v226, s[40:43], s63 offen offset:2048 sc1
    v_mfma_f32_16x16x32_bf16 v[172:175], a[196:199], a[232:235], v[172:175]
    v_mul_f32 v154, v154, v158
    v_mul_f32 v155, v155, v159
    v_mfma_f32_16x16x32_bf16 v[176:179], a[196:199], a[236:239], v[176:179]
    v_add_f32 v216, 1.0, v216
    v_add_f32 v217, 1.0, v217
    v_mfma_f32_16x16x32_bf16 v[180:183], a[196:199], a[240:243], v[180:183]
    v_add_f32 v218, 1.0, v218
    v_add_f32 v219, 1.0, v219
    v_mfma_f32_16x16x32_bf16 v[184:187], a[196:199], a[244:247], v[184:187]
    buffer_load_dwordx4 a[60:63], v226, s[40:43], s63 offen offset:2304 sc1
    v_mfma_f32_16x16x32_bf16 v[188:191], a[196:199], a[248:251], v[188:191]
    v_rcp_f32 v216, v216
    v_mfma_f32_16x16x32_bf16 v[168:171], a[200:203], a[224:227], v[168:171]
    v_rcp_f32 v217, v217
    v_mfma_f32_16x16x32_bf16 v[172:175], a[200:203], a[228:231], v[172:175]
    v_rcp_f32 v218, v218
    v_mfma_f32_16x16x32_bf16 v[176:179], a[200:203], a[232:235], v[176:179]
    s_add_u32 m0, s91, 147456
    v_mul_f32 v152, v152, v216
    v_mfma_f32_16x16x32_bf16 v[180:183], a[200:203], a[236:239], v[180:183]
    buffer_load_dwordx4 v222, s[40:43], s19 offen sc1 lds
    v_mfma_f32_16x16x32_bf16 v[184:187], a[200:203], a[240:243], v[184:187]
    v_rcp_f32 v219, v219
    v_mfma_f32_16x16x32_bf16 v[188:191], a[200:203], a[244:247], v[188:191]
    v_mul_f32 v153, v153, v217
    v_mul_f32 v154, v154, v218
    v_mfma_f32_16x16x32_bf16 v[172:175], a[204:207], a[224:227], v[172:175]
    buffer_load_dwordx4 v222, s[40:43], s19 offen offset:1024 sc1 lds
    v_mfma_f32_16x16x32_bf16 v[176:179], a[204:207], a[228:231], v[176:179]
    v_mul_f32 v155, v155, v219
    v_cvt_pk_bf16_f32 v150, v152, v153
    v_mfma_f32_16x16x32_bf16 v[180:183], a[204:207], a[232:235], v[180:183]
    v_cvt_pk_bf16_f32 v151, v154, v155
    v_mfma_f32_16x16x32_bf16 v[184:187], a[204:207], a[236:239], v[184:187]
    buffer_store_dwordx4 v[148:151], v244, s[40:43], s75 offen sc1
    v_mfma_f32_16x16x32_bf16 v[188:191], a[204:207], a[240:243], v[188:191]
    v_mfma_f32_16x16x32_bf16 v[176:179], a[208:211], a[224:227], v[176:179]
    buffer_load_dwordx4 v223, s[40:43], s19 offen offset:2048 sc1 lds
    v_mfma_f32_16x16x32_bf16 v[180:183], a[208:211], a[228:231], v[180:183]
    s_waitcnt vmcnt(45)
    s_barrier
    v_mfma_f32_16x16x32_bf16 v[184:187], a[208:211], a[232:235], v[184:187]
    ds_read_b128 v[104:107], v244 offset:32768
    v_mfma_f32_16x16x32_bf16 v[188:191], a[208:211], a[236:239], v[188:191]
    v_mfma_f32_16x16x32_bf16 v[180:183], a[212:215], a[224:227], v[180:183]
    ds_read_b128 v[108:111], v244 offset:33792
    v_mfma_f32_16x16x32_bf16 v[184:187], a[212:215], a[228:231], v[184:187]
    buffer_load_dwordx4 v223, s[40:43], s19 offen offset:3072 sc1 lds
    v_mfma_f32_16x16x32_bf16 v[188:191], a[212:215], a[232:235], v[188:191]
    ds_read_b128 v[112:115], v244 offset:34816
    v_mfma_f32_16x16x32_bf16 v[184:187], a[216:219], a[224:227], v[184:187]
    v_mfma_f32_16x16x32_bf16 v[188:191], a[216:219], a[228:231], v[188:191]
    ds_read_b128 v[116:119], v244 offset:35840
    v_mfma_f32_16x16x32_bf16 v[188:191], a[220:223], a[224:227], v[188:191]
    s_waitcnt vmcnt(32) lgkmcnt(2)
    v_mfma_f32_16x16x32_bf16 v[48:51], v[104:107], v[0:3], 0
    ds_read_b128 v[120:123], v244 offset:36864
    v_mfma_f32_16x16x32_bf16 v[52:55], v[104:107], v[4:7], 0
    buffer_load_dwordx4 a[64:67], v250, s[40:43], s64 offen sc1
    v_mfma_f32_16x16x32_bf16 v[56:59], v[108:111], v[0:3], 0
    ds_read_b128 v[124:127], v244 offset:37888
    v_mfma_f32_16x16x32_bf16 v[60:63], v[108:111], v[4:7], 0
    s_waitcnt lgkmcnt(2)
    v_mfma_f32_16x16x32_bf16 v[64:67], v[112:115], v[0:3], 0
    ds_read_b128 v[104:107], v244 offset:38912
    v_mfma_f32_16x16x32_bf16 v[68:71], v[112:115], v[4:7], 0
    buffer_load_dwordx4 a[68:71], v250, s[40:43], s64 offen offset:256 sc1
    v_mfma_f32_16x16x32_bf16 v[72:75], v[116:119], v[0:3], 0
    ds_read_b128 v[108:111], v244 offset:39936
    v_mfma_f32_16x16x32_bf16 v[76:79], v[116:119], v[4:7], 0
    s_waitcnt vmcnt(32) lgkmcnt(2)
    v_mfma_f32_16x16x32_bf16 v[48:51], v[120:123], v[8:11], v[48:51]
    ds_read_b128 v[112:115], v244 offset:40960
    v_mfma_f32_16x16x32_bf16 v[52:55], v[120:123], v[12:15], v[52:55]
    buffer_load_dwordx4 a[72:75], v250, s[40:43], s64 offen offset:2048 sc1
    v_mfma_f32_16x16x32_bf16 v[56:59], v[124:127], v[8:11], v[56:59]
    ds_read_b128 v[116:119], v244 offset:41984
    v_mfma_f32_16x16x32_bf16 v[60:63], v[124:127], v[12:15], v[60:63]
    s_waitcnt lgkmcnt(2)
    v_mfma_f32_16x16x32_bf16 v[64:67], v[104:107], v[8:11], v[64:67]
    ds_read_b128 v[120:123], v244 offset:43008
    v_mfma_f32_16x16x32_bf16 v[68:71], v[104:107], v[12:15], v[68:71]
    buffer_load_dwordx4 a[76:79], v250, s[40:43], s64 offen offset:2304 sc1
    v_mfma_f32_16x16x32_bf16 v[72:75], v[108:111], v[8:11], v[72:75]
    ds_read_b128 v[124:127], v244 offset:44032
    v_nop
    s_bitcmp1_b32 s52, 0
    s_cbranch_scc0 SW1D
    v_swap_b32 v160, v176
    v_swap_b32 v161, v177
    v_swap_b32 v162, v178
    v_swap_b32 v163, v179
    v_swap_b32 v164, v180
    v_swap_b32 v165, v181
    v_swap_b32 v166, v182
    v_swap_b32 v167, v183
    v_swap_b32 v168, v184
    v_swap_b32 v169, v185
    v_swap_b32 v170, v186
    v_swap_b32 v171, v187
    v_swap_b32 v172, v188
    v_swap_b32 v173, v189
    v_swap_b32 v174, v190
    v_swap_b32 v175, v191
SW1D:
    ds_write_b128 v253, v[176:179]
    ds_write_b128 v253, v[180:183] offset:1024
    ds_write_b128 v253, v[184:187] offset:2048
    ds_write_b128 v253, v[188:191] offset:3072
    v_mfma_f32_16x16x32_bf16 v[76:79], v[108:111], v[12:15], v[76:79]
    s_waitcnt vmcnt(32) lgkmcnt(6)
    v_mfma_f32_16x16x32_bf16 v[48:51], v[112:115], v[16:19], v[48:51]
    ds_read_b128 v[104:107], v244 offset:45056
    s_waitcnt lgkmcnt(1)
    s_barrier
    v_mfma_f32_16x16x32_bf16 v[52:55], v[112:115], v[20:23], v[52:55]
    buffer_load_dwordx4 a[80:83], v226, s[40:43], s64 offen sc1
    v_mfma_f32_16x16x32_bf16 v[56:59], v[116:119], v[16:19], v[56:59]
    ds_read_b128 v[108:111], v244 offset:46080
    ds_read_b64 v[208:209], v241 offset:3584
    v_mfma_f32_16x16x32_bf16 v[60:63], v[116:119], v[20:23], v[60:63]
    buffer_load_dwordx4 a[84:87], v226, s[40:43], s64 offen offset:256 sc1
    v_mfma_f32_16x16x32_bf16 v[64:67], v[120:123], v[16:19], v[64:67]
    ds_read_b128 v[112:115], v244 offset:47104
    ds_read_b64 v[210:211], v241 offset:3072
    v_mfma_f32_16x16x32_bf16 v[68:71], v[120:123], v[20:23], v[68:71]
    buffer_load_dwordx4 a[88:91], v226, s[40:43], s64 offen offset:2048 sc1
    v_mfma_f32_16x16x32_bf16 v[72:75], v[124:127], v[16:19], v[72:75]
    ds_read_b128 v[116:119], v244 offset:48128
    ds_read_b64 v[212:213], v241 offset:2560
    v_mfma_f32_16x16x32_bf16 v[76:79], v[124:127], v[20:23], v[76:79]
    ds_read_b64 v[214:215], v241 offset:2048
    s_waitcnt vmcnt(33) lgkmcnt(6)
    v_mfma_f32_16x16x32_bf16 v[48:51], v[104:107], v[24:27], v[48:51]
    ds_read_b128 v[120:123], v244 offset:49152
    ds_read_b128 v[192:195], v254
    v_mfma_f32_16x16x32_bf16 v[52:55], v[104:107], v[28:31], v[52:55]
    buffer_load_dwordx4 a[92:95], v226, s[40:43], s64 offen offset:2304 sc1
    v_mfma_f32_16x16x32_bf16 v[56:59], v[108:111], v[24:27], v[56:59]
    ds_read_b128 v[124:127], v244 offset:50176
    ds_read_b128 v[196:199], v254 offset:1024
    v_mfma_f32_16x16x32_bf16 v[60:63], v[108:111], v[28:31], v[60:63]
    ds_read_b128 v[200:203], v254 offset:2048
    s_waitcnt lgkmcnt(7)
    v_mfma_f32_16x16x32_bf16 v[64:67], v[112:115], v[24:27], v[64:67]
    ds_read_b128 v[104:107], v244 offset:51200
    ds_read_b128 v[204:207], v254 offset:3072
    v_mfma_f32_16x16x32_bf16 v[68:71], v[112:115], v[28:31], v[68:71]
    buffer_load_dwordx4 a[96:99], v250, s[40:43], s65 offen sc1
    v_mfma_f32_16x16x32_bf16 v[72:75], v[116:119], v[24:27], v[72:75]
    ds_read_b128 v[108:111], v244 offset:53248
    v_mfma_f32_16x16x32_bf16 v[76:79], v[116:119], v[28:31], v[76:79]
    s_waitcnt lgkmcnt(5)
    v_mfma_f32_16x16x32_bf16 v[80:83], v[120:123], v[0:3], 0
    ds_read_b128 v[112:115], v244 offset:54272
    v_mfma_f32_16x16x32_bf16 v[84:87], v[120:123], v[4:7], 0
    buffer_load_dwordx4 a[100:103], v250, s[40:43], s65 offen offset:256 sc1
    v_mfma_f32_16x16x32_bf16 v[88:91], v[124:127], v[0:3], 0
    ds_read_b128 v[116:119], v244 offset:55296
    v_mfma_f32_16x16x32_bf16 v[92:95], v[124:127], v[4:7], 0
    s_waitcnt lgkmcnt(2)
    v_mfma_f32_16x16x32_bf16 v[96:99], v[104:107], v[0:3], 0
    ds_read_b128 v[120:123], v244 offset:57344
    v_add_f32 v160, v160, v192
    v_mfma_f32_16x16x32_bf16 v[100:103], v[104:107], v[4:7], 0
    buffer_load_dwordx4 a[104:107], v250, s[40:43], s65 offen offset:2048 sc1
    v_mfma_f32_16x16x32_bf16 v[80:83], v[108:111], v[8:11], v[80:83]
    ds_read_b128 v[124:127], v244 offset:58368
    v_add_f32 v161, v161, v193
    v_mfma_f32_16x16x32_bf16 v[84:87], v[108:111], v[12:15], v[84:87]
    v_add_f32 v162, v162, v194
    s_waitcnt lgkmcnt(2)
    v_mfma_f32_16x16x32_bf16 v[88:91], v[112:115], v[8:11], v[88:91]
    ds_read_b128 v[104:107], v244 offset:59392
    v_add_f32 v163, v163, v195
    v_mfma_f32_16x16x32_bf16 v[92:95], v[112:115], v[12:15], v[92:95]
    buffer_load_dwordx4 a[108:111], v250, s[40:43], s65 offen offset:2304 sc1
    v_mfma_f32_16x16x32_bf16 v[96:99], v[116:119], v[8:11], v[96:99]
    ds_read_b128 v[108:111], v244 offset:61440
    v_add_f32 v164, v164, v196
    v_mfma_f32_16x16x32_bf16 v[100:103], v[116:119], v[12:15], v[100:103]
    v_add_f32 v165, v165, v197
    s_waitcnt lgkmcnt(2)
    v_mfma_f32_16x16x32_bf16 v[80:83], v[120:123], v[16:19], v[80:83]
    ds_read_b128 v[112:115], v244 offset:62464
    v_add_f32 v166, v166, v198
    v_mfma_f32_16x16x32_bf16 v[84:87], v[120:123], v[20:23], v[84:87]
    buffer_load_dwordx4 a[112:115], v226, s[40:43], s65 offen sc1
    v_mfma_f32_16x16x32_bf16 v[88:91], v[124:127], v[16:19], v[88:91]
    ds_read_b128 v[116:119], v244 offset:63488
    v_add_f32 v167, v167, v199
    v_mfma_f32_16x16x32_bf16 v[92:95], v[124:127], v[20:23], v[92:95]
    s_barrier
    s_waitcnt lgkmcnt(2)
    v_mfma_f32_16x16x32_bf16 v[96:99], v[104:107], v[16:19], v[96:99]
KF_PG7:
    s_cbranch_execz KF_PG10
    ds_read_b128 v[120:123], v251
    v_add_f32 v168, v168, v200
    v_mfma_f32_16x16x32_bf16 v[100:103], v[104:107], v[20:23], v[100:103]
    buffer_load_dwordx4 a[116:119], v226, s[40:43], s65 offen offset:256 sc1
    v_mfma_f32_16x16x32_bf16 v[80:83], v[108:111], v[24:27], v[80:83]
    ds_read_b128 v[124:127], v251 offset:1024
    v_add_f32 v169, v169, v201
    v_mfma_f32_16x16x32_bf16 v[84:87], v[108:111], v[28:31], v[84:87]
    v_add_f32 v170, v170, v202
    s_waitcnt lgkmcnt(2)
    v_mfma_f32_16x16x32_bf16 v[88:91], v[112:115], v[24:27], v[88:91]
    ds_read_b128 v[104:107], v251 offset:2048
    v_add_f32 v171, v171, v203
    v_mfma_f32_16x16x32_bf16 v[92:95], v[112:115], v[28:31], v[92:95]
    s_add_u32 m0, s91, 32768
    v_add_f32 v172, v172, v204
    v_mfma_f32_16x16x32_bf16 v[96:99], v[116:119], v[24:27], v[96:99]
    ds_read_b128 v[108:111], v251 offset:3072
    v_add_f32 v173, v173, v205
    v_mfma_f32_16x16x32_bf16 v[100:103], v[116:119], v[28:31], v[100:103]
    v_add_f32 v174, v174, v206
    s_waitcnt vmcnt(38) lgkmcnt(2)
    v_mfma_f32_16x16x32_bf16 v[48:51], v[120:123], a[0:3], v[48:51]
    ds_read_b128 v[112:115], v251 offset:4096
    s_waitcnt vmcnt(16)
    v_mov_b32 v242, s77
    s_mov_b64 exec, 1
    buffer_store_dword v242, off, s[40:43], s101 offset:64 sc1
    s_mov_b64 exec, -1
    v_mfma_f32_16x16x32_bf16 v[52:55], v[120:123], a[4:7], v[52:55]
    buffer_load_dwordx4 v224, s[40:43], s19 offen sc1 lds
    v_mfma_f32_16x16x32_bf16 v[56:59], v[124:127], a[0:3], v[56:59]
    ds_read_b128 v[116:119], v251 offset:5120
    v_add_f32 v175, v175, v207
    v_mfma_f32_16x16x32_bf16 v[60:63], v[124:127], a[4:7], v[60:63]
    v_and_b32 v216, s99, v209
    s_waitcnt lgkmcnt(2)
    v_mfma_f32_16x16x32_bf16 v[64:67], v[104:107], a[0:3], v[64:67]
    ds_read_b128 v[120:123], v251 offset:6144
    v_lshlrev_b32 v217, 16, v209
    v_mfma_f32_16x16x32_bf16 v[68:71], v[104:107], a[4:7], v[68:71]
    buffer_load_dwordx4 v224, s[40:43], s19 offen offset:1024 sc1 lds
    v_mfma_f32_16x16x32_bf16 v[72:75], v[108:111], a[0:3], v[72:75]
    ds_read_b128 v[124:127], v251 offset:7168
    v_and_b32 v218, s99, v208
    v_mfma_f32_16x16x32_bf16 v[76:79], v[108:111], a[4:7], v[76:79]
    v_lshlrev_b32 v219, 16, v208
    s_waitcnt lgkmcnt(2)
    v_mfma_f32_16x16x32_bf16 v[48:51], v[112:115], a[8:11], v[48:51]
    ds_read_b128 v[104:107], v251 offset:8192
    v_fmac_f32 v160, s98, v216
    v_mfma_f32_16x16x32_bf16 v[52:55], v[112:115], a[12:15], v[52:55]
    buffer_load_dwordx4 v225, s[40:43], s19 offen offset:2048 sc1 lds
    v_mfma_f32_16x16x32_bf16 v[56:59], v[116:119], a[8:11], v[56:59]
    ds_read_b128 v[108:111], v251 offset:9216
    s_add_u32 m0, s91, 98304
    v_mfma_f32_16x16x32_bf16 v[60:63], v[116:119], a[12:15], v[60:63]
    v_fmac_f32 v161, s98, v217
    s_waitcnt lgkmcnt(2)
    v_mfma_f32_16x16x32_bf16 v[64:67], v[120:123], a[8:11], v[64:67]
    ds_read_b128 v[112:115], v251 offset:10240
    v_fmac_f32 v162, s98, v218
    v_mfma_f32_16x16x32_bf16 v[68:71], v[120:123], a[12:15], v[68:71]
    buffer_load_dwordx4 v222, s[40:43], s20 offen sc1 lds
    v_mfma_f32_16x16x32_bf16 v[72:75], v[124:127], a[8:11], v[72:75]
    ds_read_b128 v[116:119], v251 offset:11264
    v_fmac_f32 v163, s98, v219
    v_mfma_f32_16x16x32_bf16 v[76:79], v[124:127], a[12:15], v[76:79]
    v_cvt_pk_bf16_f32 v208, v160, v161
    s_waitcnt lgkmcnt(2)
    v_mfma_f32_16x16x32_bf16 v[48:51], v[104:107], a[16:19], v[48:51]
    ds_read_b128 v[120:123], v251 offset:12288
    v_cvt_pk_bf16_f32 v209, v162, v163
    v_mfma_f32_16x16x32_bf16 v[52:55], v[104:107], a[20:23], v[52:55]
    buffer_load_dwordx4 v222, s[40:43], s20 offen offset:1024 sc1 lds
    v_mfma_f32_16x16x32_bf16 v[56:59], v[108:111], a[16:19], v[56:59]
    ds_read_b128 v[124:127], v251 offset:13312
    v_and_b32 v216, s99, v211
    v_mfma_f32_16x16x32_bf16 v[60:63], v[108:111], a[20:23], v[60:63]
    v_lshlrev_b32 v217, 16, v211
    s_waitcnt lgkmcnt(2)
    v_mfma_f32_16x16x32_bf16 v[64:67], v[112:115], a[16:19], v[64:67]
    ds_read_b128 v[104:107], v251 offset:14336
    v_and_b32 v218, s99, v210
    v_mfma_f32_16x16x32_bf16 v[68:71], v[112:115], a[20:23], v[68:71]
    buffer_load_dwordx4 v223, s[40:43], s20 offen offset:2048 sc1 lds
    v_mfma_f32_16x16x32_bf16 v[72:75], v[116:119], a[16:19], v[72:75]
    ds_read_b128 v[108:111], v251 offset:15360
    v_lshlrev_b32 v219, 16, v210
    v_mfma_f32_16x16x32_bf16 v[76:79], v[116:119], a[20:23], v[76:79]
    v_fmac_f32 v164, s98, v216
    s_waitcnt lgkmcnt(2)
    v_mfma_f32_16x16x32_bf16 v[48:51], v[120:123], a[24:27], v[48:51]
    ds_read_b128 v[112:115], v251 offset:16384
    buffer_store_dwordx2 v[208:209], v249, s[40:43], s100 offen sc1
    v_mfma_f32_16x16x32_bf16 v[52:55], v[120:123], a[28:31], v[52:55]
    buffer_load_dwordx4 v223, s[40:43], s20 offen offset:3072 sc1 lds
    v_mfma_f32_16x16x32_bf16 v[56:59], v[124:127], a[24:27], v[56:59]
    ds_read_b128 v[116:119], v251 offset:17408
    s_add_u32 m0, s91, 114688
    v_mfma_f32_16x16x32_bf16 v[60:63], v[124:127], a[28:31], v[60:63]
    v_fmac_f32 v165, s98, v217
    s_waitcnt lgkmcnt(2)
    v_mfma_f32_16x16x32_bf16 v[64:67], v[104:107], a[24:27], v[64:67]
    ds_read_b128 v[120:123], v251 offset:18432
    v_fmac_f32 v166, s98, v218
    v_mfma_f32_16x16x32_bf16 v[68:71], v[104:107], a[28:31], v[68:71]
    buffer_load_dwordx4 v224, s[40:43], s20 offen sc1 lds
    v_mfma_f32_16x16x32_bf16 v[72:75], v[108:111], a[24:27], v[72:75]
    ds_read_b128 v[124:127], v251 offset:20480
    v_fmac_f32 v167, s98, v219
    v_mfma_f32_16x16x32_bf16 v[76:79], v[108:111], a[28:31], v[76:79]
    v_cvt_pk_bf16_f32 v210, v164, v165
    s_waitcnt lgkmcnt(2)
    v_mfma_f32_16x16x32_bf16 v[80:83], v[112:115], a[0:3], v[80:83]
    ds_read_b128 v[104:107], v251 offset:21504
    v_cvt_pk_bf16_f32 v211, v166, v167
    v_mfma_f32_16x16x32_bf16 v[84:87], v[112:115], a[4:7], v[84:87]
    buffer_load_dwordx4 v224, s[40:43], s20 offen offset:1024 sc1 lds
    v_mfma_f32_16x16x32_bf16 v[88:91], v[116:119], a[0:3], v[88:91]
    ds_read_b128 v[108:111], v251 offset:22528
    v_and_b32 v216, s99, v213
    v_mfma_f32_16x16x32_bf16 v[92:95], v[116:119], a[4:7], v[92:95]
    v_lshlrev_b32 v217, 16, v213
    s_waitcnt lgkmcnt(2)
    v_mfma_f32_16x16x32_bf16 v[96:99], v[120:123], a[0:3], v[96:99]
    ds_read_b128 v[112:115], v251 offset:24576
    v_and_b32 v218, s99, v212
    v_mfma_f32_16x16x32_bf16 v[100:103], v[120:123], a[4:7], v[100:103]
    buffer_load_dwordx4 v225, s[40:43], s20 offen offset:2048 sc1 lds
    v_mfma_f32_16x16x32_bf16 v[80:83], v[124:127], a[8:11], v[80:83]
    ds_read_b128 v[116:119], v251 offset:25600
    v_lshlrev_b32 v219, 16, v212
    v_mfma_f32_16x16x32_bf16 v[84:87], v[124:127], a[12:15], v[84:87]
    v_fmac_f32 v168, s98, v216
    s_waitcnt lgkmcnt(2)
    v_mfma_f32_16x16x32_bf16 v[88:91], v[104:107], a[8:11], v[88:91]
    ds_read_b128 v[120:123], v251 offset:26624
    buffer_store_dwordx2 v[210:211], v249, s[40:43], s100 offen offset:512 sc1
    v_mfma_f32_16x16x32_bf16 v[92:95], v[104:107], a[12:15], v[92:95]
    buffer_load_dwordx4 a[120:123], v226, s[40:43], s65 offen offset:2048 sc1
    v_mfma_f32_16x16x32_bf16 v[96:99], v[108:111], a[8:11], v[96:99]
    ds_read_b128 v[124:127], v251 offset:28672
    v_fmac_f32 v169, s98, v217
    v_mfma_f32_16x16x32_bf16 v[100:103], v[108:111], a[12:15], v[100:103]
    v_fmac_f32 v170, s98, v218
    s_waitcnt lgkmcnt(2)
    v_mfma_f32_16x16x32_bf16 v[80:83], v[112:115], a[16:19], v[80:83]
    ds_read_b128 v[104:107], v251 offset:29696
    v_fmac_f32 v171, s98, v219
    v_mfma_f32_16x16x32_bf16 v[84:87], v[112:115], a[20:23], v[84:87]
    buffer_load_dwordx4 a[124:127], v226, s[40:43], s65 offen offset:2304 sc1
    v_mfma_f32_16x16x32_bf16 v[88:91], v[116:119], a[16:19], v[88:91]
    ds_read_b128 v[108:111], v251 offset:30720
    v_cvt_pk_bf16_f32 v212, v168, v169
    v_mfma_f32_16x16x32_bf16 v[92:95], v[116:119], a[20:23], v[92:95]
    s_barrier
    s_waitcnt lgkmcnt(2)
    v_mfma_f32_16x16x32_bf16 v[96:99], v[120:123], a[16:19], v[96:99]
    ds_read_b128 v[112:115], v244 offset:16384
    v_cvt_pk_bf16_f32 v213, v170, v171
    v_mfma_f32_16x16x32_bf16 v[100:103], v[120:123], a[20:23], v[100:103]
    buffer_load_dwordx4 a[128:131], v250, s[40:43], s66 offen sc1
    v_mfma_f32_16x16x32_bf16 v[80:83], v[124:127], a[24:27], v[80:83]
    ds_read_b128 v[116:119], v244 offset:17408
    v_and_b32 v216, s99, v215
    v_mfma_f32_16x16x32_bf16 v[84:87], v[124:127], a[28:31], v[84:87]
    v_lshlrev_b32 v217, 16, v215
    s_waitcnt lgkmcnt(2)
    v_mfma_f32_16x16x32_bf16 v[88:91], v[104:107], a[24:27], v[88:91]
    ds_read_b128 v[120:123], v244 offset:18432
    v_and_b32 v218, s99, v214
    v_mfma_f32_16x16x32_bf16 v[92:95], v[104:107], a[28:31], v[92:95]
    buffer_load_dwordx4 a[132:135], v250, s[40:43], s66 offen offset:256 sc1
    v_mfma_f32_16x16x32_bf16 v[96:99], v[108:111], a[24:27], v[96:99]
    ds_read_b128 v[124:127], v244 offset:19456
    s_add_u32 m0, s91, 49152
    v_mfma_f32_16x16x32_bf16 v[100:103], v[108:111], a[28:31], v[100:103]
    v_lshlrev_b32 v219, 16, v214
    s_waitcnt lgkmcnt(2)
    v_mfma_f32_16x16x32_bf16 v[48:51], v[112:115], a[32:35], v[48:51]
    ds_read_b128 v[104:107], v244 offset:20480
    buffer_store_dwordx2 v[212:213], v249, s[40:43], s100 offen offset:1024 sc1
    v_mfma_f32_16x16x32_bf16 v[52:55], v[112:115], a[36:39], v[52:55]
    buffer_load_dwordx4 v222, s[40:43], s21 offen sc1 lds
    v_mfma_f32_16x16x32_bf16 v[56:59], v[116:119], a[32:35], v[56:59]
    ds_read_b128 v[108:111], v244 offset:21504
    v_fmac_f32 v172, s98, v216
    v_mfma_f32_16x16x32_bf16 v[60:63], v[116:119], a[36:39], v[60:63]
    v_fmac_f32 v173, s98, v217
    s_waitcnt lgkmcnt(2)
    v_mfma_f32_16x16x32_bf16 v[64:67], v[120:123], a[32:35], v[64:67]
    ds_read_b128 v[112:115], v244 offset:22528
    v_fmac_f32 v174, s98, v218
    v_fmac_f32 v175, s98, v219
    v_cvt_pk_bf16_f32 v214, v172, v173
    v_cvt_pk_bf16_f32 v215, v174, v175
    buffer_store_dwordx2 v[214:215], v249, s[40:43], s100 offen offset:1536 sc1
    v_mfma_f32_16x16x32_bf16 v[68:71], v[120:123], a[36:39], v[68:71]
    buffer_load_dwordx4 v222, s[40:43], s21 offen offset:1024 sc1 lds
    v_mfma_f32_16x16x32_bf16 v[72:75], v[124:127], a[32:35], v[72:75]
    ds_read_b128 v[116:119], v244 offset:23552
    v_mfma_f32_16x16x32_bf16 v[76:79], v[124:127], a[36:39], v[76:79]
    s_waitcnt lgkmcnt(2)
    v_mfma_f32_16x16x32_bf16 v[48:51], v[104:107], a[40:43], v[48:51]
    ds_read_b128 v[120:123], v244 offset:24576
    v_mfma_f32_16x16x32_bf16 v[52:55], v[104:107], a[44:47], v[52:55]
    buffer_load_dwordx4 v223, s[40:43], s21 offen offset:2048 sc1 lds
    v_mfma_f32_16x16x32_bf16 v[56:59], v[108:111], a[40:43], v[56:59]
    ds_read_b128 v[124:127], v244 offset:25600
    v_mfma_f32_16x16x32_bf16 v[60:63], v[108:111], a[44:47], v[60:63]
    s_waitcnt lgkmcnt(2)
    v_mfma_f32_16x16x32_bf16 v[64:67], v[112:115], a[40:43], v[64:67]
    ds_read_b128 v[104:107], v244 offset:26624
    v_mfma_f32_16x16x32_bf16 v[68:71], v[112:115], a[44:47], v[68:71]
    buffer_load_dwordx4 v223, s[40:43], s21 offen offset:3072 sc1 lds
    v_mfma_f32_16x16x32_bf16 v[72:75], v[116:119], a[40:43], v[72:75]
    ds_read_b128 v[108:111], v244 offset:27648
    s_add_u32 m0, s91, 65536
    v_mfma_f32_16x16x32_bf16 v[76:79], v[116:119], a[44:47], v[76:79]
    s_waitcnt lgkmcnt(2)
    v_mfma_f32_16x16x32_bf16 v[48:51], v[120:123], a[48:51], v[48:51]
    ds_read_b128 v[112:115], v244 offset:28672
    v_mfma_f32_16x16x32_bf16 v[52:55], v[120:123], a[52:55], v[52:55]
    buffer_load_dwordx4 v224, s[40:43], s21 offen sc1 lds
    v_mfma_f32_16x16x32_bf16 v[56:59], v[124:127], a[48:51], v[56:59]
    ds_read_b128 v[116:119], v244 offset:29696
    v_and_b32 v237, 15, v248
    v_mfma_f32_16x16x32_bf16 v[60:63], v[124:127], a[52:55], v[60:63]
    s_waitcnt lgkmcnt(2)
    v_mfma_f32_16x16x32_bf16 v[64:67], v[104:107], a[48:51], v[64:67]
    ds_read_b128 v[120:123], v244 offset:30720
    v_lshrrev_b32 v238, 4, v248
    v_mfma_f32_16x16x32_bf16 v[68:71], v[104:107], a[52:55], v[68:71]
    buffer_load_dwordx4 v224, s[40:43], s21 offen offset:1024 sc1 lds
    v_mfma_f32_16x16x32_bf16 v[72:75], v[108:111], a[48:51], v[72:75]
    ds_read_b128 v[124:127], v244 offset:31744
    v_lshl_add_u32 v241, v237, 6, s91
    v_mfma_f32_16x16x32_bf16 v[76:79], v[108:111], a[52:55], v[76:79]
    s_waitcnt lgkmcnt(2)
    v_mfma_f32_16x16x32_bf16 v[48:51], v[112:115], a[56:59], v[48:51]
    ds_read_b128 v[104:107], v252
    v_lshl_add_u32 v241, v238, 3, v241
    v_mfma_f32_16x16x32_bf16 v[52:55], v[112:115], a[60:63], v[52:55]
    buffer_load_dwordx4 v225, s[40:43], s21 offen offset:2048 sc1 lds
    v_mfma_f32_16x16x32_bf16 v[56:59], v[116:119], a[56:59], v[56:59]
    ds_read_b128 v[108:111], v252 offset:1024
    v_lshlrev_b32 v245, 2, v248
    v_mfma_f32_16x16x32_bf16 v[60:63], v[116:119], a[60:63], v[60:63]
    s_waitcnt lgkmcnt(2)
    v_mfma_f32_16x16x32_bf16 v[64:67], v[120:123], a[56:59], v[64:67]
    ds_read_b128 v[112:115], v252 offset:2048
    v_and_b32 v245, 48, v245
    v_mfma_f32_16x16x32_bf16 v[68:71], v[120:123], a[60:63], v[68:71]
    buffer_load_dwordx4 a[136:139], v250, s[40:43], s66 offen offset:2048 sc1
    v_mfma_f32_16x16x32_bf16 v[72:75], v[124:127], a[56:59], v[72:75]
    ds_read_b128 v[116:119], v252 offset:4096
    v_mfma_f32_16x16x32_bf16 v[76:79], v[124:127], a[60:63], v[76:79]
    v_xor_b32 v241, v241, v245
    s_waitcnt lgkmcnt(2)
    v_mfma_f32_16x16x32_bf16 v[80:83], v[104:107], a[32:35], v[80:83]
    ds_read_b128 v[120:123], v252 offset:5120
    v_mfma_f32_16x16x32_bf16 v[84:87], v[104:107], a[36:39], v[84:87]
    buffer_load_dwordx4 a[140:143], v250, s[40:43], s66 offen offset:2304 sc1
    v_mfma_f32_16x16x32_bf16 v[88:91], v[108:111], a[32:35], v[88:91]
    ds_read_b128 v[124:127], v252 offset:6144
    v_xor_b32 v245, 32, v241
    v_mfma_f32_16x16x32_bf16 v[92:95], v[108:111], a[36:39], v[92:95]
    v_add_u32 v253, s91, v244
    s_waitcnt lgkmcnt(2)
    v_mfma_f32_16x16x32_bf16 v[96:99], v[112:115], a[32:35], v[96:99]
    ds_read_b128 v[104:107], v252 offset:8192
    v_mfma_f32_16x16x32_bf16 v[100:103], v[112:115], a[36:39], v[100:103]
    buffer_load_dword v220, v255, s[40:43], s57 offen offset:64 sc1
    buffer_load_dwordx4 a[144:147], v226, s[40:43], s66 offen sc1
    v_mfma_f32_16x16x32_bf16 v[80:83], v[116:119], a[40:43], v[80:83]
    ds_read_b128 v[108:111], v252 offset:9216
    s_mov_b32 s80, 0x33333333
    v_mfma_f32_16x16x32_bf16 v[84:87], v[116:119], a[44:47], v[84:87]
    s_mov_b32 s81, 0xcccccccc
    s_waitcnt lgkmcnt(2)
    v_mfma_f32_16x16x32_bf16 v[88:91], v[120:123], a[40:43], v[88:91]
    ds_read_b128 v[112:115], v252 offset:10240
    v_mfma_f32_16x16x32_bf16 v[92:95], v[120:123], a[44:47], v[92:95]
    buffer_load_dwordx4 a[148:151], v226, s[40:43], s66 offen offset:256 sc1
    v_mfma_f32_16x16x32_bf16 v[96:99], v[124:127], a[40:43], v[96:99]
    ds_read_b128 v[116:119], v252 offset:12288
    s_add_u32 s83, s91, 3072
    v_mfma_f32_16x16x32_bf16 v[100:103], v[124:127], a[44:47], v[100:103]
    s_waitcnt lgkmcnt(2)
    v_mfma_f32_16x16x32_bf16 v[80:83], v[104:107], a[48:51], v[80:83]
    ds_read_b128 v[120:123], v252 offset:13312
    v_lshl_add_u32 v237, v237, 2, s83
    v_mfma_f32_16x16x32_bf16 v[84:87], v[104:107], a[52:55], v[84:87]
    buffer_load_dwordx4 a[152:155], v226, s[40:43], s66 offen offset:2048 sc1
    v_mfma_f32_16x16x32_bf16 v[88:91], v[108:111], a[48:51], v[88:91]
    ds_read_b128 v[124:127], v252 offset:14336
    v_lshlrev_b32 v236, 2, v248
    v_mfma_f32_16x16x32_bf16 v[92:95], v[108:111], a[52:55], v[92:95]
    s_waitcnt vmcnt(28)
    s_barrier
    s_waitcnt lgkmcnt(2)
    v_mfma_f32_16x16x32_bf16 v[96:99], v[112:115], a[48:51], v[96:99]
    ds_read_b128 v[104:107], v252 offset:16384
    v_lshrrev_b32 v238, 2, v248
    v_mfma_f32_16x16x32_bf16 v[100:103], v[112:115], a[52:55], v[100:103]
    buffer_load_dwordx4 a[156:159], v226, s[40:43], s66 offen offset:2304 sc1
    v_mfma_f32_16x16x32_bf16 v[80:83], v[116:119], a[56:59], v[80:83]
    ds_read_b128 v[108:111], v252 offset:17408
    s_add_u32 m0, s91, 16384
    v_mfma_f32_16x16x32_bf16 v[84:87], v[116:119], a[60:63], v[84:87]
    v_mul_u32_u24 v254, 1152, v238
    s_waitcnt lgkmcnt(2)
    v_mfma_f32_16x16x32_bf16 v[88:91], v[120:123], a[56:59], v[88:91]
    ds_read_b128 v[112:115], v252 offset:18432
    v_mfma_f32_16x16x32_bf16 v[92:95], v[120:123], a[60:63], v[92:95]
    buffer_load_dwordx4 v222, s[40:43], s30 offen sc1 lds
    v_mfma_f32_16x16x32_bf16 v[96:99], v[124:127], a[56:59], v[96:99]
    ds_read_b128 v[116:119], v252 offset:19456
    v_lshlrev_b32 v239, 6, v238
    v_mfma_f32_16x16x32_bf16 v[100:103], v[124:127], a[60:63], v[100:103]
    v_lshlrev_b32 v238, 12, v238
    s_waitcnt lgkmcnt(2)
    v_mfma_f32_16x16x32_bf16 v[48:51], v[104:107], a[64:67], v[48:51]
    ds_read_b128 v[120:123], v252 offset:20480
    v_mfma_f32_16x16x32_bf16 v[52:55], v[104:107], a[68:71], v[52:55]
    buffer_load_dwordx4 v222, s[40:43], s30 offen offset:1024 sc1 lds
    v_mfma_f32_16x16x32_bf16 v[56:59], v[108:111], a[64:67], v[56:59]
    ds_read_b128 v[124:127], v252 offset:21504
    s_add_u32 m0, s91, 18432
    v_mfma_f32_16x16x32_bf16 v[60:63], v[108:111], a[68:71], v[60:63]
    v_and_b32 v240, 3, v248
    s_waitcnt lgkmcnt(2)
    v_mfma_f32_16x16x32_bf16 v[64:67], v[112:115], a[64:67], v[64:67]
    ds_read_b128 v[104:107], v252 offset:22528
    v_lshl_add_u32 v238, v240, 4, v238
    v_mfma_f32_16x16x32_bf16 v[68:71], v[112:115], a[68:71], v[68:71]
    buffer_load_dwordx4 v222, s[40:43], s31 offen sc1 lds
    v_mfma_f32_16x16x32_bf16 v[72:75], v[116:119], a[64:67], v[72:75]
    ds_read_b128 v[108:111], v252 offset:23552
    v_lshl_add_u32 v239, v240, 3, v239
    v_mfma_f32_16x16x32_bf16 v[76:79], v[116:119], a[68:71], v[76:79]
    s_waitcnt lgkmcnt(2)
    v_mfma_f32_16x16x32_bf16 v[48:51], v[120:123], a[72:75], v[48:51]
    ds_read_b128 v[112:115], v252 offset:24576
    v_lshrrev_b32 v246, 4, v248
    v_mfma_f32_16x16x32_bf16 v[52:55], v[120:123], a[76:79], v[52:55]
    buffer_load_dwordx4 v222, s[40:43], s31 offen offset:1024 sc1 lds
    v_mfma_f32_16x16x32_bf16 v[56:59], v[124:127], a[72:75], v[56:59]
    ds_read_b128 v[116:119], v252 offset:25600
    s_add_u32 m0, s91, 81920
    v_mfma_f32_16x16x32_bf16 v[60:63], v[124:127], a[76:79], v[60:63]
    v_xor_b32 v240, v240, v246
    s_waitcnt lgkmcnt(2)
    v_mfma_f32_16x16x32_bf16 v[64:67], v[104:107], a[72:75], v[64:67]
    ds_read_b128 v[120:123], v252 offset:26624
    v_lshl_add_u32 v254, v240, 4, v254
    v_mfma_f32_16x16x32_bf16 v[68:71], v[104:107], a[76:79], v[68:71]
    buffer_load_dwordx4 v222, s[40:43], s89 offen sc1 lds
    v_mfma_f32_16x16x32_bf16 v[72:75], v[108:111], a[72:75], v[72:75]
    ds_read_b128 v[124:127], v252 offset:27648
    s_lshl_b32 s83, s52, 12
    v_mfma_f32_16x16x32_bf16 v[76:79], v[108:111], a[76:79], v[76:79]
    s_waitcnt lgkmcnt(2)
    v_mfma_f32_16x16x32_bf16 v[48:51], v[112:115], a[80:83], v[48:51]
    ds_read_b128 v[104:107], v252 offset:28672
    v_add_u32 v239, s83, v239
    v_mfma_f32_16x16x32_bf16 v[52:55], v[112:115], a[84:87], v[52:55]
    buffer_load_dwordx4 v222, s[40:43], s89 offen offset:1024 sc1 lds
    v_mfma_f32_16x16x32_bf16 v[56:59], v[116:119], a[80:83], v[56:59]
    ds_read_b128 v[108:111], v252 offset:29696
    s_and_b32 s83, s2, 1
    v_mfma_f32_16x16x32_bf16 v[60:63], v[116:119], a[84:87], v[60:63]
    s_waitcnt lgkmcnt(2)
    v_mfma_f32_16x16x32_bf16 v[64:67], v[120:123], a[80:83], v[64:67]
    ds_read_b128 v[112:115], v252 offset:30720
    v_mfma_f32_16x16x32_bf16 v[68:71], v[120:123], a[84:87], v[68:71]
    s_waitcnt vmcnt(10)
    v_cmp_ne_u32 vcc, s77, v220
    s_cbranch_vccnz SLOW_HLD
BACK_HLD:
    buffer_load_dwordx4 a[160:163], v250, s[40:43], s67 offen sc1
    v_mfma_f32_16x16x32_bf16 v[72:75], v[124:127], a[80:83], v[72:75]
    ds_read_b128 v[116:119], v252 offset:31744
    s_lshl_b32 s83, s83, 3
    v_mfma_f32_16x16x32_bf16 v[76:79], v[124:127], a[84:87], v[76:79]
    s_bfe_u32 s84, s2, 0x30003
    s_waitcnt lgkmcnt(2)
    v_mfma_f32_16x16x32_bf16 v[48:51], v[104:107], a[88:91], v[48:51]
    ds_read_b128 v[120:123], v244 offset:32768
    v_mfma_f32_16x16x32_bf16 v[52:55], v[104:107], a[92:95], v[52:55]
    buffer_load_dwordx4 a[164:167], v250, s[40:43], s67 offen offset:256 sc1
    v_mfma_f32_16x16x32_bf16 v[56:59], v[108:111], a[88:91], v[56:59]
    ds_read_b128 v[124:127], v244 offset:33792
    s_add_u32 s83, s83, s84
    v_mfma_f32_16x16x32_bf16 v[60:63], v[108:111], a[92:95], v[60:63]
    s_lshr_b32 s84, s2, 6
    s_waitcnt lgkmcnt(2)
    v_mfma_f32_16x16x32_bf16 v[64:67], v[112:115], a[88:91], v[64:67]
    ds_read_b128 v[104:107], v244 offset:34816
    v_mfma_f32_16x16x32_bf16 v[68:71], v[112:115], a[92:95], v[68:71]
    buffer_load_dwordx4 a[168:171], v250, s[40:43], s67 offen offset:2048 sc1
    v_mfma_f32_16x16x32_bf16 v[72:75], v[116:119], a[88:91], v[72:75]
    ds_read_b128 v[108:111], v244 offset:36864
    s_lshl_b32 s85, s83, 2
    v_mfma_f32_16x16x32_bf16 v[76:79], v[116:119], a[92:95], v[76:79]
    s_waitcnt lgkmcnt(2)
    v_mfma_f32_16x16x32_bf16 v[80:83], v[120:123], a[64:67], v[80:83]
    ds_read_b128 v[112:115], v244 offset:37888
    s_add_u32 s78, s85, s84
    v_mfma_f32_16x16x32_bf16 v[84:87], v[120:123], a[68:71], v[84:87]
    buffer_load_dwordx4 a[172:175], v250, s[40:43], s67 offen offset:2304 sc1
    v_mfma_f32_16x16x32_bf16 v[88:91], v[124:127], a[64:67], v[88:91]
    ds_read_b128 v[116:119], v244 offset:38912
    s_add_u32 s83, s85, s52
    v_mfma_f32_16x16x32_bf16 v[92:95], v[124:127], a[68:71], v[92:95]
    s_waitcnt lgkmcnt(2)
    v_mfma_f32_16x16x32_bf16 v[96:99], v[104:107], a[64:67], v[96:99]
    ds_read_b128 v[120:123], v244 offset:40960
    s_lshl_b32 s85, s78, 2
    v_mfma_f32_16x16x32_bf16 v[100:103], v[104:107], a[68:71], v[100:103]
    buffer_load_dwordx4 a[176:179], v226, s[40:43], s67 offen sc1
    v_mfma_f32_16x16x32_bf16 v[80:83], v[108:111], a[72:75], v[80:83]
    ds_read_b128 v[124:127], v244 offset:41984
    s_add_u32 s79, s85, s53
    v_mfma_f32_16x16x32_bf16 v[84:87], v[108:111], a[76:79], v[84:87]
    s_waitcnt lgkmcnt(2)
    v_mfma_f32_16x16x32_bf16 v[88:91], v[112:115], a[72:75], v[88:91]
    ds_read_b128 v[104:107], v244 offset:43008
    s_lshl_b32 s79, s79, 2
    v_mfma_f32_16x16x32_bf16 v[92:95], v[112:115], a[76:79], v[92:95]
    buffer_load_dwordx4 a[180:183], v226, s[40:43], s67 offen offset:256 sc1
    v_mfma_f32_16x16x32_bf16 v[96:99], v[116:119], a[72:75], v[96:99]
    ds_read_b128 v[108:111], v244 offset:45056
    v_mfma_f32_16x16x32_bf16 v[100:103], v[116:119], a[76:79], v[100:103]
    s_add_u32 s79, s79, s52
    s_waitcnt lgkmcnt(2)
    v_mfma_f32_16x16x32_bf16 v[80:83], v[120:123], a[80:83], v[80:83]
    ds_read_b128 v[112:115], v244 offset:46080
    v_mfma_f32_16x16x32_bf16 v[84:87], v[120:123], a[84:87], v[84:87]
    buffer_load_dwordx4 a[184:187], v226, s[40:43], s67 offen offset:2048 sc1
    v_mfma_f32_16x16x32_bf16 v[88:91], v[124:127], a[80:83], v[88:91]
    ds_read_b128 v[116:119], v244 offset:47104
    s_mul_i32 s79, s79, 6144
    v_mfma_f32_16x16x32_bf16 v[92:95], v[124:127], a[84:87], v[92:95]
    s_barrier
    s_waitcnt lgkmcnt(2)
    v_mfma_f32_16x16x32_bf16 v[96:99], v[104:107], a[80:83], v[96:99]
    ds_read_b128 v[120:123], v251 offset:32768
    s_add_u32 s72, s79, 28909568
    v_mfma_f32_16x16x32_bf16 v[100:103], v[104:107], a[84:87], v[100:103]
    buffer_load_dwordx4 a[188:191], v226, s[40:43], s67 offen offset:2304 sc1
    v_mfma_f32_16x16x32_bf16 v[80:83], v[108:111], a[88:91], v[80:83]
    ds_read_b128 v[124:127], v251 offset:33792
    s_add_u32 s59, s72, 4096
    v_mfma_f32_16x16x32_bf16 v[84:87], v[108:111], a[92:95], v[84:87]
    s_add_u32 s85, s85, s52
    s_waitcnt lgkmcnt(2)
    v_mfma_f32_16x16x32_bf16 v[88:91], v[112:115], a[88:91], v[88:91]
    ds_read_b128 v[104:107], v251 offset:34816
    v_mfma_f32_16x16x32_bf16 v[92:95], v[112:115], a[92:95], v[92:95]
    buffer_load_dwordx4 a[192:195], v250, s[40:43], s4 offen sc1
    v_mfma_f32_16x16x32_bf16 v[96:99], v[116:119], a[88:91], v[96:99]
    ds_read_b128 v[108:111], v251 offset:35840
    s_lshl_b32 s85, s85, 12
    v_mfma_f32_16x16x32_bf16 v[100:103], v[116:119], a[92:95], v[100:103]
    s_waitcnt lgkmcnt(2)
    v_mfma_f32_16x16x32_bf16 v[48:51], v[120:123], a[96:99], v[48:51]
    ds_read_b128 v[112:115], v251 offset:36864
    s_and_b32 s78, s53, 1
    v_mfma_f32_16x16x32_bf16 v[52:55], v[120:123], a[100:103], v[52:55]
    buffer_load_dwordx4 a[196:199], v250, s[40:43], s4 offen offset:256 sc1
    v_mfma_f32_16x16x32_bf16 v[56:59], v[124:127], a[96:99], v[56:59]
    ds_read_b128 v[116:119], v251 offset:37888
    s_lshl_b32 s79, s78, 3
    v_mfma_f32_16x16x32_bf16 v[60:63], v[124:127], a[100:103], v[60:63]
    s_waitcnt lgkmcnt(2)
    v_mfma_f32_16x16x32_bf16 v[64:67], v[104:107], a[96:99], v[64:67]
    ds_read_b128 v[120:123], v251 offset:38912
    s_add_u32 s85, s85, s79
    v_mfma_f32_16x16x32_bf16 v[68:71], v[104:107], a[100:103], v[68:71]
    buffer_load_dwordx4 a[200:203], v250, s[40:43], s4 offen offset:2048 sc1
    v_mfma_f32_16x16x32_bf16 v[72:75], v[108:111], a[96:99], v[72:75]
    ds_read_b128 v[124:127], v251 offset:39936
    s_add_u32 s73, s85, 35201024
    v_mfma_f32_16x16x32_bf16 v[76:79], v[108:111], a[100:103], v[76:79]
    s_waitcnt lgkmcnt(2)
    v_mfma_f32_16x16x32_bf16 v[48:51], v[112:115], a[104:107], v[48:51]
    ds_read_b128 v[104:107], v251 offset:40960
    v_mfma_f32_16x16x32_bf16 v[52:55], v[112:115], a[108:111], v[52:55]
    buffer_load_dwordx4 a[204:207], v250, s[40:43], s4 offen offset:2304 sc1
    v_mfma_f32_16x16x32_bf16 v[56:59], v[116:119], a[104:107], v[56:59]
    ds_read_b128 v[108:111], v251 offset:41984
    s_mul_i32 s84, s84, 9
    v_mfma_f32_16x16x32_bf16 v[60:63], v[116:119], a[108:111], v[60:63]
    s_lshl_b32 s85, s53, 1
    s_waitcnt lgkmcnt(2)
    v_mfma_f32_16x16x32_bf16 v[64:67], v[120:123], a[104:107], v[64:67]
    ds_read_b128 v[112:115], v251 offset:43008
    v_mfma_f32_16x16x32_bf16 v[68:71], v[120:123], a[108:111], v[68:71]
    buffer_load_dwordx4 a[208:211], v226, s[40:43], s4 offen sc1
    v_mfma_f32_16x16x32_bf16 v[72:75], v[124:127], a[104:107], v[72:75]
    ds_read_b128 v[116:119], v251 offset:44032
    s_add_u32 s85, s85, s84
    v_mfma_f32_16x16x32_bf16 v[76:79], v[124:127], a[108:111], v[76:79]
    s_add_u32 s84, s84, 8
    s_waitcnt lgkmcnt(2)
    v_mfma_f32_16x16x32_bf16 v[48:51], v[104:107], a[112:115], v[48:51]
    ds_read_b128 v[120:123], v251 offset:45056
    v_mfma_f32_16x16x32_bf16 v[52:55], v[104:107], a[116:119], v[52:55]
    buffer_load_dwordx4 a[212:215], v226, s[40:43], s4 offen offset:256 sc1
    v_mfma_f32_16x16x32_bf16 v[56:59], v[108:111], a[112:115], v[56:59]
    ds_read_b128 v[124:127], v251 offset:46080
    s_mul_i32 s79, s83, 36864
    v_mfma_f32_16x16x32_bf16 v[60:63], v[108:111], a[116:119], v[60:63]
    s_lshl_b32 s68, s85, 5
    s_waitcnt lgkmcnt(2)
    v_mfma_f32_16x16x32_bf16 v[64:67], v[112:115], a[112:115], v[64:67]
    ds_read_b128 v[104:107], v251 offset:47104
    v_mfma_f32_16x16x32_bf16 v[68:71], v[112:115], a[116:119], v[68:71]
    buffer_load_dwordx4 a[216:219], v226, s[40:43], s4 offen offset:2048 sc1
    v_mfma_f32_16x16x32_bf16 v[72:75], v[116:119], a[112:115], v[72:75]
    ds_read_b128 v[108:111], v251 offset:48128
    s_add_u32 s68, s68, s79
    v_mfma_f32_16x16x32_bf16 v[76:79], v[116:119], a[116:119], v[76:79]
    s_waitcnt lgkmcnt(2)
    v_mfma_f32_16x16x32_bf16 v[48:51], v[120:123], a[120:123], v[48:51]
    ds_read_b128 v[112:115], v251 offset:49152
    s_add_u32 s69, s68, 18432
    v_mfma_f32_16x16x32_bf16 v[52:55], v[120:123], a[124:127], v[52:55]
    buffer_load_dwordx4 a[220:223], v226, s[40:43], s4 offen offset:2304 sc1
    v_mfma_f32_16x16x32_bf16 v[56:59], v[124:127], a[120:123], v[56:59]
    ds_read_b128 v[116:119], v251 offset:50176
    s_lshl_b32 s70, s84, 5
    v_mfma_f32_16x16x32_bf16 v[60:63], v[124:127], a[124:127], v[60:63]
    s_waitcnt lgkmcnt(2)
    v_mfma_f32_16x16x32_bf16 v[64:67], v[104:107], a[120:123], v[64:67]
    ds_read_b128 v[120:123], v251 offset:51200
    s_add_u32 s70, s70, s79
    v_mfma_f32_16x16x32_bf16 v[68:71], v[104:107], a[124:127], v[68:71]
    buffer_load_dwordx4 a[224:227], v250, s[40:43], s5 offen sc1
    v_mfma_f32_16x16x32_bf16 v[72:75], v[108:111], a[120:123], v[72:75]
    ds_read_b128 v[124:127], v251 offset:53248
    s_mul_i32 s79, s78, 18432
    v_mfma_f32_16x16x32_bf16 v[76:79], v[108:111], a[124:127], v[76:79]
    s_waitcnt lgkmcnt(2)
    v_mfma_f32_16x16x32_bf16 v[80:83], v[112:115], a[96:99], v[80:83]
    ds_read_b128 v[104:107], v251 offset:54272
    v_mfma_f32_16x16x32_bf16 v[84:87], v[112:115], a[100:103], v[84:87]
    buffer_load_dwordx4 a[228:231], v250, s[40:43], s5 offen offset:256 sc1
    v_mfma_f32_16x16x32_bf16 v[88:91], v[116:119], a[96:99], v[88:91]
    ds_read_b128 v[108:111], v251 offset:55296
    buffer_load_dwordx4 v[176:179], v244, s[40:43], s58 offen offset:1024 sc1
    v_mfma_f32_16x16x32_bf16 v[92:95], v[116:119], a[100:103], v[92:95]
    s_add_u32 s70, s70, s79
    s_waitcnt lgkmcnt(2)
    v_mfma_f32_16x16x32_bf16 v[96:99], v[120:123], a[96:99], v[96:99]
    ds_read_b128 v[112:115], v251 offset:57344
    s_lshl_b32 s71, s83, 7
    v_mfma_f32_16x16x32_bf16 v[100:103], v[120:123], a[100:103], v[100:103]
    buffer_load_dwordx4 a[232:235], v250, s[40:43], s5 offen offset:2048 sc1
    v_mfma_f32_16x16x32_bf16 v[80:83], v[124:127], a[104:107], v[80:83]
    ds_read_b128 v[116:119], v251 offset:58368
    s_add_u32 s71, s71, 28901376
    v_mfma_f32_16x16x32_bf16 v[84:87], v[124:127], a[108:111], v[84:87]
    s_lshl_b32 s83, s83, 6
    s_waitcnt lgkmcnt(2)
    v_mfma_f32_16x16x32_bf16 v[88:91], v[104:107], a[104:107], v[88:91]
    ds_read_b128 v[120:123], v251 offset:59392
    v_mfma_f32_16x16x32_bf16 v[92:95], v[104:107], a[108:111], v[92:95]
    buffer_load_dwordx4 a[236:239], v250, s[40:43], s5 offen offset:2304 sc1
    v_mfma_f32_16x16x32_bf16 v[96:99], v[108:111], a[104:107], v[96:99]
    ds_read_b128 v[124:127], v251 offset:61440
    s_add_u32 m0, s91, 81920
    v_mfma_f32_16x16x32_bf16 v[100:103], v[108:111], a[108:111], v[100:103]
    s_add_u32 s83, s83, 26542080
    s_waitcnt lgkmcnt(2)
    v_mfma_f32_16x16x32_bf16 v[80:83], v[112:115], a[112:115], v[80:83]
    ds_read_b128 v[104:107], v251 offset:62464
    s_lshl_b32 s74, s85, 16
    v_mfma_f32_16x16x32_bf16 v[84:87], v[112:115], a[116:119], v[84:87]
    buffer_load_dwordx4 v223, s[40:43], s30 offen offset:2048 sc1 lds
    v_mfma_f32_16x16x32_bf16 v[88:91], v[116:119], a[112:115], v[88:91]
    ds_read_b128 v[108:111], v251 offset:63488
    s_add_u32 s74, s74, s83
    v_mfma_f32_16x16x32_bf16 v[92:95], v[116:119], a[116:119], v[92:95]
    s_barrier
    s_waitcnt lgkmcnt(2)
    v_mfma_f32_16x16x32_bf16 v[96:99], v[120:123], a[112:115], v[96:99]
KF_PG8:
    s_cbranch_execz KF_PG11
    ds_read_b128 v[112:115], v244 offset:49152
    s_lshl_b32 s75, s84, 16
    v_mfma_f32_16x16x32_bf16 v[100:103], v[120:123], a[116:119], v[100:103]
    buffer_load_dwordx4 v223, s[40:43], s30 offen offset:3072 sc1 lds
    v_mfma_f32_16x16x32_bf16 v[80:83], v[124:127], a[120:123], v[80:83]
    ds_read_b128 v[116:119], v244 offset:50176
    s_add_u32 m0, s91, 129024
    v_mfma_f32_16x16x32_bf16 v[84:87], v[124:127], a[124:127], v[84:87]
    s_add_u32 s75, s75, s83
    s_waitcnt lgkmcnt(2)
    v_mfma_f32_16x16x32_bf16 v[88:91], v[104:107], a[120:123], v[88:91]
    ds_read_b128 v[120:123], v244 offset:51200
    s_lshl_b32 s79, s78, 5
    v_mfma_f32_16x16x32_bf16 v[92:95], v[104:107], a[124:127], v[92:95]
    buffer_load_dwordx4 v223, s[40:43], s31 offen offset:2048 sc1 lds
    v_mfma_f32_16x16x32_bf16 v[96:99], v[108:111], a[120:123], v[96:99]
    ds_read_b128 v[124:127], v244 offset:52224
    v_mfma_f32_16x16x32_bf16 v[100:103], v[108:111], a[124:127], v[100:103]
    s_add_u32 s75, s75, s79
    s_waitcnt lgkmcnt(2)
    v_mfma_f32_16x16x32_bf16 v[48:51], v[112:115], a[128:131], v[48:51]
    ds_read_b128 v[104:107], v244 offset:53248
    v_mfma_f32_16x16x32_bf16 v[52:55], v[112:115], a[132:135], v[52:55]
    buffer_load_dwordx4 v223, s[40:43], s31 offen offset:3072 sc1 lds
    v_mfma_f32_16x16x32_bf16 v[56:59], v[116:119], a[128:131], v[56:59]
    ds_read_b128 v[108:111], v244 offset:54272
    s_add_u32 m0, s91, 131072
    v_mfma_f32_16x16x32_bf16 v[60:63], v[116:119], a[132:135], v[60:63]
    s_lshl_b32 s79, s78, 6
    s_waitcnt lgkmcnt(2)
    v_mfma_f32_16x16x32_bf16 v[64:67], v[120:123], a[128:131], v[64:67]
    ds_read_b128 v[112:115], v244 offset:55296
    v_add_u32 v249, s79, v237
    v_mfma_f32_16x16x32_bf16 v[68:71], v[120:123], a[132:135], v[68:71]
    buffer_load_dwordx4 v223, s[40:43], s89 offen offset:2048 sc1 lds
    v_mfma_f32_16x16x32_bf16 v[72:75], v[124:127], a[128:131], v[72:75]
    ds_read_b128 v[116:119], v244 offset:56320
    s_mov_b64 s[44:45], s[26:27]
    v_mfma_f32_16x16x32_bf16 v[76:79], v[124:127], a[132:135], v[76:79]
    s_mov_b32 s46, 2359296
    s_waitcnt lgkmcnt(2)
    v_mfma_f32_16x16x32_bf16 v[48:51], v[104:107], a[136:139], v[48:51]
    ds_read_b128 v[120:123], v244 offset:57344
    v_mfma_f32_16x16x32_bf16 v[52:55], v[104:107], a[140:143], v[52:55]
    buffer_load_dwordx4 v223, s[40:43], s89 offen offset:3072 sc1 lds
    v_mfma_f32_16x16x32_bf16 v[56:59], v[108:111], a[136:139], v[56:59]
    ds_read_b128 v[124:127], v244 offset:58368
    v_mfma_f32_16x16x32_bf16 v[60:63], v[108:111], a[140:143], v[60:63]
    s_waitcnt lgkmcnt(2)
    v_mfma_f32_16x16x32_bf16 v[64:67], v[112:115], a[136:139], v[64:67]
    ds_read_b128 v[104:107], v244 offset:59392
    v_mfma_f32_16x16x32_bf16 v[68:71], v[112:115], a[140:143], v[68:71]
    buffer_load_dwordx4 a[240:243], v226, s[40:43], s5 offen sc1
    v_mfma_f32_16x16x32_bf16 v[72:75], v[116:119], a[136:139], v[72:75]
    ds_read_b128 v[108:111], v244 offset:60416
    v_mfma_f32_16x16x32_bf16 v[76:79], v[116:119], a[140:143], v[76:79]
    s_waitcnt vmcnt(36) lgkmcnt(2)
    v_mfma_f32_16x16x32_bf16 v[48:51], v[120:123], a[144:147], v[48:51]
    ds_read_b128 v[112:115], v244 offset:61440
    v_mfma_f32_16x16x32_bf16 v[52:55], v[120:123], a[148:151], v[52:55]
    buffer_load_dwordx4 a[244:247], v226, s[40:43], s5 offen offset:256 sc1
    v_mfma_f32_16x16x32_bf16 v[56:59], v[124:127], a[144:147], v[56:59]
    ds_read_b128 v[116:119], v244 offset:62464
    v_mfma_f32_16x16x32_bf16 v[60:63], v[124:127], a[148:151], v[60:63]
    s_waitcnt lgkmcnt(2)
    v_mfma_f32_16x16x32_bf16 v[64:67], v[104:107], a[144:147], v[64:67]
    ds_read_b128 v[120:123], v244 offset:63488
    v_mfma_f32_16x16x32_bf16 v[68:71], v[104:107], a[148:151], v[68:71]
    buffer_load_dwordx4 a[248:251], v226, s[40:43], s5 offen offset:2048 sc1
    v_mfma_f32_16x16x32_bf16 v[72:75], v[108:111], a[144:147], v[72:75]
    ds_read_b128 v[124:127], v244 offset:64512
    v_mfma_f32_16x16x32_bf16 v[76:79], v[108:111], a[148:151], v[76:79]
    s_waitcnt vmcnt(36) lgkmcnt(2)
    v_mfma_f32_16x16x32_bf16 v[48:51], v[112:115], a[152:155], v[48:51]
    ds_read_b128 v[104:107], v251
    v_mfma_f32_16x16x32_bf16 v[52:55], v[112:115], a[156:159], v[52:55]
    buffer_load_dwordx4 a[252:255], v226, s[40:43], s5 offen offset:2304 sc1
    v_mfma_f32_16x16x32_bf16 v[56:59], v[116:119], a[152:155], v[56:59]
    ds_read_b128 v[108:111], v251 offset:1024
    s_add_u32 m0, s91, 147456
    v_mfma_f32_16x16x32_bf16 v[60:63], v[116:119], a[156:159], v[60:63]
    s_waitcnt lgkmcnt(2)
    v_mfma_f32_16x16x32_bf16 v[64:67], v[120:123], a[152:155], v[64:67]
    ds_read_b128 v[112:115], v251 offset:2048
    v_mfma_f32_16x16x32_bf16 v[68:71], v[120:123], a[156:159], v[68:71]
    buffer_load_dwordx4 v224, s[40:43], s30 offen sc1 lds
    v_mfma_f32_16x16x32_bf16 v[72:75], v[124:127], a[152:155], v[72:75]
    ds_read_b128 v[116:119], v251 offset:4096
    v_mfma_f32_16x16x32_bf16 v[76:79], v[124:127], a[156:159], v[76:79]
    s_waitcnt lgkmcnt(2)
    v_mfma_f32_16x16x32_bf16 v[80:83], v[104:107], a[128:131], v[80:83]
    ds_read_b128 v[120:123], v251 offset:5120
    v_mfma_f32_16x16x32_bf16 v[84:87], v[104:107], a[132:135], v[84:87]
    buffer_load_dwordx4 v224, s[40:43], s30 offen offset:1024 sc1 lds
    v_mfma_f32_16x16x32_bf16 v[88:91], v[108:111], a[128:131], v[88:91]
    ds_read_b128 v[124:127], v251 offset:6144
    v_mfma_f32_16x16x32_bf16 v[92:95], v[108:111], a[132:135], v[92:95]
    s_waitcnt lgkmcnt(2)
    v_mfma_f32_16x16x32_bf16 v[96:99], v[112:115], a[128:131], v[96:99]
    ds_read_b128 v[104:107], v251 offset:8192
    v_mfma_f32_16x16x32_bf16 v[100:103], v[112:115], a[132:135], v[100:103]
    buffer_load_dwordx4 v225, s[40:43], s30 offen offset:2048 sc1 lds
    v_mfma_f32_16x16x32_bf16 v[80:83], v[116:119], a[136:139], v[80:83]
    ds_read_b128 v[108:111], v251 offset:9216
    s_mov_b32 m0, s91
    v_mfma_f32_16x16x32_bf16 v[84:87], v[116:119], a[140:143], v[84:87]
    s_waitcnt lgkmcnt(2)
    v_mfma_f32_16x16x32_bf16 v[88:91], v[120:123], a[136:139], v[88:91]
    ds_read_b128 v[112:115], v251 offset:10240
    v_mfma_f32_16x16x32_bf16 v[92:95], v[120:123], a[140:143], v[92:95]
    buffer_load_dwordx4 v254, s[32:35], s68 offen lds
    v_mfma_f32_16x16x32_bf16 v[96:99], v[124:127], a[136:139], v[96:99]
    ds_read_b128 v[116:119], v251 offset:12288
    v_mfma_f32_16x16x32_bf16 v[100:103], v[124:127], a[140:143], v[100:103]
    s_waitcnt lgkmcnt(2)
    v_mfma_f32_16x16x32_bf16 v[80:83], v[104:107], a[144:147], v[80:83]
    ds_read_b128 v[120:123], v251 offset:13312
    s_add_u32 m0, s91, 1024
    v_mfma_f32_16x16x32_bf16 v[84:87], v[104:107], a[148:151], v[84:87]
    v_mfma_f32_16x16x32_bf16 v[88:91], v[108:111], a[144:147], v[88:91]
    ds_read_b128 v[124:127], v251 offset:14336
    v_mfma_f32_16x16x32_bf16 v[92:95], v[108:111], a[148:151], v[92:95]
    s_waitcnt vmcnt(35)
    s_barrier
    s_waitcnt lgkmcnt(2)
    v_mfma_f32_16x16x32_bf16 v[96:99], v[112:115], a[144:147], v[96:99]
    ds_read_b128 v[104:107], v244 offset:16384
    v_mfma_f32_16x16x32_bf16 v[100:103], v[112:115], a[148:151], v[100:103]
    buffer_load_dwordx4 v254, s[32:35], s69 offen lds
    v_mfma_f32_16x16x32_bf16 v[80:83], v[116:119], a[152:155], v[80:83]
    ds_read_b128 v[108:111], v244 offset:17408
    s_add_u32 m0, s91, 2048
    v_mfma_f32_16x16x32_bf16 v[84:87], v[116:119], a[156:159], v[84:87]
    s_waitcnt lgkmcnt(2)
    v_mfma_f32_16x16x32_bf16 v[88:91], v[120:123], a[152:155], v[88:91]
    ds_read_b128 v[112:115], v244 offset:20480
    v_mfma_f32_16x16x32_bf16 v[92:95], v[120:123], a[156:159], v[92:95]
    buffer_load_dwordx4 v254, s[32:35], s70 offen lds
    v_mfma_f32_16x16x32_bf16 v[96:99], v[124:127], a[152:155], v[96:99]
    ds_read_b128 v[116:119], v244 offset:21504
    v_mfma_f32_16x16x32_bf16 v[100:103], v[124:127], a[156:159], v[100:103]
    s_waitcnt vmcnt(35) lgkmcnt(2)
    v_mfma_f32_16x16x32_bf16 v[48:51], v[104:107], a[160:163], v[48:51]
    ds_read_b128 v[120:123], v244 offset:24576
    s_add_u32 m0, s91, 3072
    v_mfma_f32_16x16x32_bf16 v[52:55], v[104:107], a[164:167], v[52:55]
    v_mfma_f32_16x16x32_bf16 v[56:59], v[108:111], a[160:163], v[56:59]
    ds_read_b128 v[124:127], v244 offset:25600
    v_mfma_f32_16x16x32_bf16 v[60:63], v[108:111], a[164:167], v[60:63]
    s_waitcnt vmcnt(33) lgkmcnt(2)
    v_mfma_f32_16x16x32_bf16 v[48:51], v[112:115], a[168:171], v[48:51]
    ds_read_b128 v[104:107], v244 offset:28672
    v_mfma_f32_16x16x32_bf16 v[52:55], v[112:115], a[172:175], v[52:55]
    s_mov_b32 exec_hi, 0
    buffer_load_dword v236, s[40:43], s71 offen sc1 lds
    s_mov_b64 exec, -1
    s_add_u32 m0, s91, 32768
    s_nop 0
    buffer_load_dwordx4 v224, s[40:43], s31 offen sc1 lds
    v_mfma_f32_16x16x32_bf16 v[56:59], v[116:119], a[168:171], v[56:59]
    ds_read_b128 v[108:111], v244 offset:29696
    v_mfma_f32_16x16x32_bf16 v[60:63], v[116:119], a[172:175], v[60:63]
    s_waitcnt vmcnt(33) lgkmcnt(2)
    v_mfma_f32_16x16x32_bf16 v[48:51], v[120:123], a[176:179], v[48:51]
    ds_read_b128 v[112:115], v244 offset:18432
    v_mfma_f32_16x16x32_bf16 v[52:55], v[120:123], a[180:183], v[52:55]
    buffer_load_dwordx4 v224, s[40:43], s31 offen offset:1024 sc1 lds
    v_mfma_f32_16x16x32_bf16 v[56:59], v[124:127], a[176:179], v[56:59]
    ds_read_b128 v[116:119], v244 offset:19456
    v_mfma_f32_16x16x32_bf16 v[60:63], v[124:127], a[180:183], v[60:63]
    s_waitcnt vmcnt(32) lgkmcnt(2)
    v_mfma_f32_16x16x32_bf16 v[48:51], v[104:107], a[184:187], v[48:51]
    ds_read_b128 v[120:123], v244 offset:22528
    v_mfma_f32_16x16x32_bf16 v[52:55], v[104:107], a[188:191], v[52:55]
    buffer_load_dwordx4 v225, s[40:43], s31 offen offset:2048 sc1 lds
    v_mfma_f32_16x16x32_bf16 v[56:59], v[108:111], a[184:187], v[56:59]
    ds_read_b128 v[124:127], v244 offset:23552
    s_add_u32 m0, s91, 98304
    v_mfma_f32_16x16x32_bf16 v[60:63], v[108:111], a[188:191], v[60:63]
    s_waitcnt vmcnt(31) lgkmcnt(2)
    v_mfma_f32_16x16x32_bf16 v[48:51], v[112:115], a[192:195], v[48:51]
    ds_read_b128 v[104:107], v244 offset:26624
    v_mfma_f32_16x16x32_bf16 v[52:55], v[112:115], a[196:199], v[52:55]
    buffer_load_dwordx4 v224, s[40:43], s89 offen sc1 lds
    v_mfma_f32_16x16x32_bf16 v[56:59], v[116:119], a[192:195], v[56:59]
    ds_read_b128 v[108:111], v244 offset:27648
    v_mfma_f32_16x16x32_bf16 v[60:63], v[116:119], a[196:199], v[60:63]
    s_waitcnt vmcnt(30) lgkmcnt(2)
    v_mfma_f32_16x16x32_bf16 v[48:51], v[120:123], a[200:203], v[48:51]
    ds_read_b128 v[112:115], v244 offset:30720
    v_mfma_f32_16x16x32_bf16 v[52:55], v[120:123], a[204:207], v[52:55]
    buffer_load_dwordx4 v224, s[40:43], s89 offen offset:1024 sc1 lds
    v_mfma_f32_16x16x32_bf16 v[56:59], v[124:127], a[200:203], v[56:59]
    ds_read_b128 v[116:119], v244 offset:31744
    v_mfma_f32_16x16x32_bf16 v[60:63], v[124:127], a[204:207], v[60:63]
    s_waitcnt vmcnt(29) lgkmcnt(2)
    v_mfma_f32_16x16x32_bf16 v[48:51], v[104:107], a[208:211], v[48:51]
    ds_read_b128 v[120:123], v251 offset:16384
    v_mfma_f32_16x16x32_bf16 v[52:55], v[104:107], a[212:215], v[52:55]
    buffer_load_dwordx4 v225, s[40:43], s89 offen offset:2048 sc1 lds
    v_mfma_f32_16x16x32_bf16 v[56:59], v[108:111], a[208:211], v[56:59]
    ds_read_b128 v[124:127], v251 offset:17408
    s_add_u32 m0, s91, 49152
    v_mfma_f32_16x16x32_bf16 v[60:63], v[108:111], a[212:215], v[60:63]
    s_waitcnt vmcnt(28) lgkmcnt(2)
    v_mfma_f32_16x16x32_bf16 v[48:51], v[112:115], a[216:219], v[48:51]
    ds_read_b128 v[104:107], v251 offset:20480
    v_mfma_f32_16x16x32_bf16 v[52:55], v[112:115], a[220:223], v[52:55]
    buffer_load_dwordx4 v221, s[40:43], s16 offen sc1 lds
    v_mfma_f32_16x16x32_bf16 v[56:59], v[116:119], a[216:219], v[56:59]
    ds_read_b128 v[108:111], v251 offset:21504
    v_mfma_f32_16x16x32_bf16 v[60:63], v[116:119], a[220:223], v[60:63]
    s_waitcnt vmcnt(27) lgkmcnt(2)
    v_mfma_f32_16x16x32_bf16 v[48:51], v[120:123], a[224:227], v[48:51]
    ds_read_b128 v[112:115], v251 offset:24576
    v_mfma_f32_16x16x32_bf16 v[52:55], v[120:123], a[228:231], v[52:55]
    buffer_load_dwordx4 v221, s[40:43], s16 offen offset:1024 sc1 lds
    v_mfma_f32_16x16x32_bf16 v[56:59], v[124:127], a[224:227], v[56:59]
    ds_read_b128 v[116:119], v251 offset:25600
    s_add_u32 m0, s91, 51200
    v_mfma_f32_16x16x32_bf16 v[60:63], v[124:127], a[228:231], v[60:63]
    s_waitcnt vmcnt(25) lgkmcnt(2)
    v_mfma_f32_16x16x32_bf16 v[48:51], v[104:107], a[232:235], v[48:51]
    ds_read_b128 v[120:123], v251 offset:28672
    v_mfma_f32_16x16x32_bf16 v[52:55], v[104:107], a[236:239], v[52:55]
    buffer_load_dwordx4 v221, s[40:43], s17 offen sc1 lds
    v_mfma_f32_16x16x32_bf16 v[56:59], v[108:111], a[232:235], v[56:59]
    ds_read_b128 v[124:127], v251 offset:29696
    v_mfma_f32_16x16x32_bf16 v[60:63], v[108:111], a[236:239], v[60:63]
    s_waitcnt vmcnt(20)
    s_barrier
    s_waitcnt vmcnt(18) lgkmcnt(2)
    v_mfma_f32_16x16x32_bf16 v[48:51], v[112:115], a[240:243], v[48:51]
    ds_read_b128 v[104:107], v251 offset:18432
    v_mfma_f32_16x16x32_bf16 v[52:55], v[112:115], a[244:247], v[52:55]
    buffer_load_dwordx4 v221, s[40:43], s17 offen offset:1024 sc1 lds
    v_mfma_f32_16x16x32_bf16 v[56:59], v[116:119], a[240:243], v[56:59]
    ds_read_b128 v[108:111], v251 offset:19456
    s_add_u32 m0, s91, 114688
    v_mfma_f32_16x16x32_bf16 v[60:63], v[116:119], a[244:247], v[60:63]
    s_waitcnt vmcnt(17) lgkmcnt(2)
    v_mfma_f32_16x16x32_bf16 v[48:51], v[120:123], a[248:251], v[48:51]
    ds_read_b128 v[112:115], v251 offset:22528
    v_mfma_f32_16x16x32_bf16 v[52:55], v[120:123], a[252:255], v[52:55]
    buffer_load_dwordx4 v221, s[40:43], s18 offen sc1 lds
    v_mfma_f32_16x16x32_bf16 v[56:59], v[124:127], a[248:251], v[56:59]
    ds_read_b128 v[116:119], v251 offset:23552
    v_mfma_f32_16x16x32_bf16 v[60:63], v[124:127], a[252:255], v[60:63]
    s_nop 1
    v_cvt_pk_bf16_f32 v48, v48, v49
    s_waitcnt lgkmcnt(2)
    v_mfma_f32_16x16x32_bf16 v[64:67], v[104:107], a[160:163], v[64:67]
    ds_read_b128 v[120:123], v251 offset:26624
    v_cvt_pk_bf16_f32 v49, v50, v51
    v_mfma_f32_16x16x32_bf16 v[68:71], v[104:107], a[164:167], v[68:71]
    buffer_load_dwordx4 v221, s[40:43], s18 offen offset:1024 sc1 lds
    v_mfma_f32_16x16x32_bf16 v[72:75], v[108:111], a[160:163], v[72:75]
    ds_read_b128 v[124:127], v251 offset:27648
    s_add_u32 m0, s91, 116736
    v_mfma_f32_16x16x32_bf16 v[76:79], v[108:111], a[164:167], v[76:79]
    v_cvt_pk_bf16_f32 v50, v52, v53
    s_waitcnt lgkmcnt(2)
    v_mfma_f32_16x16x32_bf16 v[64:67], v[112:115], a[168:171], v[64:67]
    ds_read_b128 v[104:107], v251 offset:30720
    v_cvt_pk_bf16_f32 v51, v54, v55
    v_mfma_f32_16x16x32_bf16 v[68:71], v[112:115], a[172:175], v[68:71]
    buffer_load_dwordx4 v221, s[40:43], s19 offen sc1 lds
    v_mfma_f32_16x16x32_bf16 v[72:75], v[116:119], a[168:171], v[72:75]
    ds_read_b128 v[108:111], v251 offset:31744
    v_mfma_f32_16x16x32_bf16 v[76:79], v[116:119], a[172:175], v[76:79]
    buffer_store_dwordx4 v[48:51], v244, s[40:43], s93 offen sc1
    s_waitcnt lgkmcnt(2)
    v_mfma_f32_16x16x32_bf16 v[64:67], v[120:123], a[176:179], v[64:67]
    ds_read_b128 v[112:115], v252
    v_cvt_pk_bf16_f32 v56, v56, v57
    v_mfma_f32_16x16x32_bf16 v[68:71], v[120:123], a[180:183], v[68:71]
    buffer_load_dwordx4 v221, s[40:43], s19 offen offset:1024 sc1 lds
    v_mfma_f32_16x16x32_bf16 v[72:75], v[124:127], a[176:179], v[72:75]
    ds_read_b128 v[116:119], v252 offset:1024
    v_cvt_pk_bf16_f32 v57, v58, v59
    v_mfma_f32_16x16x32_bf16 v[76:79], v[124:127], a[180:183], v[76:79]
    s_add_u32 m0, s91, 16384
    s_waitcnt lgkmcnt(2)
    v_mfma_f32_16x16x32_bf16 v[64:67], v[104:107], a[184:187], v[64:67]
    ds_read_b128 v[120:123], v252 offset:4096
    v_cvt_pk_bf16_f32 v58, v60, v61
    v_cvt_pk_bf16_f32 v59, v62, v63
    buffer_store_dwordx4 v[56:59], v244, s[40:43], s93 offen offset:1024 sc1
    v_mfma_f32_16x16x32_bf16 v[68:71], v[104:107], a[188:191], v[68:71]
    buffer_load_dwordx4 v221, s[40:43], s20 offen sc1 lds
    v_mfma_f32_16x16x32_bf16 v[72:75], v[108:111], a[184:187], v[72:75]
    ds_read_b128 v[124:127], v252 offset:5120
    v_mfma_f32_16x16x32_bf16 v[76:79], v[108:111], a[188:191], v[76:79]
    s_waitcnt lgkmcnt(2)
    v_mfma_f32_16x16x32_bf16 v[64:67], v[112:115], a[192:195], v[64:67]
    ds_read_b128 v[104:107], v252 offset:8192
    v_mfma_f32_16x16x32_bf16 v[68:71], v[112:115], a[196:199], v[68:71]
    buffer_load_dwordx4 v221, s[40:43], s20 offen offset:1024 sc1 lds
    v_mfma_f32_16x16x32_bf16 v[72:75], v[116:119], a[192:195], v[72:75]
    ds_read_b128 v[108:111], v252 offset:9216
    s_add_u32 m0, s91, 18432
    v_mfma_f32_16x16x32_bf16 v[76:79], v[116:119], a[196:199], v[76:79]
    s_waitcnt lgkmcnt(2)
    v_mfma_f32_16x16x32_bf16 v[64:67], v[120:123], a[200:203], v[64:67]
    ds_read_b128 v[112:115], v252 offset:12288
    v_mfma_f32_16x16x32_bf16 v[68:71], v[120:123], a[204:207], v[68:71]
    buffer_load_dwordx4 v221, s[40:43], s21 offen sc1 lds
    v_mfma_f32_16x16x32_bf16 v[72:75], v[124:127], a[200:203], v[72:75]
    ds_read_b128 v[116:119], v252 offset:13312
    v_mfma_f32_16x16x32_bf16 v[76:79], v[124:127], a[204:207], v[76:79]
    s_waitcnt lgkmcnt(2)
    v_mfma_f32_16x16x32_bf16 v[64:67], v[104:107], a[208:211], v[64:67]
    ds_read_b128 v[120:123], v252 offset:2048
    v_mfma_f32_16x16x32_bf16 v[68:71], v[104:107], a[212:215], v[68:71]
    buffer_load_dwordx4 v221, s[40:43], s21 offen offset:1024 sc1 lds
    v_mfma_f32_16x16x32_bf16 v[72:75], v[108:111], a[208:211], v[72:75]
    ds_read_b128 v[124:127], v252 offset:3072
    s_add_u32 m0, s91, 65536
    v_mfma_f32_16x16x32_bf16 v[76:79], v[108:111], a[212:215], v[76:79]
    s_waitcnt lgkmcnt(2)
    v_mfma_f32_16x16x32_bf16 v[64:67], v[112:115], a[216:219], v[64:67]
    ds_read_b128 v[104:107], v252 offset:6144
    v_mfma_f32_16x16x32_bf16 v[68:71], v[112:115], a[220:223], v[68:71]
    buffer_load_dwordx4 v221, s[40:43], s30 offen sc1 lds
    v_mfma_f32_16x16x32_bf16 v[72:75], v[116:119], a[216:219], v[72:75]
    ds_read_b128 v[108:111], v252 offset:7168
    v_mfma_f32_16x16x32_bf16 v[76:79], v[116:119], a[220:223], v[76:79]
    s_waitcnt lgkmcnt(2)
    v_mfma_f32_16x16x32_bf16 v[64:67], v[120:123], a[224:227], v[64:67]
    ds_read_b128 v[112:115], v252 offset:10240
    v_mfma_f32_16x16x32_bf16 v[68:71], v[120:123], a[228:231], v[68:71]
    buffer_load_dwordx4 v221, s[40:43], s30 offen offset:1024 sc1 lds
    v_mfma_f32_16x16x32_bf16 v[72:75], v[124:127], a[224:227], v[72:75]
    ds_read_b128 v[116:119], v252 offset:11264
    s_add_u32 m0, s91, 67584
    v_mfma_f32_16x16x32_bf16 v[76:79], v[124:127], a[228:231], v[76:79]
    s_waitcnt lgkmcnt(2)
    v_mfma_f32_16x16x32_bf16 v[64:67], v[104:107], a[232:235], v[64:67]
    ds_read_b128 v[120:123], v252 offset:14336
    v_mfma_f32_16x16x32_bf16 v[68:71], v[104:107], a[236:239], v[68:71]
    buffer_load_dwordx4 v221, s[40:43], s31 offen sc1 lds
    v_mfma_f32_16x16x32_bf16 v[72:75], v[108:111], a[232:235], v[72:75]
    ds_read_b128 v[124:127], v252 offset:15360
    v_mfma_f32_16x16x32_bf16 v[76:79], v[108:111], a[236:239], v[76:79]
    s_waitcnt vmcnt(17)
    s_barrier
    s_waitcnt lgkmcnt(2)
    v_mfma_f32_16x16x32_bf16 v[64:67], v[112:115], a[240:243], v[64:67]
    ds_read_b128 v[104:107], v252 offset:16384
    v_mfma_f32_16x16x32_bf16 v[68:71], v[112:115], a[244:247], v[68:71]
    buffer_load_dwordx4 v221, s[40:43], s31 offen offset:1024 sc1 lds
    v_mfma_f32_16x16x32_bf16 v[72:75], v[116:119], a[240:243], v[72:75]
    ds_read_b128 v[108:111], v252 offset:17408
    s_add_u32 m0, s91, 81920
    v_mfma_f32_16x16x32_bf16 v[76:79], v[116:119], a[244:247], v[76:79]
    s_waitcnt lgkmcnt(2)
    v_mfma_f32_16x16x32_bf16 v[64:67], v[120:123], a[248:251], v[64:67]
    ds_read_b128 v[112:115], v252 offset:18432
    v_mfma_f32_16x16x32_bf16 v[68:71], v[120:123], a[252:255], v[68:71]
    buffer_load_dwordx4 v221, s[40:43], s89 offen sc1 lds
    v_mfma_f32_16x16x32_bf16 v[72:75], v[124:127], a[248:251], v[72:75]
    ds_read_b128 v[116:119], v252 offset:20480
    v_mfma_f32_16x16x32_bf16 v[76:79], v[124:127], a[252:255], v[76:79]
    s_nop 1
    v_cvt_pk_bf16_f32 v64, v64, v65
    s_waitcnt lgkmcnt(2)
    v_mfma_f32_16x16x32_bf16 v[80:83], v[104:107], a[160:163], v[80:83]
    ds_read_b128 v[120:123], v252 offset:21504
    v_cvt_pk_bf16_f32 v65, v66, v67
    v_mfma_f32_16x16x32_bf16 v[84:87], v[104:107], a[164:167], v[84:87]
    buffer_load_dwordx4 v221, s[40:43], s89 offen offset:1024 sc1 lds
    v_mfma_f32_16x16x32_bf16 v[88:91], v[108:111], a[160:163], v[88:91]
    ds_read_b128 v[124:127], v252 offset:22528
    ds_read_b64 v[192:193], v241
    v_mfma_f32_16x16x32_bf16 v[92:95], v[108:111], a[164:167], v[92:95]
    ds_read_b64 v[194:195], v241 offset:1024
    s_waitcnt lgkmcnt(4)
    v_mfma_f32_16x16x32_bf16 v[96:99], v[112:115], a[160:163], v[96:99]
    ds_read_b128 v[104:107], v252 offset:24576
    ds_read_b64 v[196:197], v245
    v_mfma_f32_16x16x32_bf16 v[100:103], v[112:115], a[164:167], v[100:103]
    ds_read_b64 v[198:199], v245 offset:1024
    ds_read_b64 v[200:201], v241 offset:2048
    ds_read2_b32 v[212:213], v237 offset0:0 offset1:16
    ds_read_b32 v214, v249
    v_mfma_f32_16x16x32_bf16 v[80:83], v[116:119], a[168:171], v[80:83]
    ds_read_b128 v[108:111], v252 offset:25600
    v_cvt_pk_bf16_f32 v66, v68, v69
    v_mfma_f32_16x16x32_bf16 v[84:87], v[116:119], a[172:175], v[84:87]
    v_cvt_pk_bf16_f32 v67, v70, v71
    buffer_store_dwordx4 v[64:67], v244, s[40:43], s94 offen sc1
    s_waitcnt lgkmcnt(9)
    v_mfma_f32_16x16x32_bf16 v[88:91], v[120:123], a[168:171], v[88:91]
    ds_read_b128 v[112:115], v252 offset:26624
    v_cvt_pk_bf16_f32 v72, v72, v73
    v_mfma_f32_16x16x32_bf16 v[92:95], v[120:123], a[172:175], v[92:95]
    v_cvt_pk_bf16_f32 v73, v74, v75
    v_cvt_pk_bf16_f32 v74, v76, v77
    v_mfma_f32_16x16x32_bf16 v[96:99], v[124:127], a[168:171], v[96:99]
    ds_read_b128 v[116:119], v252 offset:28672
    v_cvt_pk_bf16_f32 v75, v78, v79
    v_mfma_f32_16x16x32_bf16 v[100:103], v[124:127], a[172:175], v[100:103]
    s_waitcnt lgkmcnt(2)
    v_mfma_f32_16x16x32_bf16 v[80:83], v[104:107], a[176:179], v[80:83]
    ds_read_b128 v[120:123], v252 offset:29696
    buffer_store_dwordx4 v[72:75], v244, s[40:43], s94 offen offset:1024 sc1
    v_mfma_f32_16x16x32_bf16 v[84:87], v[104:107], a[180:183], v[84:87]
    v_cmp_ne_u32 vcc, s77, v176
    v_cmp_ne_u32 s[86:87], s77, v177
    s_nop 0
    s_or_b64 vcc, vcc, s[86:87]
    v_cmp_ne_u32 s[86:87], s77, v178
    s_nop 0
    s_or_b64 vcc, vcc, s[86:87]
    v_cmp_ne_u32 s[86:87], s77, v179
    s_nop 0
    s_or_b64 vcc, vcc, s[86:87]
    s_cbranch_vccnz SLOW_J2D
BACK_J2D:
    s_lshl_b32 m0, s52, 12
    s_nop 0
    buffer_load_dwordx4 v238, s[40:43], s74 offen sc1 lds
    v_mfma_f32_16x16x32_bf16 v[88:91], v[108:111], a[176:179], v[88:91]
    ds_read_b128 v[124:127], v252 offset:30720
    s_add_u32 s82, s74, 64512
    v_mfma_f32_16x16x32_bf16 v[92:95], v[108:111], a[180:183], v[92:95]
    s_waitcnt lgkmcnt(2)
    v_mfma_f32_16x16x32_bf16 v[96:99], v[112:115], a[176:179], v[96:99]
    ds_read_b128 v[104:107], v244 offset:32768
    v_mfma_f32_16x16x32_bf16 v[100:103], v[112:115], a[180:183], v[100:103]
    buffer_load_dwordx4 v238, s[40:43], s82 offen offset:1024 sc1 lds
    v_mfma_f32_16x16x32_bf16 v[80:83], v[116:119], a[184:187], v[80:83]
    ds_read_b128 v[108:111], v244 offset:33792
    v_mfma_f32_16x16x32_bf16 v[84:87], v[116:119], a[188:191], v[84:87]
    s_waitcnt lgkmcnt(2)
    v_mfma_f32_16x16x32_bf16 v[88:91], v[120:123], a[184:187], v[88:91]
    ds_read_b128 v[112:115], v244 offset:34816
    s_sub_u32 s82, s75, 2048
    v_mfma_f32_16x16x32_bf16 v[92:95], v[120:123], a[188:191], v[92:95]
    v_mfma_f32_16x16x32_bf16 v[96:99], v[124:127], a[184:187], v[96:99]
    ds_read_b128 v[116:119], v244 offset:36864
    v_mfma_f32_16x16x32_bf16 v[100:103], v[124:127], a[188:191], v[100:103]
    s_waitcnt lgkmcnt(2)
    v_mfma_f32_16x16x32_bf16 v[80:83], v[104:107], a[192:195], v[80:83]
    ds_read_b128 v[120:123], v244 offset:37888
    v_mfma_f32_16x16x32_bf16 v[84:87], v[104:107], a[196:199], v[84:87]
    buffer_load_dwordx4 v238, s[40:43], s82 offen offset:2048 sc1 lds
    v_mfma_f32_16x16x32_bf16 v[88:91], v[108:111], a[192:195], v[88:91]
    ds_read_b128 v[124:127], v244 offset:38912
    v_mfma_f32_16x16x32_bf16 v[92:95], v[108:111], a[196:199], v[92:95]
    s_waitcnt lgkmcnt(2)
    v_mfma_f32_16x16x32_bf16 v[96:99], v[112:115], a[192:195], v[96:99]
    ds_read_b128 v[104:107], v244 offset:40960
    v_mfma_f32_16x16x32_bf16 v[100:103], v[112:115], a[196:199], v[100:103]
    v_mfma_f32_16x16x32_bf16 v[80:83], v[116:119], a[200:203], v[80:83]
    ds_read_b128 v[108:111], v244 offset:41984
    v_mfma_f32_16x16x32_bf16 v[84:87], v[116:119], a[204:207], v[84:87]
    s_waitcnt lgkmcnt(2)
    v_mfma_f32_16x16x32_bf16 v[88:91], v[120:123], a[200:203], v[88:91]
    ds_read_b128 v[112:115], v244 offset:43008
    v_mfma_f32_16x16x32_bf16 v[92:95], v[120:123], a[204:207], v[92:95]
    v_mfma_f32_16x16x32_bf16 v[96:99], v[124:127], a[200:203], v[96:99]
    ds_read_b128 v[116:119], v244 offset:45056
    v_mfma_f32_16x16x32_bf16 v[100:103], v[124:127], a[204:207], v[100:103]
    s_waitcnt lgkmcnt(2)
    v_mfma_f32_16x16x32_bf16 v[80:83], v[104:107], a[208:211], v[80:83]
    ds_read_b128 v[120:123], v244 offset:46080
    v_mfma_f32_16x16x32_bf16 v[84:87], v[104:107], a[212:215], v[84:87]
    v_mfma_f32_16x16x32_bf16 v[88:91], v[108:111], a[208:211], v[88:91]
    ds_read_b128 v[124:127], v244 offset:47104
    v_mfma_f32_16x16x32_bf16 v[92:95], v[108:111], a[212:215], v[92:95]
    s_waitcnt lgkmcnt(2)
    v_mfma_f32_16x16x32_bf16 v[96:99], v[112:115], a[208:211], v[96:99]
    ds_read_b128 v[104:107], v251 offset:32768
    v_mfma_f32_16x16x32_bf16 v[100:103], v[112:115], a[212:215], v[100:103]
    v_mfma_f32_16x16x32_bf16 v[80:83], v[116:119], a[216:219], v[80:83]
    ds_read_b128 v[108:111], v251 offset:33792
    v_mfma_f32_16x16x32_bf16 v[84:87], v[116:119], a[220:223], v[84:87]
    s_waitcnt lgkmcnt(2)
    v_mfma_f32_16x16x32_bf16 v[88:91], v[120:123], a[216:219], v[88:91]
    ds_read_b128 v[112:115], v251 offset:34816
    v_mfma_f32_16x16x32_bf16 v[92:95], v[120:123], a[220:223], v[92:95]
    v_mfma_f32_16x16x32_bf16 v[96:99], v[124:127], a[216:219], v[96:99]
    ds_read_b128 v[116:119], v251 offset:36864
    v_mfma_f32_16x16x32_bf16 v[100:103], v[124:127], a[220:223], v[100:103]
    s_waitcnt lgkmcnt(2)
    v_mfma_f32_16x16x32_bf16 v[80:83], v[104:107], a[224:227], v[80:83]
    ds_read_b128 v[120:123], v251 offset:37888
    v_mfma_f32_16x16x32_bf16 v[84:87], v[104:107], a[228:231], v[84:87]
    v_mfma_f32_16x16x32_bf16 v[88:91], v[108:111], a[224:227], v[88:91]
    ds_read_b128 v[124:127], v251 offset:38912
    v_mfma_f32_16x16x32_bf16 v[92:95], v[108:111], a[228:231], v[92:95]
    s_waitcnt lgkmcnt(2)
    v_mfma_f32_16x16x32_bf16 v[96:99], v[112:115], a[224:227], v[96:99]
    ds_read_b128 v[104:107], v251 offset:40960
    v_mfma_f32_16x16x32_bf16 v[100:103], v[112:115], a[228:231], v[100:103]
    v_mfma_f32_16x16x32_bf16 v[80:83], v[116:119], a[232:235], v[80:83]
    ds_read_b128 v[108:111], v251 offset:41984
    v_mfma_f32_16x16x32_bf16 v[84:87], v[116:119], a[236:239], v[84:87]
    s_waitcnt lgkmcnt(2)
    v_mfma_f32_16x16x32_bf16 v[88:91], v[120:123], a[232:235], v[88:91]
    ds_read_b128 v[112:115], v251 offset:43008
    v_mfma_f32_16x16x32_bf16 v[92:95], v[120:123], a[236:239], v[92:95]
    v_mfma_f32_16x16x32_bf16 v[96:99], v[124:127], a[232:235], v[96:99]
    ds_read_b128 v[116:119], v251 offset:45056
    v_mfma_f32_16x16x32_bf16 v[100:103], v[124:127], a[236:239], v[100:103]
    s_waitcnt lgkmcnt(2)
    v_mfma_f32_16x16x32_bf16 v[80:83], v[104:107], a[240:243], v[80:83]
    ds_read_b128 v[120:123], v251 offset:46080
    v_mfma_f32_16x16x32_bf16 v[84:87], v[104:107], a[244:247], v[84:87]
    v_mfma_f32_16x16x32_bf16 v[88:91], v[108:111], a[240:243], v[88:91]
    ds_read_b128 v[124:127], v251 offset:47104
    v_mfma_f32_16x16x32_bf16 v[92:95], v[108:111], a[244:247], v[92:95]
    s_waitcnt vmcnt(19)
    s_barrier
    s_waitcnt lgkmcnt(2)
    v_mfma_f32_16x16x32_bf16 v[96:99], v[112:115], a[240:243], v[96:99]
    ds_read_b128 v[104:107], v244 offset:49152
    v_mfma_f32_16x16x32_bf16 v[100:103], v[112:115], a[244:247], v[100:103]
    v_mfma_f32_16x16x32_bf16 v[80:83], v[116:119], a[248:251], v[80:83]
    ds_read_b128 v[108:111], v244 offset:50176
    v_mfma_f32_16x16x32_bf16 v[84:87], v[116:119], a[252:255], v[84:87]
    s_waitcnt lgkmcnt(2)
    v_mfma_f32_16x16x32_bf16 v[88:91], v[120:123], a[248:251], v[88:91]
    ds_read_b128 v[112:115], v244 offset:53248
    v_mfma_f32_16x16x32_bf16 v[92:95], v[120:123], a[252:255], v[92:95]
    s_nop 1
    v_cvt_pk_bf16_f32 v80, v80, v81
    v_cvt_pk_bf16_f32 v81, v82, v83
    v_mfma_f32_16x16x32_bf16 v[96:99], v[124:127], a[248:251], v[96:99]
    ds_read_b128 v[116:119], v244 offset:54272
    v_cvt_pk_bf16_f32 v82, v84, v85
    v_mfma_f32_16x16x32_bf16 v[100:103], v[124:127], a[252:255], v[100:103]
    v_cvt_pk_bf16_f32 v83, v86, v87
    s_waitcnt lgkmcnt(2)
    v_mfma_f32_16x16x32_bf16 v[32:35], v[104:107], v[0:3], 0
    ds_read_b128 v[120:123], v244 offset:57344
    v_mfma_f32_16x16x32_bf16 v[36:39], v[104:107], v[4:7], 0
    buffer_store_dwordx4 v[80:83], v244, s[40:43], s95 offen sc1
    v_mfma_f32_16x16x32_bf16 v[40:43], v[108:111], v[0:3], 0
    ds_read_b128 v[124:127], v244 offset:58368
    v_cvt_pk_bf16_f32 v88, v88, v89
    v_mfma_f32_16x16x32_bf16 v[44:47], v[108:111], v[4:7], 0
    v_cvt_pk_bf16_f32 v89, v90, v91
    s_waitcnt lgkmcnt(2)
    v_mfma_f32_16x16x32_bf16 v[32:35], v[112:115], v[8:11], v[32:35]
    ds_read_b128 v[104:107], v244 offset:61440
    v_cvt_pk_bf16_f32 v90, v92, v93
    v_mfma_f32_16x16x32_bf16 v[36:39], v[112:115], v[12:15], v[36:39]
    v_cvt_pk_bf16_f32 v91, v94, v95
    v_mfma_f32_16x16x32_bf16 v[40:43], v[116:119], v[8:11], v[40:43]
    ds_read_b128 v[108:111], v244 offset:62464
    v_mfma_f32_16x16x32_bf16 v[44:47], v[116:119], v[12:15], v[44:47]
    s_waitcnt lgkmcnt(2)
    v_mfma_f32_16x16x32_bf16 v[32:35], v[120:123], v[16:19], v[32:35]
    ds_read_b128 v[112:115], v244 offset:51200
    v_mfma_f32_16x16x32_bf16 v[36:39], v[120:123], v[20:23], v[36:39]
    buffer_store_dwordx4 v[88:91], v244, s[40:43], s95 offen offset:1024 sc1
    v_mfma_f32_16x16x32_bf16 v[40:43], v[124:127], v[16:19], v[40:43]
KF_PG9:
    s_cbranch_execz KF_PG12
    ds_read_b128 v[116:119], v244 offset:52224
    v_cvt_pk_bf16_f32 v96, v96, v97
    v_mfma_f32_16x16x32_bf16 v[44:47], v[124:127], v[20:23], v[44:47]
    v_cvt_pk_bf16_f32 v97, v98, v99
    s_waitcnt lgkmcnt(2)
    v_mfma_f32_16x16x32_bf16 v[32:35], v[104:107], v[24:27], v[32:35]
    ds_read_b128 v[120:123], v244 offset:55296
    v_cvt_pk_bf16_f32 v98, v100, v101
    v_mfma_f32_16x16x32_bf16 v[36:39], v[104:107], v[28:31], v[36:39]
    v_cvt_pk_bf16_f32 v99, v102, v103
    v_mfma_f32_16x16x32_bf16 v[40:43], v[108:111], v[24:27], v[40:43]
    ds_read_b128 v[124:127], v244 offset:56320
    v_mfma_f32_16x16x32_bf16 v[44:47], v[108:111], v[28:31], v[44:47]
    buffer_store_dwordx4 v[96:99], v244, s[40:43], s96 offen sc1
    s_waitcnt lgkmcnt(2)
    v_mfma_f32_16x16x32_bf16 v[32:35], v[112:115], a[0:3], v[32:35]
    ds_read_b128 v[104:107], v244 offset:59392
    v_mfma_f32_16x16x32_bf16 v[36:39], v[112:115], a[4:7], v[36:39]
    v_mfma_f32_16x16x32_bf16 v[40:43], v[116:119], a[0:3], v[40:43]
    ds_read_b128 v[108:111], v244 offset:60416
    v_mfma_f32_16x16x32_bf16 v[44:47], v[116:119], a[4:7], v[44:47]
    s_waitcnt lgkmcnt(2)
    v_mfma_f32_16x16x32_bf16 v[32:35], v[120:123], a[8:11], v[32:35]
    ds_read_b128 v[112:115], v244 offset:63488
    v_mfma_f32_16x16x32_bf16 v[36:39], v[120:123], a[12:15], v[36:39]
    v_mfma_f32_16x16x32_bf16 v[40:43], v[124:127], a[8:11], v[40:43]
    ds_read_b128 v[116:119], v244 offset:64512
    v_mfma_f32_16x16x32_bf16 v[44:47], v[124:127], a[12:15], v[44:47]
    s_waitcnt lgkmcnt(2)
    v_mfma_f32_16x16x32_bf16 v[32:35], v[104:107], a[16:19], v[32:35]
    ds_read_b128 v[120:123], v251 offset:49152
    v_mfma_f32_16x16x32_bf16 v[36:39], v[104:107], a[20:23], v[36:39]
    v_mfma_f32_16x16x32_bf16 v[40:43], v[108:111], a[16:19], v[40:43]
    ds_read_b128 v[124:127], v251 offset:50176
    v_mfma_f32_16x16x32_bf16 v[44:47], v[108:111], a[20:23], v[44:47]
    s_waitcnt lgkmcnt(2)
    v_mfma_f32_16x16x32_bf16 v[32:35], v[112:115], a[24:27], v[32:35]
    ds_read_b128 v[104:107], v251 offset:53248
    v_mfma_f32_16x16x32_bf16 v[36:39], v[112:115], a[28:31], v[36:39]
    v_mfma_f32_16x16x32_bf16 v[40:43], v[116:119], a[24:27], v[40:43]
    ds_read_b128 v[108:111], v251 offset:54272
    v_mfma_f32_16x16x32_bf16 v[44:47], v[116:119], a[28:31], v[44:47]
    s_waitcnt lgkmcnt(2)
    v_mfma_f32_16x16x32_bf16 v[32:35], v[120:123], a[32:35], v[32:35]
    ds_read_b128 v[112:115], v251 offset:57344
    v_mfma_f32_16x16x32_bf16 v[36:39], v[120:123], a[36:39], v[36:39]
    s_waitcnt vmcnt(3)
    ds_read_b64_tr_b16 v[202:203], v239
    v_mfma_f32_16x16x32_bf16 v[40:43], v[124:127], a[32:35], v[40:43]
    ds_read_b128 v[116:119], v251 offset:58368
    ds_read_b64_tr_b16 v[204:205], v239 offset:32
    v_mfma_f32_16x16x32_bf16 v[44:47], v[124:127], a[36:39], v[44:47]
    ds_read_b64_tr_b16 v[206:207], v239 offset:1024
    s_waitcnt lgkmcnt(5)
    v_mfma_f32_16x16x32_bf16 v[32:35], v[104:107], a[40:43], v[32:35]
    ds_read_b128 v[120:123], v251 offset:61440
    ds_read_b64_tr_b16 v[208:209], v239 offset:1056
    v_mfma_f32_16x16x32_bf16 v[36:39], v[104:107], a[44:47], v[36:39]
    ds_read_b64_tr_b16 v[210:211], v239 offset:2048
    v_mfma_f32_16x16x32_bf16 v[40:43], v[108:111], a[40:43], v[40:43]
    ds_read_b128 v[124:127], v251 offset:62464
    v_mfma_f32_16x16x32_bf16 v[44:47], v[108:111], a[44:47], v[44:47]
    s_barrier
    s_waitcnt lgkmcnt(6)
    v_mfma_f32_16x16x32_bf16 v[32:35], v[112:115], a[48:51], v[32:35]
    ds_read_b128 v[104:107], v251 offset:51200
    v_mfma_f32_16x16x32_bf16 v[36:39], v[112:115], a[52:55], v[36:39]
    s_waitcnt lgkmcnt(2)
    v_pk_max_u16 v216, v202, v203
    v_mfma_f32_16x16x32_bf16 v[40:43], v[116:119], a[48:51], v[40:43]
    ds_read_b128 v[108:111], v251 offset:52224
    v_pk_max_u16 v217, v204, v205
    v_mfma_f32_16x16x32_bf16 v[44:47], v[116:119], a[52:55], v[44:47]
    v_pk_max_u16 v216, v216, v206
    s_waitcnt lgkmcnt(2)
    v_mfma_f32_16x16x32_bf16 v[32:35], v[120:123], a[56:59], v[32:35]
    ds_read_b128 v[112:115], v251 offset:55296
    v_pk_max_u16 v217, v217, v207
    v_mfma_f32_16x16x32_bf16 v[36:39], v[120:123], a[60:63], v[36:39]
    v_pk_max_u16 v216, v216, v208
    v_pk_max_u16 v217, v217, v209
    v_mfma_f32_16x16x32_bf16 v[40:43], v[124:127], a[56:59], v[40:43]
    ds_read_b128 v[116:119], v251 offset:56320
    v_pk_max_u16 v216, v216, v210
    v_mfma_f32_16x16x32_bf16 v[44:47], v[124:127], a[60:63], v[44:47]
    v_pk_max_u16 v217, v217, v211
    s_waitcnt lgkmcnt(2)
    v_mfma_f32_16x16x32_bf16 v[32:35], v[104:107], a[64:67], v[32:35]
    ds_read_b128 v[120:123], v251 offset:59392
    v_pk_max_u16 v216, v216, v217
    v_mfma_f32_16x16x32_bf16 v[36:39], v[104:107], a[68:71], v[36:39]
    v_lshlrev_b32 v217, 16, v216
    v_max_u32 v216, v216, v217
    v_mfma_f32_16x16x32_bf16 v[40:43], v[108:111], a[64:67], v[40:43]
    ds_read_b128 v[124:127], v251 offset:60416
    v_mfma_f32_16x16x32_bf16 v[44:47], v[108:111], a[68:71], v[44:47]
    s_waitcnt lgkmcnt(2)
    v_mfma_f32_16x16x32_bf16 v[32:35], v[112:115], a[72:75], v[32:35]
    ds_read_b128 v[104:107], v251 offset:63488
    v_mfma_f32_16x16x32_bf16 v[36:39], v[112:115], a[76:79], v[36:39]
    v_cmp_le_u32 vcc, s99, v216
    s_cbranch_vccnz SLOW_YD
BACK_YD:
    v_mfma_f32_16x16x32_bf16 v[40:43], v[116:119], a[72:75], v[40:43]
    ds_read_b128 v[108:111], v251 offset:64512
    v_lshlrev_b32 v48, 16, v192
    v_mfma_f32_16x16x32_bf16 v[44:47], v[116:119], a[76:79], v[44:47]
    v_lshlrev_b32 v68, 16, v202
    s_waitcnt lgkmcnt(2)
    v_mfma_f32_16x16x32_bf16 v[32:35], v[120:123], a[80:83], v[32:35]
    ds_read_b128 v[112:115], v244 offset:16384
    v_and_b32 v49, s99, v192
    v_mfma_f32_16x16x32_bf16 v[36:39], v[120:123], a[84:87], v[36:39]
    v_and_b32 v69, s99, v202
    v_lshlrev_b32 v50, 16, v193
    v_mfma_f32_16x16x32_bf16 v[40:43], v[124:127], a[80:83], v[40:43]
    ds_read_b128 v[116:119], v244 offset:17408
    v_lshlrev_b32 v70, 16, v203
    v_mfma_f32_16x16x32_bf16 v[44:47], v[124:127], a[84:87], v[44:47]
    v_and_b32 v51, s99, v193
    s_waitcnt lgkmcnt(2)
    v_mfma_f32_16x16x32_bf16 v[32:35], v[104:107], a[88:91], v[32:35]
    ds_read_b128 v[120:123], v244 offset:20480
    v_and_b32 v71, s99, v203
    v_mfma_f32_16x16x32_bf16 v[36:39], v[104:107], a[92:95], v[36:39]
    v_mul_f32 v48, v48, v68
    v_mul_f32 v49, v49, v69
    v_mfma_f32_16x16x32_bf16 v[40:43], v[108:111], a[88:91], v[40:43]
    ds_read_b128 v[124:127], v244 offset:21504
    v_mul_f32 v50, v50, v70
    v_mfma_f32_16x16x32_bf16 v[44:47], v[108:111], a[92:95], v[44:47]
    v_mul_f32 v51, v51, v71
    s_waitcnt lgkmcnt(2)
    v_mfma_f32_16x16x32_bf16 v[32:35], v[112:115], a[96:99], v[32:35]
    ds_read_b128 v[104:107], v244 offset:24576
    v_mul_f32 v48, v48, v212
    v_mfma_f32_16x16x32_bf16 v[36:39], v[112:115], a[100:103], v[36:39]
    buffer_load_dwordx4 v[128:131], v244, s[40:43], s72 offen sc1
    v_mfma_f32_16x16x32_bf16 v[40:43], v[116:119], a[96:99], v[40:43]
    ds_read_b128 v[108:111], v244 offset:25600
    v_mul_f32 v49, v49, v212
    v_mfma_f32_16x16x32_bf16 v[44:47], v[116:119], a[100:103], v[44:47]
    v_mul_f32 v50, v50, v212
    s_waitcnt lgkmcnt(2)
    v_mfma_f32_16x16x32_bf16 v[32:35], v[120:123], a[104:107], v[32:35]
    ds_read_b128 v[112:115], v244 offset:28672
    v_mul_f32 v51, v51, v212
    v_mfma_f32_16x16x32_bf16 v[36:39], v[120:123], a[108:111], v[36:39]
    buffer_load_dwordx4 v[132:135], v244, s[40:43], s72 offen offset:1024 sc1
    v_mfma_f32_16x16x32_bf16 v[40:43], v[124:127], a[104:107], v[40:43]
    ds_read_b128 v[116:119], v244 offset:29696
    v_lshlrev_b32 v52, 16, v194
    v_mfma_f32_16x16x32_bf16 v[44:47], v[124:127], a[108:111], v[44:47]
    v_lshlrev_b32 v68, 16, v204
    s_waitcnt lgkmcnt(2)
    v_mfma_f32_16x16x32_bf16 v[32:35], v[104:107], a[112:115], v[32:35]
    ds_read_b128 v[120:123], v244 offset:18432
    v_and_b32 v53, s99, v194
    v_mfma_f32_16x16x32_bf16 v[36:39], v[104:107], a[116:119], v[36:39]
    buffer_load_dwordx4 v[136:139], v244, s[40:43], s72 offen offset:2048 sc1
    v_mfma_f32_16x16x32_bf16 v[40:43], v[108:111], a[112:115], v[40:43]
    ds_read_b128 v[124:127], v244 offset:19456
    v_and_b32 v69, s99, v204
    v_mfma_f32_16x16x32_bf16 v[44:47], v[108:111], a[116:119], v[44:47]
    v_lshlrev_b32 v54, 16, v195
    s_waitcnt lgkmcnt(2)
    v_mfma_f32_16x16x32_bf16 v[32:35], v[112:115], a[120:123], v[32:35]
    ds_read_b128 v[104:107], v244 offset:22528
    v_lshlrev_b32 v70, 16, v205
    v_mfma_f32_16x16x32_bf16 v[36:39], v[112:115], a[124:127], v[36:39]
    buffer_load_dwordx4 v[140:143], v244, s[40:43], s72 offen offset:3072 sc1
    v_mfma_f32_16x16x32_bf16 v[40:43], v[116:119], a[120:123], v[40:43]
    ds_read_b128 v[108:111], v244 offset:23552
    v_and_b32 v55, s99, v195
    v_mfma_f32_16x16x32_bf16 v[44:47], v[116:119], a[124:127], v[44:47]
    v_and_b32 v71, s99, v205
    s_waitcnt lgkmcnt(2)
    v_mfma_f32_16x16x32_bf16 v[32:35], v[120:123], a[128:131], v[32:35]
    ds_read_b128 v[112:115], v244 offset:26624
    v_mul_f32 v52, v52, v68
    v_mfma_f32_16x16x32_bf16 v[36:39], v[120:123], a[132:135], v[36:39]
    v_mul_f32 v53, v53, v69
    v_mul_f32 v54, v54, v70
    v_mfma_f32_16x16x32_bf16 v[40:43], v[124:127], a[128:131], v[40:43]
    ds_read_b128 v[116:119], v244 offset:27648
    v_mul_f32 v55, v55, v71
    v_mfma_f32_16x16x32_bf16 v[44:47], v[124:127], a[132:135], v[44:47]
    v_mul_f32 v52, v52, v213
    s_waitcnt lgkmcnt(2)
    v_mfma_f32_16x16x32_bf16 v[32:35], v[104:107], a[136:139], v[32:35]
    ds_read_b128 v[120:123], v244 offset:30720
    v_mul_f32 v53, v53, v213
    v_mfma_f32_16x16x32_bf16 v[36:39], v[104:107], a[140:143], v[36:39]
    v_mul_f32 v54, v54, v213
    v_mul_f32 v55, v55, v213
    v_mfma_f32_16x16x32_bf16 v[40:43], v[108:111], a[136:139], v[40:43]
    ds_read_b128 v[124:127], v244 offset:31744
    v_lshlrev_b32 v56, 16, v196
    v_mfma_f32_16x16x32_bf16 v[44:47], v[108:111], a[140:143], v[44:47]
    s_barrier
    s_waitcnt lgkmcnt(2)
    v_mfma_f32_16x16x32_bf16 v[32:35], v[112:115], a[144:147], v[32:35]
    ds_read_b128 v[104:107], v251
    v_lshlrev_b32 v68, 16, v206
    v_mfma_f32_16x16x32_bf16 v[36:39], v[112:115], a[148:151], v[36:39]
    v_and_b32 v57, s99, v196
    v_and_b32 v69, s99, v206
    v_mfma_f32_16x16x32_bf16 v[40:43], v[116:119], a[144:147], v[40:43]
    ds_read_b128 v[108:111], v251 offset:1024
    v_lshlrev_b32 v58, 16, v197
    v_mfma_f32_16x16x32_bf16 v[44:47], v[116:119], a[148:151], v[44:47]
    v_lshlrev_b32 v70, 16, v207
    s_waitcnt lgkmcnt(2)
    v_mfma_f32_16x16x32_bf16 v[32:35], v[120:123], a[152:155], v[32:35]
    ds_read_b128 v[112:115], v251 offset:4096
    v_and_b32 v59, s99, v197
    v_mfma_f32_16x16x32_bf16 v[36:39], v[120:123], a[156:159], v[36:39]
    v_and_b32 v71, s99, v207
    v_mfma_f32_16x16x32_bf16 v[40:43], v[124:127], a[152:155], v[40:43]
    ds_read_b128 v[116:119], v251 offset:5120
    v_mul_f32 v56, v56, v68
    v_mfma_f32_16x16x32_bf16 v[44:47], v[124:127], a[156:159], v[44:47]
    v_mul_f32 v57, v57, v69
    s_waitcnt lgkmcnt(2)
    v_mfma_f32_16x16x32_bf16 v[32:35], v[104:107], a[160:163], v[32:35]
    ds_read_b128 v[120:123], v251 offset:8192
    v_mul_f32 v58, v58, v70
    v_mfma_f32_16x16x32_bf16 v[36:39], v[104:107], a[164:167], v[36:39]
    buffer_load_dwordx4 v[144:147], v244, s[40:43], s59 offen sc1
    v_mfma_f32_16x16x32_bf16 v[40:43], v[108:111], a[160:163], v[40:43]
    ds_read_b128 v[124:127], v251 offset:9216
    v_mul_f32 v59, v59, v71
    v_mfma_f32_16x16x32_bf16 v[44:47], v[108:111], a[164:167], v[44:47]
    v_mul_f32 v56, v56, v212
    s_waitcnt lgkmcnt(2)
    v_mfma_f32_16x16x32_bf16 v[32:35], v[112:115], a[168:171], v[32:35]
    ds_read_b128 v[104:107], v251 offset:12288
    v_mul_f32 v57, v57, v212
    v_mfma_f32_16x16x32_bf16 v[36:39], v[112:115], a[172:175], v[36:39]
    buffer_load_dwordx4 v[148:151], v244, s[40:43], s59 offen offset:1024 sc1
    v_mfma_f32_16x16x32_bf16 v[40:43], v[116:119], a[168:171], v[40:43]
    ds_read_b128 v[108:111], v251 offset:13312
    v_mul_f32 v58, v58, v212
    v_mfma_f32_16x16x32_bf16 v[44:47], v[116:119], a[172:175], v[44:47]
    v_mul_f32 v59, v59, v212
    s_waitcnt lgkmcnt(2)
    v_mfma_f32_16x16x32_bf16 v[32:35], v[120:123], a[176:179], v[32:35]
    ds_read_b128 v[112:115], v251 offset:2048
    v_lshlrev_b32 v60, 16, v198
    v_mfma_f32_16x16x32_bf16 v[36:39], v[120:123], a[180:183], v[36:39]
    buffer_load_dwordx2 v[152:153], v244, s[40:43], s73 offen sc1
    v_mfma_f32_16x16x32_bf16 v[40:43], v[124:127], a[176:179], v[40:43]
    ds_read_b128 v[116:119], v251 offset:3072
    v_lshlrev_b32 v68, 16, v208
    v_mfma_f32_16x16x32_bf16 v[44:47], v[124:127], a[180:183], v[44:47]
    v_and_b32 v61, s99, v198
    s_waitcnt lgkmcnt(2)
    v_mfma_f32_16x16x32_bf16 v[32:35], v[104:107], a[184:187], v[32:35]
    ds_read_b128 v[120:123], v251 offset:6144
    v_and_b32 v69, s99, v208
    v_mfma_f32_16x16x32_bf16 v[36:39], v[104:107], a[188:191], v[36:39]
    buffer_load_dwordx2 v[154:155], v244, s[40:43], s73 offen offset:1024 sc1
    v_mfma_f32_16x16x32_bf16 v[40:43], v[108:111], a[184:187], v[40:43]
    ds_read_b128 v[124:127], v251 offset:7168
    v_lshlrev_b32 v62, 16, v199
    v_mfma_f32_16x16x32_bf16 v[44:47], v[108:111], a[188:191], v[44:47]
    v_lshlrev_b32 v70, 16, v209
    s_waitcnt lgkmcnt(2)
    v_mfma_f32_16x16x32_bf16 v[32:35], v[112:115], a[192:195], v[32:35]
    ds_read_b128 v[104:107], v251 offset:10240
    v_and_b32 v63, s99, v199
    v_mfma_f32_16x16x32_bf16 v[36:39], v[112:115], a[196:199], v[36:39]
    buffer_load_dwordx2 v[156:157], v244, s[40:43], s73 offen offset:2048 sc1
    v_mfma_f32_16x16x32_bf16 v[40:43], v[116:119], a[192:195], v[40:43]
    ds_read_b128 v[108:111], v251 offset:11264
    v_and_b32 v71, s99, v209
    v_mfma_f32_16x16x32_bf16 v[44:47], v[116:119], a[196:199], v[44:47]
    v_mul_f32 v60, v60, v68
    s_waitcnt lgkmcnt(2)
    v_mfma_f32_16x16x32_bf16 v[32:35], v[120:123], a[200:203], v[32:35]
    ds_read_b128 v[112:115], v251 offset:14336
    v_mul_f32 v61, v61, v69
    v_mfma_f32_16x16x32_bf16 v[36:39], v[120:123], a[204:207], v[36:39]
    buffer_load_dwordx2 v[158:159], v244, s[40:43], s73 offen offset:3072 sc1
    v_mfma_f32_16x16x32_bf16 v[40:43], v[124:127], a[200:203], v[40:43]
    ds_read_b128 v[116:119], v251 offset:15360
    v_mul_f32 v62, v62, v70
    v_mfma_f32_16x16x32_bf16 v[44:47], v[124:127], a[204:207], v[44:47]
    v_mul_f32 v63, v63, v71
    s_waitcnt lgkmcnt(2)
    v_mfma_f32_16x16x32_bf16 v[32:35], v[104:107], a[208:211], v[32:35]
    ds_read_b128 v[120:123], v251 offset:16384
    v_mul_f32 v60, v60, v213
    v_mfma_f32_16x16x32_bf16 v[36:39], v[104:107], a[212:215], v[36:39]
    v_mul_f32 v61, v61, v213
    v_mul_f32 v62, v62, v213
    v_mfma_f32_16x16x32_bf16 v[40:43], v[108:111], a[208:211], v[40:43]
    ds_read_b128 v[124:127], v251 offset:17408
    v_mul_f32 v63, v63, v213
    v_mfma_f32_16x16x32_bf16 v[44:47], v[108:111], a[212:215], v[44:47]
    v_lshlrev_b32 v64, 16, v200
    s_waitcnt lgkmcnt(2)
    v_mfma_f32_16x16x32_bf16 v[32:35], v[112:115], a[216:219], v[32:35]
    ds_read_b128 v[104:107], v251 offset:20480
    v_lshlrev_b32 v68, 16, v210
    v_mfma_f32_16x16x32_bf16 v[36:39], v[112:115], a[220:223], v[36:39]
    v_and_b32 v65, s99, v200
    v_and_b32 v69, s99, v210
    v_mfma_f32_16x16x32_bf16 v[40:43], v[116:119], a[216:219], v[40:43]
    ds_read_b128 v[108:111], v251 offset:21504
    v_lshlrev_b32 v66, 16, v201
    v_mfma_f32_16x16x32_bf16 v[44:47], v[116:119], a[220:223], v[44:47]
    v_lshlrev_b32 v70, 16, v211
    s_waitcnt lgkmcnt(2)
    v_mfma_f32_16x16x32_bf16 v[32:35], v[120:123], a[224:227], v[32:35]
    ds_read_b128 v[112:115], v251 offset:24576
    v_and_b32 v67, s99, v201
    v_mfma_f32_16x16x32_bf16 v[36:39], v[120:123], a[228:231], v[36:39]
    v_and_b32 v71, s99, v211
    v_mul_f32 v64, v64, v68
    v_mfma_f32_16x16x32_bf16 v[40:43], v[124:127], a[224:227], v[40:43]
    ds_read_b128 v[116:119], v251 offset:25600
    v_mul_f32 v65, v65, v69
    v_mfma_f32_16x16x32_bf16 v[44:47], v[124:127], a[228:231], v[44:47]
    v_mul_f32 v66, v66, v70
    s_waitcnt lgkmcnt(2)
    v_mfma_f32_16x16x32_bf16 v[32:35], v[104:107], a[232:235], v[32:35]
    ds_read_b128 v[120:123], v251 offset:28672
    v_mul_f32 v67, v67, v71
    v_mfma_f32_16x16x32_bf16 v[36:39], v[104:107], a[236:239], v[36:39]
    v_mul_f32 v64, v64, v214
    v_mul_f32 v65, v65, v214
    v_mfma_f32_16x16x32_bf16 v[40:43], v[108:111], a[232:235], v[40:43]
    ds_read_b128 v[124:127], v251 offset:29696
    v_mul_f32 v66, v66, v214
    v_mfma_f32_16x16x32_bf16 v[44:47], v[108:111], a[236:239], v[44:47]
    v_mul_f32 v67, v67, v214
    s_waitcnt lgkmcnt(2)
    v_mfma_f32_16x16x32_bf16 v[32:35], v[112:115], a[240:243], v[32:35]
    v_sub_f32 v212, 1.0, v212
    v_mfma_f32_16x16x32_bf16 v[36:39], v[112:115], a[244:247], v[36:39]
    v_sub_f32 v213, 1.0, v213
    v_mfma_f32_16x16x32_bf16 v[40:43], v[116:119], a[240:243], v[40:43]
    v_sub_f32 v214, 1.0, v214
    v_mfma_f32_16x16x32_bf16 v[44:47], v[116:119], a[244:247], v[44:47]
    s_waitcnt lgkmcnt(0)
    v_mfma_f32_16x16x32_bf16 v[32:35], v[120:123], a[248:251], v[32:35]
    v_mfma_f32_16x16x32_bf16 v[36:39], v[120:123], a[252:255], v[36:39]
    v_mfma_f32_16x16x32_bf16 v[40:43], v[124:127], a[248:251], v[40:43]
    v_mfma_f32_16x16x32_bf16 v[44:47], v[124:127], a[252:255], v[44:47]
    s_waitcnt vmcnt(0)
    v_max3_u32 v72, v128, v129, v130
    v_max3_u32 v73, v131, v132, v133
    v_max3_u32 v72, v72, v134, v135
    v_max3_u32 v73, v73, v136, v137
    v_max3_u32 v72, v72, v138, v139
    v_max3_u32 v73, v73, v140, v141
    v_max3_u32 v72, v72, v142, v143
    v_max3_u32 v73, v73, v144, v145
    v_max3_u32 v72, v72, v146, v147
    v_max3_u32 v73, v73, v148, v149
    v_max3_u32 v72, v72, v150, v151
    v_max3_u32 v73, v73, v152, v153
    v_max3_u32 v72, v72, v154, v155
    v_max3_u32 v73, v73, v156, v157
    v_max3_u32 v72, v72, v158, v159
    v_max_u32 v72, v72, v73
    v_cmp_eq_u32 vcc, -1, v72
    s_cbranch_vccnz SLOW_RD
BACK_RD:
    v_lshlrev_b32 v160, 16, v128
    v_and_b32 v161, s99, v128
    v_lshlrev_b32 v162, 16, v129
    v_and_b32 v163, s99, v129
    v_lshlrev_b32 v164, 16, v136
    v_and_b32 v165, s99, v136
    v_lshlrev_b32 v166, 16, v137
    v_and_b32 v167, s99, v137
    v_lshlrev_b32 v168, 16, v144
    v_and_b32 v169, s99, v144
    v_lshlrev_b32 v170, 16, v145
    v_and_b32 v171, s99, v145
    v_add_f32 v160, v160, v164
    v_add_f32 v161, v161, v165
    v_add_f32 v162, v162, v166
    v_add_f32 v163, v163, v167
    v_add_f32 v32, v32, v168
    v_add_f32 v33, v33, v169
    v_add_f32 v34, v34, v170
    v_add_f32 v35, v35, v171
    v_add_f32 v32, v32, v160
    v_add_f32 v33, v33, v161
    v_add_f32 v34, v34, v162
    v_add_f32 v35, v35, v163
    v_fmac_f32 v48, v32, v212
    v_fmac_f32 v49, v33, v212
    v_fmac_f32 v50, v34, v212
    v_fmac_f32 v51, v35, v212
    v_cvt_pk_bf16_f32 v48, v48, v49
    v_cvt_pk_bf16_f32 v49, v50, v51
    ds_write_b64 v241, v[48:49]
    v_lshlrev_b32 v160, 16, v132
    v_and_b32 v161, s99, v132
    v_lshlrev_b32 v162, 16, v133
    v_and_b32 v163, s99, v133
    v_lshlrev_b32 v164, 16, v140
    v_and_b32 v165, s99, v140
    v_lshlrev_b32 v166, 16, v141
    v_and_b32 v167, s99, v141
    v_lshlrev_b32 v168, 16, v148
    v_and_b32 v169, s99, v148
    v_lshlrev_b32 v170, 16, v149
    v_and_b32 v171, s99, v149
    v_add_f32 v160, v160, v164
    v_add_f32 v161, v161, v165
    v_add_f32 v162, v162, v166
    v_add_f32 v163, v163, v167
    v_add_f32 v40, v40, v168
    v_add_f32 v41, v41, v169
    v_add_f32 v42, v42, v170
    v_add_f32 v43, v43, v171
    v_add_f32 v40, v40, v160
    v_add_f32 v41, v41, v161
    v_add_f32 v42, v42, v162
    v_add_f32 v43, v43, v163
    v_fmac_f32 v56, v40, v212
    v_fmac_f32 v57, v41, v212
    v_fmac_f32 v58, v42, v212
    v_fmac_f32 v59, v43, v212
    v_cvt_pk_bf16_f32 v56, v56, v57
    v_cvt_pk_bf16_f32 v57, v58, v59
    ds_write_b64 v245, v[56:57]
    ds_read_b128 v[192:195], v253
    v_lshlrev_b32 v160, 16, v130
    v_and_b32 v161, s99, v130
    v_lshlrev_b32 v162, 16, v131
    v_and_b32 v163, s99, v131
    v_lshlrev_b32 v164, 16, v138
    v_and_b32 v165, s99, v138
    v_lshlrev_b32 v166, 16, v139
    v_and_b32 v167, s99, v139
    v_lshlrev_b32 v168, 16, v146
    v_and_b32 v169, s99, v146
    v_lshlrev_b32 v170, 16, v147
    v_and_b32 v171, s99, v147
    v_add_f32 v160, v160, v164
    v_add_f32 v161, v161, v165
    v_add_f32 v162, v162, v166
    v_add_f32 v163, v163, v167
    v_add_f32 v36, v36, v168
    v_add_f32 v37, v37, v169
    v_add_f32 v38, v38, v170
    v_add_f32 v39, v39, v171
    v_add_f32 v36, v36, v160
    v_add_f32 v37, v37, v161
    v_add_f32 v38, v38, v162
    v_add_f32 v39, v39, v163
    v_fmac_f32 v52, v36, v213
    v_fmac_f32 v53, v37, v213
    v_fmac_f32 v54, v38, v213
    v_fmac_f32 v55, v39, v213
    v_cvt_pk_bf16_f32 v52, v52, v53
    v_cvt_pk_bf16_f32 v53, v54, v55
    s_waitcnt lgkmcnt(0)
    buffer_store_dwordx4 v[192:195], v254, s[44:47], s68 offen
    ds_write_b64 v241, v[52:53] offset:1024
    v_lshlrev_b32 v160, 16, v134
    v_and_b32 v161, s99, v134
    v_lshlrev_b32 v162, 16, v135
    v_and_b32 v163, s99, v135
    v_lshlrev_b32 v164, 16, v142
    v_and_b32 v165, s99, v142
    v_lshlrev_b32 v166, 16, v143
    v_and_b32 v167, s99, v143
    v_lshlrev_b32 v168, 16, v150
    v_and_b32 v169, s99, v150
    v_lshlrev_b32 v170, 16, v151
    v_and_b32 v171, s99, v151
    v_add_f32 v160, v160, v164
    v_add_f32 v161, v161, v165
    v_add_f32 v162, v162, v166
    v_add_f32 v163, v163, v167
    v_add_f32 v44, v44, v168
    v_add_f32 v45, v45, v169
    v_add_f32 v46, v46, v170
    v_add_f32 v47, v47, v171
    v_add_f32 v44, v44, v160
    v_add_f32 v45, v45, v161
    v_add_f32 v46, v46, v162
    v_add_f32 v47, v47, v163
    v_fmac_f32 v60, v44, v213
    v_fmac_f32 v61, v45, v213
    v_fmac_f32 v62, v46, v213
    v_fmac_f32 v63, v47, v213
    v_cvt_pk_bf16_f32 v60, v60, v61
    v_cvt_pk_bf16_f32 v61, v62, v63
    ds_write_b64 v245, v[60:61] offset:1024
    ds_read_b128 v[196:199], v253 offset:1024
    v_lshlrev_b32 v172, 16, v152
    v_and_b32 v173, s99, v152
    v_lshlrev_b32 v174, 16, v153
    v_and_b32 v175, s99, v153
    v_lshlrev_b32 v160, 16, v154
    v_and_b32 v161, s99, v154
    v_lshlrev_b32 v162, 16, v155
    v_and_b32 v163, s99, v155
    v_lshlrev_b32 v164, 16, v156
    v_and_b32 v165, s99, v156
    v_lshlrev_b32 v166, 16, v157
    v_and_b32 v167, s99, v157
    v_lshlrev_b32 v168, 16, v158
    v_and_b32 v169, s99, v158
    v_lshlrev_b32 v170, 16, v159
    v_and_b32 v171, s99, v159
    v_add_f32 v160, v160, v164
    v_add_f32 v161, v161, v165
    v_add_f32 v162, v162, v166
    v_add_f32 v163, v163, v167
    v_add_f32 v172, v172, v168
    v_add_f32 v173, v173, v169
    v_add_f32 v174, v174, v170
    v_add_f32 v175, v175, v171
    v_add_f32 v172, v172, v160
    v_add_f32 v173, v173, v161
    v_add_f32 v174, v174, v162
    v_add_f32 v175, v175, v163
    v_fmac_f32 v64, v172, v214
    v_fmac_f32 v65, v173, v214
    v_fmac_f32 v66, v174, v214
    v_fmac_f32 v67, v175, v214
    v_cvt_pk_bf16_f32 v64, v64, v65
    v_cvt_pk_bf16_f32 v65, v66, v67
    s_waitcnt lgkmcnt(0)
    buffer_store_dwordx4 v[196:199], v254, s[44:47], s69 offen
    ds_write_b64 v241, v[64:65] offset:2048
    ds_read_b128 v[200:203], v253 offset:2048
    s_mov_b64 exec, s[80:81]
    s_waitcnt lgkmcnt(0)
    buffer_store_dwordx4 v[200:203], v254, s[44:47], s70 offen
    s_endpgm
KF_THREE:
    s_cbranch_execz KF_PG13
    s_nop 7
    s_waitcnt lgkmcnt(0)
    v_mfma_f32_16x16x32_bf16 v[160:163], v[32:35], v[64:67], 0
    v_mfma_f32_16x16x32_bf16 v[164:167], v[32:35], v[68:71], 0
    s_add_u32 s78, s6, 512
    s_lshl_b32 s78, s78, 12
    v_mfma_f32_16x16x32_bf16 v[168:171], v[32:35], v[72:75], 0
    s_add_u32 s78, s78, s92
    s_nop 1
    v_mul_f32 v212, s76, v128
    v_mfma_f32_16x16x32_bf16 v[172:175], v[32:35], v[76:79], 0
    s_mov_b32 s79, 16384
    v_mul_f32 v213, s76, v129
    v_mfma_f32_16x16x32_bf16 v[176:179], v[32:35], v[80:83], 0
    s_waitcnt vmcnt(17)
    s_barrier
    v_mfma_f32_16x16x32_bf16 v[180:183], v[32:35], v[84:87], 0
    s_lshl_b32 s83, s2, 2
    s_add_u32 s83, s83, 36249600
    v_mov_b32 v243, s77
    s_cmp_eq_u32 s52, 0
    s_cselect_b64 exec, 1, 0
    buffer_store_dword v243, off, s[40:43], s83 offset:1024 sc1
    s_mov_b64 exec, -1
    v_mfma_f32_16x16x32_bf16 v[184:187], v[32:35], v[88:91], 0
    s_mov_b64 s[48:49], s[12:13]
    s_mov_b32 s50, 2359296
    v_mfma_f32_16x16x32_bf16 v[188:191], v[32:35], v[92:95], 0
    buffer_load_dwordx4 v[192:195], v244, s[48:51], s78 offen
    v_mfma_f32_16x16x32_bf16 v[164:167], v[36:39], v[64:67], v[164:167]
    buffer_load_dwordx4 v[196:199], v244, s[48:51], s78 offen offset:4
    v_mfma_f32_16x16x32_bf16 v[168:171], v[36:39], v[68:71], v[168:171]
    s_add_u32 s82, s79, s92
    s_add_u32 m0, s82, 32
    v_mfma_f32_16x16x32_bf16 v[172:175], v[36:39], v[72:75], v[172:175]
    ds_read2_b32 a[192:193], v236 offset0:16 offset1:17
    ds_read2_b32 a[194:195], v236 offset0:18 offset1:19
    v_mfma_f32_16x16x32_bf16 v[176:179], v[36:39], v[76:79], v[176:179]
    buffer_load_dwordx4 v244, s[48:51], s78 offen lds
    v_mfma_f32_16x16x32_bf16 v[180:183], v[36:39], v[80:83], v[180:183]
    s_add_u32 s82, s79, s92
    s_add_u32 m0, s82, 8320
    s_add_u32 s82, s78, 24182784
    v_mfma_f32_16x16x32_bf16 v[184:187], v[36:39], v[84:87], v[184:187]
    ds_read_b128 a[224:227], v240 offset:3648
    ds_read_b128 a[228:231], v240 offset:3136
    v_mfma_f32_16x16x32_bf16 v[188:191], v[36:39], v[88:91], v[188:191]
    ds_read_b128 a[232:235], v240 offset:2624
    ds_read_b128 a[236:239], v240 offset:2112
    v_mfma_f32_16x16x32_bf16 v[168:171], v[40:43], v[64:67], v[168:171]
    buffer_load_dwordx4 v244, s[40:43], s82 offen sc1 lds
    v_mfma_f32_16x16x32_bf16 v[172:175], v[40:43], v[68:71], v[172:175]
    ds_read_b128 a[240:243], v240 offset:1600
    ds_read_b128 a[244:247], v240 offset:1088
    v_mfma_f32_16x16x32_bf16 v[176:179], v[40:43], v[72:75], v[176:179]
    ds_read_b128 a[248:251], v240 offset:576
    ds_read_b128 a[252:255], v240 offset:64
    v_mfma_f32_16x16x32_bf16 v[180:183], v[40:43], v[76:79], v[180:183]
    ds_read2_b32 a[196:197], v236 offset0:144 offset1:145
    ds_read2_b32 a[198:199], v236 offset0:146 offset1:147
    v_mfma_f32_16x16x32_bf16 v[184:187], v[40:43], v[80:83], v[184:187]
    ds_read2_b32 a[200:201], v237 offset0:16 offset1:17
    ds_read2_b32 a[202:203], v237 offset0:18 offset1:19
    v_mfma_f32_16x16x32_bf16 v[188:191], v[40:43], v[84:87], v[188:191]
    ds_read2_b32 a[204:205], v237 offset0:144 offset1:145
    ds_read2_b32 a[206:207], v237 offset0:146 offset1:147
    v_mfma_f32_16x16x32_bf16 v[172:175], v[44:47], v[64:67], v[172:175]
    v_mul_f32 v214, s76, v130
    v_mul_f32 v215, s76, v131
    v_mfma_f32_16x16x32_bf16 v[176:179], v[44:47], v[68:71], v[176:179]
    s_waitcnt vmcnt(14)
    v_cmp_ne_u32 vcc, s77, v220
    s_cbranch_vccnz SLOW_HET
BACK_HET:
    v_mfma_f32_16x16x32_bf16 v[180:183], v[44:47], v[72:75], v[180:183]
    buffer_load_dwordx4 v[0:3], v250, s[40:43], s61 offen sc1
    v_mfma_f32_16x16x32_bf16 v[184:187], v[44:47], v[76:79], v[184:187]
    ds_read2_b32 a[208:209], v238 offset0:16 offset1:17
    ds_read2_b32 a[210:211], v238 offset0:18 offset1:19
    v_mfma_f32_16x16x32_bf16 v[188:191], v[44:47], v[80:83], v[188:191]
    ds_read2_b32 a[212:213], v238 offset0:144 offset1:145
    ds_read2_b32 a[214:215], v238 offset0:146 offset1:147
    v_mfma_f32_16x16x32_bf16 v[176:179], v[48:51], v[64:67], v[176:179]
    buffer_load_dwordx4 v[4:7], v250, s[40:43], s61 offen offset:256 sc1
    v_mfma_f32_16x16x32_bf16 v[180:183], v[48:51], v[68:71], v[180:183]
    ds_read2_b32 a[216:217], v239 offset0:16 offset1:17
    ds_read2_b32 a[218:219], v239 offset0:18 offset1:19
    v_mfma_f32_16x16x32_bf16 v[184:187], v[48:51], v[72:75], v[184:187]
    ds_read2_b32 a[220:221], v239 offset0:144 offset1:145
    ds_read2_b32 a[222:223], v239 offset0:146 offset1:147
    v_mfma_f32_16x16x32_bf16 v[188:191], v[48:51], v[76:79], v[188:191]
    v_exp_f32 v212, v212
    v_mfma_f32_16x16x32_bf16 v[180:183], v[52:55], v[64:67], v[180:183]
    buffer_load_dwordx4 v[8:11], v250, s[40:43], s61 offen offset:2048 sc1
    v_mfma_f32_16x16x32_bf16 v[184:187], v[52:55], v[68:71], v[184:187]
    v_exp_f32 v213, v213
    v_mfma_f32_16x16x32_bf16 v[188:191], v[52:55], v[72:75], v[188:191]
    v_exp_f32 v214, v214
    v_mfma_f32_16x16x32_bf16 v[184:187], v[56:59], v[64:67], v[184:187]
    v_exp_f32 v215, v215
    v_mfma_f32_16x16x32_bf16 v[188:191], v[56:59], v[68:71], v[188:191]
    buffer_load_dwordx4 v[12:15], v250, s[40:43], s61 offen offset:2304 sc1
    v_mfma_f32_16x16x32_bf16 v[188:191], v[60:63], v[64:67], v[188:191]
    v_mul_f32 v128, v128, v132
    s_waitcnt lgkmcnt(0)
    v_mfma_f32_16x16x32_bf16 v[160:163], a[192:195], a[224:227], v[160:163]
    v_mul_f32 v129, v129, v133
    v_mul_f32 v130, v130, v134
    v_mfma_f32_16x16x32_bf16 v[164:167], a[192:195], a[228:231], v[164:167]
    ds_read2_b32 v[32:33], v236 offset0:32 offset1:33
    ds_read2_b32 v[34:35], v236 offset0:34 offset1:35
    v_mfma_f32_16x16x32_bf16 v[168:171], a[192:195], a[232:235], v[168:171]
    buffer_load_dwordx4 v[16:19], v226, s[40:43], s61 offen sc1
    v_mfma_f32_16x16x32_bf16 v[172:175], a[192:195], a[236:239], v[172:175]
    ds_read_b128 v[64:67], v240 offset:3712
    ds_read_b128 v[68:71], v240 offset:3200
    v_mfma_f32_16x16x32_bf16 v[176:179], a[192:195], a[240:243], v[176:179]
    v_mul_f32 v131, v131, v135
    v_add_f32 v212, 1.0, v212
    v_mfma_f32_16x16x32_bf16 v[180:183], a[192:195], a[244:247], v[180:183]
    v_add_f32 v213, 1.0, v213
    v_add_f32 v214, 1.0, v214
    v_mfma_f32_16x16x32_bf16 v[184:187], a[192:195], a[248:251], v[184:187]
    buffer_load_dwordx4 v[20:23], v226, s[40:43], s61 offen offset:256 sc1
    v_mfma_f32_16x16x32_bf16 v[188:191], a[192:195], a[252:255], v[188:191]
    ds_read_b128 v[72:75], v240 offset:2688
    ds_read_b128 v[76:79], v240 offset:2176
    v_mfma_f32_16x16x32_bf16 v[164:167], a[196:199], a[224:227], v[164:167]
    ds_read_b128 v[80:83], v240 offset:1664
    ds_read_b128 v[84:87], v240 offset:1152
KF_PG10:
    s_cbranch_execz KF_PG6
    v_mfma_f32_16x16x32_bf16 v[168:171], a[196:199], a[228:231], v[168:171]
    v_add_f32 v215, 1.0, v215
    v_rcp_f32 v212, v212
    v_rcp_f32 v213, v213
    v_rcp_f32 v214, v214
    v_rcp_f32 v215, v215
    v_mul_f32 v128, v128, v212
    v_mul_f32 v129, v129, v213
    v_mul_f32 v130, v130, v214
    v_mul_f32 v131, v131, v215
    v_cvt_pk_bf16_f32 v132, v128, v129
    v_cvt_pk_bf16_f32 v133, v130, v131
    v_mfma_f32_16x16x32_bf16 v[172:175], a[196:199], a[232:235], v[172:175]
    buffer_load_dwordx4 v[24:27], v226, s[40:43], s61 offen offset:2048 sc1
    v_mfma_f32_16x16x32_bf16 v[176:179], a[196:199], a[236:239], v[176:179]
    ds_read_b128 v[88:91], v240 offset:640
    ds_read_b128 v[92:95], v240 offset:128
    v_mfma_f32_16x16x32_bf16 v[180:183], a[196:199], a[240:243], v[180:183]
    v_mul_f32 v216, s76, v136
    v_mul_f32 v217, s76, v137
    v_mfma_f32_16x16x32_bf16 v[184:187], a[196:199], a[244:247], v[184:187]
    ds_read2_b32 v[36:37], v236 offset0:160 offset1:161
    ds_read2_b32 v[38:39], v236 offset0:162 offset1:163
    v_mfma_f32_16x16x32_bf16 v[188:191], a[196:199], a[248:251], v[188:191]
    buffer_load_dwordx4 v[28:31], v226, s[40:43], s61 offen offset:2304 sc1
    v_mfma_f32_16x16x32_bf16 v[168:171], a[200:203], a[224:227], v[168:171]
    v_mul_f32 v218, s76, v138
    v_mul_f32 v219, s76, v139
    v_mfma_f32_16x16x32_bf16 v[172:175], a[200:203], a[228:231], v[172:175]
    ds_read2_b32 v[40:41], v237 offset0:32 offset1:33
    ds_read2_b32 v[42:43], v237 offset0:34 offset1:35
    v_mfma_f32_16x16x32_bf16 v[176:179], a[200:203], a[232:235], v[176:179]
    v_exp_f32 v216, v216
    v_mfma_f32_16x16x32_bf16 v[180:183], a[200:203], a[236:239], v[180:183]
    buffer_load_dwordx4 a[0:3], v250, s[40:43], s62 offen sc1
    v_mfma_f32_16x16x32_bf16 v[184:187], a[200:203], a[240:243], v[184:187]
    ds_read2_b32 v[44:45], v237 offset0:160 offset1:161
    ds_read2_b32 v[46:47], v237 offset0:162 offset1:163
    v_mfma_f32_16x16x32_bf16 v[188:191], a[200:203], a[244:247], v[188:191]
    v_exp_f32 v217, v217
    v_mfma_f32_16x16x32_bf16 v[172:175], a[204:207], a[224:227], v[172:175]
    ds_read2_b32 v[48:49], v238 offset0:32 offset1:33
    ds_read2_b32 v[50:51], v238 offset0:34 offset1:35
    v_mfma_f32_16x16x32_bf16 v[176:179], a[204:207], a[228:231], v[176:179]
    buffer_load_dwordx4 a[4:7], v250, s[40:43], s62 offen offset:256 sc1
    v_mfma_f32_16x16x32_bf16 v[180:183], a[204:207], a[232:235], v[180:183]
    ds_read2_b32 v[52:53], v238 offset0:160 offset1:161
    ds_read2_b32 v[54:55], v238 offset0:162 offset1:163
    v_mfma_f32_16x16x32_bf16 v[184:187], a[204:207], a[236:239], v[184:187]
    v_exp_f32 v218, v218
    v_mfma_f32_16x16x32_bf16 v[188:191], a[204:207], a[240:243], v[188:191]
    v_exp_f32 v219, v219
    v_mfma_f32_16x16x32_bf16 v[176:179], a[208:211], a[224:227], v[176:179]
    buffer_load_dwordx4 a[8:11], v250, s[40:43], s62 offen offset:2048 sc1
    v_mfma_f32_16x16x32_bf16 v[180:183], a[208:211], a[228:231], v[180:183]
    ds_read2_b32 v[56:57], v239 offset0:32 offset1:33
    ds_read2_b32 v[58:59], v239 offset0:34 offset1:35
    v_mfma_f32_16x16x32_bf16 v[184:187], a[208:211], a[232:235], v[184:187]
    ds_read2_b32 v[60:61], v239 offset0:160 offset1:161
    ds_read2_b32 v[62:63], v239 offset0:162 offset1:163
    v_mfma_f32_16x16x32_bf16 v[188:191], a[208:211], a[236:239], v[188:191]
    v_mul_f32 v136, v136, v140
    v_mul_f32 v137, v137, v141
    v_mfma_f32_16x16x32_bf16 v[180:183], a[212:215], a[224:227], v[180:183]
    buffer_load_dwordx4 a[12:15], v250, s[40:43], s62 offen offset:2304 sc1
    v_mfma_f32_16x16x32_bf16 v[184:187], a[212:215], a[228:231], v[184:187]
    v_mul_f32 v138, v138, v142
    v_mul_f32 v139, v139, v143
    v_mfma_f32_16x16x32_bf16 v[188:191], a[212:215], a[232:235], v[188:191]
    v_add_f32 v216, 1.0, v216
    v_add_f32 v217, 1.0, v217
    v_mfma_f32_16x16x32_bf16 v[184:187], a[216:219], a[224:227], v[184:187]
    v_add_f32 v218, 1.0, v218
    v_add_f32 v219, 1.0, v219
    v_mfma_f32_16x16x32_bf16 v[188:191], a[216:219], a[228:231], v[188:191]
    buffer_load_dwordx4 a[16:19], v226, s[40:43], s62 offen sc1
    v_mfma_f32_16x16x32_bf16 v[188:191], a[220:223], a[224:227], v[188:191]
    v_mov_b32 v200, 0
    s_waitcnt lgkmcnt(0)
    v_mfma_f32_16x16x32_bf16 v[160:163], v[32:35], v[64:67], v[160:163]
    v_rcp_f32 v216, v216
    v_mfma_f32_16x16x32_bf16 v[164:167], v[32:35], v[68:71], v[164:167]
    ds_read2_b32 a[192:193], v236 offset0:48 offset1:49
    ds_read2_b32 a[194:195], v236 offset0:50 offset1:51
    v_mfma_f32_16x16x32_bf16 v[168:171], v[32:35], v[72:75], v[168:171]
    buffer_load_dwordx4 a[20:23], v226, s[40:43], s62 offen offset:256 sc1
    v_mfma_f32_16x16x32_bf16 v[172:175], v[32:35], v[76:79], v[172:175]
    ds_read_b128 a[224:227], v240 offset:3776
    ds_read_b128 a[228:231], v240 offset:3264
    v_mfma_f32_16x16x32_bf16 v[176:179], v[32:35], v[80:83], v[176:179]
    v_rcp_f32 v217, v217
    v_rcp_f32 v218, v218
    v_rcp_f32 v219, v219
    v_mul_f32 v136, v136, v216
    v_mul_f32 v137, v137, v217
    v_mul_f32 v138, v138, v218
    v_mul_f32 v139, v139, v219
    v_cvt_pk_bf16_f32 v134, v136, v137
    v_cvt_pk_bf16_f32 v135, v138, v139
    buffer_store_dwordx4 v[132:135], v244, s[40:43], s74 offen sc1
    v_mfma_f32_16x16x32_bf16 v[180:183], v[32:35], v[84:87], v[180:183]
    v_mov_b32 v201, 0
    v_lshrrev_b32 v202, 1, v244
    v_mfma_f32_16x16x32_bf16 v[184:187], v[32:35], v[88:91], v[184:187]
    buffer_load_dwordx4 a[24:27], v226, s[40:43], s62 offen offset:2048 sc1
    v_mfma_f32_16x16x32_bf16 v[188:191], v[32:35], v[92:95], v[188:191]
    s_add_u32 s83, s79, 12416
    v_add_u32 v202, s83, v202
    v_mfma_f32_16x16x32_bf16 v[164:167], v[36:39], v[64:67], v[164:167]
    ds_write_b64 v202, v[200:201]
    v_mul_f32 v212, s76, v144
    v_mfma_f32_16x16x32_bf16 v[168:171], v[36:39], v[68:71], v[168:171]
    s_cmp_eq_u32 s92, 0
    s_cselect_b32 s83, 0, 4128
    v_mfma_f32_16x16x32_bf16 v[172:175], v[36:39], v[72:75], v[172:175]
    buffer_load_dwordx4 a[28:31], v226, s[40:43], s62 offen offset:2304 sc1
    v_mfma_f32_16x16x32_bf16 v[176:179], v[36:39], v[76:79], v[176:179]
    s_add_u32 s83, s83, s79
    v_add_u32 v202, s83, v255
    v_mfma_f32_16x16x32_bf16 v[180:183], v[36:39], v[80:83], v[180:183]
    ds_write_b32 v202, v200
    s_add_u32 s83, s79, s92
    v_mfma_f32_16x16x32_bf16 v[184:187], v[36:39], v[84:87], v[184:187]
    s_add_u32 s83, s83, 4192
    v_add_u32 v203, s83, v244
    v_mfma_f32_16x16x32_bf16 v[188:191], v[36:39], v[88:91], v[188:191]
    s_add_u32 m0, s91, 131072
    v_mul_f32 v213, s76, v145
    v_mfma_f32_16x16x32_bf16 v[168:171], v[40:43], v[64:67], v[168:171]
    buffer_load_dwordx4 v222, s[40:43], s18 offen sc1 lds
    v_mfma_f32_16x16x32_bf16 v[172:175], v[40:43], v[68:71], v[172:175]
    s_waitcnt vmcnt(20)
    v_alignbit_b32 v196, v196, v192, 16
    v_mfma_f32_16x16x32_bf16 v[176:179], v[40:43], v[72:75], v[176:179]
    ds_read_b128 a[232:235], v240 offset:2752
    ds_read_b128 a[236:239], v240 offset:2240
    v_mfma_f32_16x16x32_bf16 v[180:183], v[40:43], v[76:79], v[180:183]
    buffer_load_dwordx4 v222, s[40:43], s18 offen offset:1024 sc1 lds
    v_mfma_f32_16x16x32_bf16 v[184:187], v[40:43], v[80:83], v[184:187]
    ds_read_b128 a[240:243], v240 offset:1728
    ds_read_b128 a[244:247], v240 offset:1216
    v_mfma_f32_16x16x32_bf16 v[188:191], v[40:43], v[84:87], v[188:191]
    ds_read_b128 a[248:251], v240 offset:704
    ds_read_b128 a[252:255], v240 offset:192
    v_mfma_f32_16x16x32_bf16 v[172:175], v[44:47], v[64:67], v[172:175]
    ds_read2_b32 a[196:197], v236 offset0:176 offset1:177
    ds_read2_b32 a[198:199], v236 offset0:178 offset1:179
    v_mfma_f32_16x16x32_bf16 v[176:179], v[44:47], v[68:71], v[176:179]
    buffer_load_dwordx4 v223, s[40:43], s18 offen offset:2048 sc1 lds
    v_mfma_f32_16x16x32_bf16 v[180:183], v[44:47], v[72:75], v[180:183]
    ds_read2_b32 a[200:201], v237 offset0:48 offset1:49
    ds_read2_b32 a[202:203], v237 offset0:50 offset1:51
    v_mfma_f32_16x16x32_bf16 v[184:187], v[44:47], v[76:79], v[184:187]
    ds_read2_b32 a[204:205], v237 offset0:176 offset1:177
    ds_read2_b32 a[206:207], v237 offset0:178 offset1:179
    v_mfma_f32_16x16x32_bf16 v[188:191], v[44:47], v[80:83], v[188:191]
    ds_read2_b32 a[208:209], v238 offset0:48 offset1:49
    ds_read2_b32 a[210:211], v238 offset0:50 offset1:51
    v_mfma_f32_16x16x32_bf16 v[176:179], v[48:51], v[64:67], v[176:179]
    buffer_load_dwordx4 v223, s[40:43], s18 offen offset:3072 sc1 lds
    v_mfma_f32_16x16x32_bf16 v[180:183], v[48:51], v[68:71], v[180:183]
    ds_read2_b32 a[212:213], v238 offset0:176 offset1:177
    ds_read2_b32 a[214:215], v238 offset0:178 offset1:179
    v_mfma_f32_16x16x32_bf16 v[184:187], v[48:51], v[72:75], v[184:187]
    ds_read2_b32 a[216:217], v239 offset0:48 offset1:49
    ds_read2_b32 a[218:219], v239 offset0:50 offset1:51
    v_mfma_f32_16x16x32_bf16 v[188:191], v[48:51], v[76:79], v[188:191]
    ds_read2_b32 a[220:221], v239 offset0:176 offset1:177
    ds_read2_b32 a[222:223], v239 offset0:178 offset1:179
    v_mfma_f32_16x16x32_bf16 v[180:183], v[52:55], v[64:67], v[180:183]
    s_add_u32 m0, s91, 147456
    v_alignbit_b32 v197, v197, v193, 16
    v_mfma_f32_16x16x32_bf16 v[184:187], v[52:55], v[68:71], v[184:187]
    buffer_load_dwordx4 v224, s[40:43], s18 offen sc1 lds
    v_mfma_f32_16x16x32_bf16 v[188:191], v[52:55], v[72:75], v[188:191]
    v_alignbit_b32 v198, v198, v194, 16
    v_alignbit_b32 v199, v199, v195, 16
    v_readfirstlane_b32 s84, v192
    ds_write_b128 v203, v[196:199]
    s_lshl_b32 s84, s84, 16
    v_mov_b32 v201, s84
    v_cmp_eq_u32 vcc, 28, v255
    s_nop 1
    v_cndmask_b32 v201, v200, v201, vcc
    ds_write_b32 v202, v201 offset:4160
    v_mfma_f32_16x16x32_bf16 v[184:187], v[56:59], v[64:67], v[184:187]
    v_mul_f32 v214, s76, v146
    v_mul_f32 v215, s76, v147
    v_mfma_f32_16x16x32_bf16 v[188:191], v[56:59], v[68:71], v[188:191]
    buffer_load_dwordx4 v224, s[40:43], s18 offen offset:1024 sc1 lds
    v_mfma_f32_16x16x32_bf16 v[188:191], v[60:63], v[64:67], v[188:191]
    v_exp_f32 v212, v212
    v_exp_f32 v213, v213
    v_exp_f32 v214, v214
    v_exp_f32 v215, v215
    v_mul_f32 v144, v144, v148
    v_mul_f32 v145, v145, v149
    v_mul_f32 v146, v146, v150
    v_mul_f32 v147, v147, v151
    v_add_f32 v212, 1.0, v212
    v_add_f32 v213, 1.0, v213
    v_add_f32 v214, 1.0, v214
    v_add_f32 v215, 1.0, v215
    v_rcp_f32 v212, v212
    v_rcp_f32 v213, v213
    v_rcp_f32 v214, v214
    v_rcp_f32 v215, v215
    v_mul_f32 v144, v144, v212
    v_mul_f32 v145, v145, v213
    v_mul_f32 v146, v146, v214
    v_mul_f32 v147, v147, v215
    v_cvt_pk_bf16_f32 v148, v144, v145
    v_cvt_pk_bf16_f32 v149, v146, v147
    s_waitcnt lgkmcnt(2)
    v_mfma_f32_16x16x32_bf16 v[160:163], a[192:195], a[224:227], v[160:163]
    v_mul_f32 v216, s76, v152
    v_mul_f32 v217, s76, v153
    v_mfma_f32_16x16x32_bf16 v[164:167], a[192:195], a[228:231], v[164:167]
    s_lshl_b32 s86, s52, 7
    s_add_u32 s86, s86, 16384
    s_sub_u32 s86, s86, s80
    v_add_u32 v236, s86, v236
    v_add_u32 v237, s86, v237
    v_add_u32 v238, s86, v238
    v_add_u32 v239, s86, v239
    v_add_u32 v240, s86, v240
    v_mfma_f32_16x16x32_bf16 v[168:171], a[192:195], a[232:235], v[168:171]
    buffer_load_dwordx4 v225, s[40:43], s18 offen offset:2048 sc1 lds
    v_mfma_f32_16x16x32_bf16 v[172:175], a[192:195], a[236:239], v[172:175]
    v_mul_f32 v218, s76, v154
    v_mul_f32 v219, s76, v155
    v_mfma_f32_16x16x32_bf16 v[176:179], a[192:195], a[240:243], v[176:179]
    v_exp_f32 v216, v216
    v_mfma_f32_16x16x32_bf16 v[180:183], a[192:195], a[244:247], v[180:183]
    v_exp_f32 v217, v217
    v_mfma_f32_16x16x32_bf16 v[184:187], a[192:195], a[248:251], v[184:187]
    buffer_load_dwordx4 a[32:35], v250, s[40:43], s63 offen sc1
    v_mfma_f32_16x16x32_bf16 v[188:191], a[192:195], a[252:255], v[188:191]
    v_exp_f32 v218, v218
    v_mfma_f32_16x16x32_bf16 v[164:167], a[196:199], a[224:227], v[164:167]
    s_waitcnt vmcnt(25) lgkmcnt(0)
    s_barrier
    v_mfma_f32_16x16x32_bf16 v[168:171], a[196:199], a[228:231], v[168:171]
    ds_read2_b32 v[32:33], v236 offset0:0 offset1:1
    ds_read2_b32 v[34:35], v236 offset0:2 offset1:3
    v_mfma_f32_16x16x32_bf16 v[172:175], a[196:199], a[232:235], v[172:175]
    buffer_load_dwordx4 a[36:39], v250, s[40:43], s63 offen offset:256 sc1
    v_mfma_f32_16x16x32_bf16 v[176:179], a[196:199], a[236:239], v[176:179]
    ds_read_b128 v[64:67], v240 offset:3584
    ds_read_b128 v[68:71], v240 offset:3072
    v_mfma_f32_16x16x32_bf16 v[180:183], a[196:199], a[240:243], v[180:183]
    ds_read_b128 v[72:75], v240 offset:2560
    ds_read_b128 v[76:79], v240 offset:2048
    v_mfma_f32_16x16x32_bf16 v[184:187], a[196:199], a[244:247], v[184:187]
    v_exp_f32 v219, v219
    v_mfma_f32_16x16x32_bf16 v[188:191], a[196:199], a[248:251], v[188:191]
    buffer_load_dwordx4 a[40:43], v250, s[40:43], s63 offen offset:2048 sc1
    v_mfma_f32_16x16x32_bf16 v[168:171], a[200:203], a[224:227], v[168:171]
    ds_read_b128 v[80:83], v240 offset:1536
    ds_read_b128 v[84:87], v240 offset:1024
    v_mfma_f32_16x16x32_bf16 v[172:175], a[200:203], a[228:231], v[172:175]
    ds_read_b128 v[88:91], v240 offset:512
    ds_read_b128 v[92:95], v240
    v_mfma_f32_16x16x32_bf16 v[176:179], a[200:203], a[232:235], v[176:179]
    v_mul_f32 v152, v152, v156
    v_mul_f32 v153, v153, v157
    v_mfma_f32_16x16x32_bf16 v[180:183], a[200:203], a[236:239], v[180:183]
    buffer_load_dwordx4 a[44:47], v250, s[40:43], s63 offen offset:2304 sc1
    v_mfma_f32_16x16x32_bf16 v[184:187], a[200:203], a[240:243], v[184:187]
    ds_read2_b32 v[36:37], v236 offset0:128 offset1:129
    ds_read2_b32 v[38:39], v236 offset0:130 offset1:131
    v_mfma_f32_16x16x32_bf16 v[188:191], a[200:203], a[244:247], v[188:191]
    ds_read2_b32 v[40:41], v237 offset0:0 offset1:1
    ds_read2_b32 v[42:43], v237 offset0:2 offset1:3
    v_mfma_f32_16x16x32_bf16 v[172:175], a[204:207], a[224:227], v[172:175]
    ds_read2_b32 v[44:45], v237 offset0:128 offset1:129
    ds_read2_b32 v[46:47], v237 offset0:130 offset1:131
    v_mfma_f32_16x16x32_bf16 v[176:179], a[204:207], a[228:231], v[176:179]
    buffer_load_dwordx4 a[48:51], v226, s[40:43], s63 offen sc1
    v_mfma_f32_16x16x32_bf16 v[180:183], a[204:207], a[232:235], v[180:183]
    ds_read2_b32 v[48:49], v238 offset0:0 offset1:1
    ds_read2_b32 v[50:51], v238 offset0:2 offset1:3
    v_mfma_f32_16x16x32_bf16 v[184:187], a[204:207], a[236:239], v[184:187]
    v_mul_f32 v154, v154, v158
    v_mul_f32 v155, v155, v159
    v_mfma_f32_16x16x32_bf16 v[188:191], a[204:207], a[240:243], v[188:191]
    ds_read2_b32 v[52:53], v238 offset0:128 offset1:129
    ds_read2_b32 v[54:55], v238 offset0:130 offset1:131
    v_mfma_f32_16x16x32_bf16 v[176:179], a[208:211], a[224:227], v[176:179]
    buffer_load_dwordx4 a[52:55], v226, s[40:43], s63 offen offset:256 sc1
    v_mfma_f32_16x16x32_bf16 v[180:183], a[208:211], a[228:231], v[180:183]
    ds_read2_b32 v[56:57], v239 offset0:0 offset1:1
    ds_read2_b32 v[58:59], v239 offset0:2 offset1:3
    v_mfma_f32_16x16x32_bf16 v[184:187], a[208:211], a[232:235], v[184:187]
    v_add_f32 v216, 1.0, v216
    v_add_f32 v217, 1.0, v217
    v_mfma_f32_16x16x32_bf16 v[188:191], a[208:211], a[236:239], v[188:191]
    ds_read2_b32 v[60:61], v239 offset0:128 offset1:129
    ds_read2_b32 v[62:63], v239 offset0:130 offset1:131
    v_mfma_f32_16x16x32_bf16 v[180:183], a[212:215], a[224:227], v[180:183]
    buffer_load_dwordx4 a[56:59], v226, s[40:43], s63 offen offset:2048 sc1
    v_add_f32 v218, 1.0, v218
    v_add_f32 v219, 1.0, v219
    v_rcp_f32 v216, v216
    v_rcp_f32 v217, v217
    v_rcp_f32 v218, v218
    v_rcp_f32 v219, v219
    v_mul_f32 v152, v152, v216
    v_mul_f32 v153, v153, v217
    v_mul_f32 v154, v154, v218
    v_mul_f32 v155, v155, v219
    v_cvt_pk_bf16_f32 v150, v152, v153
    v_cvt_pk_bf16_f32 v151, v154, v155
    buffer_store_dwordx4 v[148:151], v244, s[40:43], s75 offen sc1
    v_mfma_f32_16x16x32_bf16 v[184:187], a[212:215], a[228:231], v[184:187]
    v_mfma_f32_16x16x32_bf16 v[188:191], a[212:215], a[232:235], v[188:191]
    v_mfma_f32_16x16x32_bf16 v[184:187], a[216:219], a[224:227], v[184:187]
    v_mfma_f32_16x16x32_bf16 v[188:191], a[216:219], a[228:231], v[188:191]
    buffer_load_dwordx4 a[60:63], v226, s[40:43], s63 offen offset:2304 sc1
    v_mfma_f32_16x16x32_bf16 v[188:191], a[220:223], a[224:227], v[188:191]
    s_waitcnt lgkmcnt(0)
    v_mfma_f32_16x16x32_bf16 v[128:131], v[32:35], v[64:67], 0
    v_mfma_f32_16x16x32_bf16 v[132:135], v[32:35], v[68:71], 0
    ds_read2_b32 a[192:193], v236 offset0:16 offset1:17
    ds_read2_b32 a[194:195], v236 offset0:18 offset1:19
    v_mfma_f32_16x16x32_bf16 v[136:139], v[32:35], v[72:75], 0
    buffer_load_dwordx4 a[64:67], v250, s[40:43], s64 offen sc1
    v_mfma_f32_16x16x32_bf16 v[140:143], v[32:35], v[76:79], 0
    ds_read_b128 a[224:227], v240 offset:3648
    ds_read_b128 a[228:231], v240 offset:3136
    v_mfma_f32_16x16x32_bf16 v[144:147], v[32:35], v[80:83], 0
    v_nop
    s_bitcmp1_b32 s52, 0
    s_cbranch_scc0 SW1T
    v_swap_b32 v160, v176
    v_swap_b32 v161, v177
    v_swap_b32 v162, v178
    v_swap_b32 v163, v179
    v_swap_b32 v164, v180
    v_swap_b32 v165, v181
    v_swap_b32 v166, v182
    v_swap_b32 v167, v183
    v_swap_b32 v168, v184
    v_swap_b32 v169, v185
    v_swap_b32 v170, v186
    v_swap_b32 v171, v187
    v_swap_b32 v172, v188
    v_swap_b32 v173, v189
    v_swap_b32 v174, v190
    v_swap_b32 v175, v191
SW1T:
    v_mfma_f32_16x16x32_bf16 v[148:151], v[32:35], v[84:87], 0
    v_mfma_f32_16x16x32_bf16 v[152:155], v[32:35], v[88:91], 0
    buffer_load_dwordx4 a[68:71], v250, s[40:43], s64 offen offset:256 sc1
    v_mfma_f32_16x16x32_bf16 v[156:159], v[32:35], v[92:95], 0
    ds_read_b128 a[232:235], v240 offset:2624
    ds_read_b128 a[236:239], v240 offset:2112
    v_mfma_f32_16x16x32_bf16 v[132:135], v[36:39], v[64:67], v[132:135]
    ds_read_b128 a[240:243], v240 offset:1600
    ds_read_b128 a[244:247], v240 offset:1088
    v_mfma_f32_16x16x32_bf16 v[136:139], v[36:39], v[68:71], v[136:139]
    v_mfma_f32_16x16x32_bf16 v[140:143], v[36:39], v[72:75], v[140:143]
    buffer_load_dwordx4 a[72:75], v250, s[40:43], s64 offen offset:2048 sc1
    v_mfma_f32_16x16x32_bf16 v[144:147], v[36:39], v[76:79], v[144:147]
    ds_write_b128 v253, v[176:179]
    ds_write_b128 v253, v[180:183] offset:1024
    v_mfma_f32_16x16x32_bf16 v[148:151], v[36:39], v[80:83], v[148:151]
    ds_write_b128 v253, v[184:187] offset:2048
    ds_write_b128 v253, v[188:191] offset:3072
    v_mfma_f32_16x16x32_bf16 v[152:155], v[36:39], v[84:87], v[152:155]
    ds_read_b128 a[248:251], v240 offset:576
    ds_read_b128 a[252:255], v240 offset:64
    v_mfma_f32_16x16x32_bf16 v[156:159], v[36:39], v[88:91], v[156:159]
    ds_read2_b32 a[196:197], v236 offset0:144 offset1:145
    ds_read2_b32 a[198:199], v236 offset0:146 offset1:147
    v_mfma_f32_16x16x32_bf16 v[136:139], v[40:43], v[64:67], v[136:139]
    buffer_load_dwordx4 a[76:79], v250, s[40:43], s64 offen offset:2304 sc1
    v_mfma_f32_16x16x32_bf16 v[140:143], v[40:43], v[68:71], v[140:143]
    s_waitcnt lgkmcnt(4)
    s_barrier
    v_mfma_f32_16x16x32_bf16 v[144:147], v[40:43], v[72:75], v[144:147]
    ds_read2_b32 a[200:201], v237 offset0:16 offset1:17
    ds_read2_b32 a[202:203], v237 offset0:18 offset1:19
    v_mfma_f32_16x16x32_bf16 v[148:151], v[40:43], v[76:79], v[148:151]
    buffer_load_dwordx4 a[80:83], v226, s[40:43], s64 offen sc1
    v_mfma_f32_16x16x32_bf16 v[152:155], v[40:43], v[80:83], v[152:155]
    ds_read2_b32 a[204:205], v237 offset0:144 offset1:145
    ds_read2_b32 a[206:207], v237 offset0:146 offset1:147
    v_mfma_f32_16x16x32_bf16 v[156:159], v[40:43], v[84:87], v[156:159]
    ds_read_b64 v[208:209], v241 offset:3584
    ds_read_b64 v[210:211], v241 offset:3072
    v_mfma_f32_16x16x32_bf16 v[140:143], v[44:47], v[64:67], v[140:143]
    ds_read2_b32 a[208:209], v238 offset0:16 offset1:17
    ds_read2_b32 a[210:211], v238 offset0:18 offset1:19
    v_mfma_f32_16x16x32_bf16 v[144:147], v[44:47], v[68:71], v[144:147]
    buffer_load_dwordx4 a[84:87], v226, s[40:43], s64 offen offset:256 sc1
    v_mfma_f32_16x16x32_bf16 v[148:151], v[44:47], v[72:75], v[148:151]
    ds_read2_b32 a[212:213], v238 offset0:144 offset1:145
    ds_read2_b32 a[214:215], v238 offset0:146 offset1:147
    v_mfma_f32_16x16x32_bf16 v[152:155], v[44:47], v[76:79], v[152:155]
    ds_read_b64 v[212:213], v241 offset:2560
    ds_read_b64 v[214:215], v241 offset:2048
    v_mfma_f32_16x16x32_bf16 v[156:159], v[44:47], v[80:83], v[156:159]
    ds_read_b128 v[192:195], v254
    ds_read_b128 v[196:199], v254 offset:1024
    v_mfma_f32_16x16x32_bf16 v[144:147], v[48:51], v[64:67], v[144:147]
    buffer_load_dwordx4 a[88:91], v226, s[40:43], s64 offen offset:2048 sc1
    v_mfma_f32_16x16x32_bf16 v[148:151], v[48:51], v[68:71], v[148:151]
    ds_read2_b32 a[216:217], v239 offset0:16 offset1:17
    ds_read2_b32 a[218:219], v239 offset0:18 offset1:19
    v_mfma_f32_16x16x32_bf16 v[152:155], v[48:51], v[72:75], v[152:155]
    ds_read2_b32 a[220:221], v239 offset0:144 offset1:145
    ds_read2_b32 a[222:223], v239 offset0:146 offset1:147
    v_mfma_f32_16x16x32_bf16 v[156:159], v[48:51], v[76:79], v[156:159]
    ds_read_b128 v[200:203], v254 offset:2048
    ds_read_b128 v[204:207], v254 offset:3072
    v_mfma_f32_16x16x32_bf16 v[148:151], v[52:55], v[64:67], v[148:151]
    buffer_load_dwordx4 a[92:95], v226, s[40:43], s64 offen offset:2304 sc1
    v_mfma_f32_16x16x32_bf16 v[152:155], v[52:55], v[68:71], v[152:155]
    s_waitcnt lgkmcnt(0)
    v_add_f32 v160, v160, v192
    v_mfma_f32_16x16x32_bf16 v[156:159], v[52:55], v[72:75], v[156:159]
    v_add_f32 v161, v161, v193
    v_add_f32 v162, v162, v194
    v_mfma_f32_16x16x32_bf16 v[152:155], v[56:59], v[64:67], v[152:155]
    v_add_f32 v163, v163, v195
    v_add_f32 v164, v164, v196
    v_mfma_f32_16x16x32_bf16 v[156:159], v[56:59], v[68:71], v[156:159]
    buffer_load_dwordx4 a[96:99], v250, s[40:43], s65 offen sc1
    v_mfma_f32_16x16x32_bf16 v[156:159], v[60:63], v[64:67], v[156:159]
    v_add_f32 v165, v165, v197
    v_add_f32 v166, v166, v198
    v_mfma_f32_16x16x32_bf16 v[128:131], a[192:195], a[224:227], v[128:131]
    v_add_f32 v167, v167, v199
    v_add_f32 v168, v168, v200
    v_mfma_f32_16x16x32_bf16 v[132:135], a[192:195], a[228:231], v[132:135]
    v_add_f32 v169, v169, v201
    v_add_f32 v170, v170, v202
    v_mfma_f32_16x16x32_bf16 v[136:139], a[192:195], a[232:235], v[136:139]
    buffer_load_dwordx4 a[100:103], v250, s[40:43], s65 offen offset:256 sc1
    v_mfma_f32_16x16x32_bf16 v[140:143], a[192:195], a[236:239], v[140:143]
    v_add_f32 v171, v171, v203
    v_add_f32 v172, v172, v204
    v_mfma_f32_16x16x32_bf16 v[144:147], a[192:195], a[240:243], v[144:147]
    v_add_f32 v173, v173, v205
    v_add_f32 v174, v174, v206
    v_mfma_f32_16x16x32_bf16 v[148:151], a[192:195], a[244:247], v[148:151]
    v_add_f32 v175, v175, v207
    v_and_b32 v216, s99, v209
    v_mfma_f32_16x16x32_bf16 v[152:155], a[192:195], a[248:251], v[152:155]
    buffer_load_dwordx4 a[104:107], v250, s[40:43], s65 offen offset:2048 sc1
    v_mfma_f32_16x16x32_bf16 v[156:159], a[192:195], a[252:255], v[156:159]
    v_lshlrev_b32 v217, 16, v209
    v_and_b32 v218, s99, v208
    v_mfma_f32_16x16x32_bf16 v[132:135], a[196:199], a[224:227], v[132:135]
    v_lshlrev_b32 v219, 16, v208
    v_fmac_f32 v160, s98, v216
    v_mfma_f32_16x16x32_bf16 v[136:139], a[196:199], a[228:231], v[136:139]
    v_fmac_f32 v161, s98, v217
    v_fmac_f32 v162, s98, v218
    v_mfma_f32_16x16x32_bf16 v[140:143], a[196:199], a[232:235], v[140:143]
    buffer_load_dwordx4 a[108:111], v250, s[40:43], s65 offen offset:2304 sc1
    v_mfma_f32_16x16x32_bf16 v[144:147], a[196:199], a[236:239], v[144:147]
    v_fmac_f32 v163, s98, v219
    v_cvt_pk_bf16_f32 v208, v160, v161
    v_mfma_f32_16x16x32_bf16 v[148:151], a[196:199], a[240:243], v[148:151]
    v_cvt_pk_bf16_f32 v209, v162, v163
    v_and_b32 v216, s99, v211
    v_mfma_f32_16x16x32_bf16 v[152:155], a[196:199], a[244:247], v[152:155]
    buffer_store_dwordx2 v[208:209], v249, s[40:43], s100 offen sc1
    v_mfma_f32_16x16x32_bf16 v[156:159], a[196:199], a[248:251], v[156:159]
    buffer_load_dwordx4 a[112:115], v226, s[40:43], s65 offen sc1
    v_mfma_f32_16x16x32_bf16 v[136:139], a[200:203], a[224:227], v[136:139]
    v_lshlrev_b32 v217, 16, v211
    v_and_b32 v218, s99, v210
    v_mfma_f32_16x16x32_bf16 v[140:143], a[200:203], a[228:231], v[140:143]
    v_lshlrev_b32 v219, 16, v210
    v_fmac_f32 v164, s98, v216
    v_mfma_f32_16x16x32_bf16 v[144:147], a[200:203], a[232:235], v[144:147]
    v_fmac_f32 v165, s98, v217
    v_fmac_f32 v166, s98, v218
    v_mfma_f32_16x16x32_bf16 v[148:151], a[200:203], a[236:239], v[148:151]
    buffer_load_dwordx4 a[116:119], v226, s[40:43], s65 offen offset:256 sc1
    v_mfma_f32_16x16x32_bf16 v[152:155], a[200:203], a[240:243], v[152:155]
    v_fmac_f32 v167, s98, v219
    v_cvt_pk_bf16_f32 v210, v164, v165
    v_mfma_f32_16x16x32_bf16 v[156:159], a[200:203], a[244:247], v[156:159]
    v_cvt_pk_bf16_f32 v211, v166, v167
    v_and_b32 v216, s99, v213
    v_mfma_f32_16x16x32_bf16 v[140:143], a[204:207], a[224:227], v[140:143]
    v_lshlrev_b32 v217, 16, v213
    v_and_b32 v218, s99, v212
    v_mfma_f32_16x16x32_bf16 v[144:147], a[204:207], a[228:231], v[144:147]
    buffer_load_dwordx4 a[120:123], v226, s[40:43], s65 offen offset:2048 sc1
    v_mfma_f32_16x16x32_bf16 v[148:151], a[204:207], a[232:235], v[148:151]
    v_lshlrev_b32 v219, 16, v212
    v_fmac_f32 v168, s98, v216
    v_mfma_f32_16x16x32_bf16 v[152:155], a[204:207], a[236:239], v[152:155]
    v_fmac_f32 v169, s98, v217
    v_fmac_f32 v170, s98, v218
    v_mfma_f32_16x16x32_bf16 v[156:159], a[204:207], a[240:243], v[156:159]
    v_fmac_f32 v171, s98, v219
    v_cvt_pk_bf16_f32 v212, v168, v169
    v_mfma_f32_16x16x32_bf16 v[144:147], a[208:211], a[224:227], v[144:147]
    s_waitcnt vmcnt(17)
    v_mov_b32 v242, s77
    s_mov_b64 exec, 1
    buffer_store_dword v242, off, s[40:43], s101 offset:64 sc1
    s_mov_b64 exec, -1
    v_mfma_f32_16x16x32_bf16 v[148:151], a[208:211], a[228:231], v[148:151]
    s_barrier
    buffer_store_dwordx2 v[210:211], v249, s[40:43], s100 offen offset:512 sc1
    v_mfma_f32_16x16x32_bf16 v[152:155], a[208:211], a[232:235], v[152:155]
    ds_read_b128 v[104:107], v244 offset:32768
    v_cvt_pk_bf16_f32 v213, v170, v171
    v_mfma_f32_16x16x32_bf16 v[156:159], a[208:211], a[236:239], v[156:159]
    buffer_load_dwordx4 a[124:127], v226, s[40:43], s65 offen offset:2304 sc1
    v_mfma_f32_16x16x32_bf16 v[148:151], a[212:215], a[224:227], v[148:151]
    ds_read_b128 v[108:111], v244 offset:33792
    v_and_b32 v216, s99, v215
    v_mfma_f32_16x16x32_bf16 v[152:155], a[212:215], a[228:231], v[152:155]
    v_lshlrev_b32 v217, 16, v215
    v_and_b32 v218, s99, v214
    v_mfma_f32_16x16x32_bf16 v[156:159], a[212:215], a[232:235], v[156:159]
    ds_read_b128 v[112:115], v244 offset:34816
    buffer_store_dwordx2 v[212:213], v249, s[40:43], s100 offen offset:1024 sc1
    v_lshlrev_b32 v219, 16, v214
    v_fmac_f32 v172, s98, v216
    v_fmac_f32 v173, s98, v217
    v_fmac_f32 v174, s98, v218
    v_fmac_f32 v175, s98, v219
    v_cvt_pk_bf16_f32 v214, v172, v173
    v_cvt_pk_bf16_f32 v215, v174, v175
    buffer_store_dwordx2 v[214:215], v249, s[40:43], s100 offen offset:1536 sc1
    v_mfma_f32_16x16x32_bf16 v[152:155], a[216:219], a[224:227], v[152:155]
    buffer_load_dwordx4 a[128:131], v250, s[40:43], s66 offen sc1
    v_mfma_f32_16x16x32_bf16 v[156:159], a[216:219], a[228:231], v[156:159]
    ds_read_b128 v[116:119], v244 offset:35840
    v_mfma_f32_16x16x32_bf16 v[156:159], a[220:223], a[224:227], v[156:159]
    s_waitcnt lgkmcnt(2)
    v_mfma_f32_16x16x32_bf16 v[48:51], v[104:107], v[0:3], 0
    ds_read_b128 v[120:123], v244 offset:36864
    v_mfma_f32_16x16x32_bf16 v[52:55], v[104:107], v[4:7], 0
    buffer_load_dwordx4 a[132:135], v250, s[40:43], s66 offen offset:256 sc1
    v_mfma_f32_16x16x32_bf16 v[56:59], v[108:111], v[0:3], 0
    ds_read_b128 v[124:127], v244 offset:37888
    v_mfma_f32_16x16x32_bf16 v[60:63], v[108:111], v[4:7], 0
    s_waitcnt lgkmcnt(2)
    v_mfma_f32_16x16x32_bf16 v[64:67], v[112:115], v[0:3], 0
    ds_read_b128 v[104:107], v244 offset:38912
    v_mfma_f32_16x16x32_bf16 v[68:71], v[112:115], v[4:7], 0
    buffer_load_dwordx4 a[136:139], v250, s[40:43], s66 offen offset:2048 sc1
    v_mfma_f32_16x16x32_bf16 v[72:75], v[116:119], v[0:3], 0
    ds_read_b128 v[108:111], v244 offset:39936
    v_mfma_f32_16x16x32_bf16 v[76:79], v[116:119], v[4:7], 0
    s_waitcnt lgkmcnt(2)
    v_mfma_f32_16x16x32_bf16 v[48:51], v[120:123], v[8:11], v[48:51]
    ds_read_b128 v[112:115], v244 offset:40960
    v_mfma_f32_16x16x32_bf16 v[52:55], v[120:123], v[12:15], v[52:55]
    buffer_load_dwordx4 a[140:143], v250, s[40:43], s66 offen offset:2304 sc1
    v_mfma_f32_16x16x32_bf16 v[56:59], v[124:127], v[8:11], v[56:59]
    ds_read_b128 v[116:119], v244 offset:41984
    v_mfma_f32_16x16x32_bf16 v[60:63], v[124:127], v[12:15], v[60:63]
    s_waitcnt lgkmcnt(2)
    v_mfma_f32_16x16x32_bf16 v[64:67], v[104:107], v[8:11], v[64:67]
    ds_read_b128 v[120:123], v244 offset:43008
    v_mfma_f32_16x16x32_bf16 v[68:71], v[104:107], v[12:15], v[68:71]
    buffer_load_dwordx4 a[144:147], v226, s[40:43], s66 offen sc1
    v_mfma_f32_16x16x32_bf16 v[72:75], v[108:111], v[8:11], v[72:75]
    ds_read_b128 v[124:127], v244 offset:44032
    v_mfma_f32_16x16x32_bf16 v[76:79], v[108:111], v[12:15], v[76:79]
    s_waitcnt lgkmcnt(2)
    v_mfma_f32_16x16x32_bf16 v[48:51], v[112:115], v[16:19], v[48:51]
    ds_read_b128 v[104:107], v244 offset:45056
    v_mfma_f32_16x16x32_bf16 v[52:55], v[112:115], v[20:23], v[52:55]
    buffer_load_dwordx4 a[148:151], v226, s[40:43], s66 offen offset:256 sc1
    v_mfma_f32_16x16x32_bf16 v[56:59], v[116:119], v[16:19], v[56:59]
    ds_read_b128 v[108:111], v244 offset:46080
    v_mfma_f32_16x16x32_bf16 v[60:63], v[116:119], v[20:23], v[60:63]
    s_waitcnt lgkmcnt(2)
    v_mfma_f32_16x16x32_bf16 v[64:67], v[120:123], v[16:19], v[64:67]
    ds_read_b128 v[112:115], v244 offset:47104
    v_mfma_f32_16x16x32_bf16 v[68:71], v[120:123], v[20:23], v[68:71]
    buffer_load_dwordx4 a[152:155], v226, s[40:43], s66 offen offset:2048 sc1
    v_mfma_f32_16x16x32_bf16 v[72:75], v[124:127], v[16:19], v[72:75]
    ds_read_b128 v[116:119], v244 offset:48128
    v_mfma_f32_16x16x32_bf16 v[76:79], v[124:127], v[20:23], v[76:79]
    s_waitcnt lgkmcnt(2)
    v_mfma_f32_16x16x32_bf16 v[48:51], v[104:107], v[24:27], v[48:51]
    ds_read_b128 v[120:123], v244 offset:49152
    v_mfma_f32_16x16x32_bf16 v[52:55], v[104:107], v[28:31], v[52:55]
    buffer_load_dwordx4 a[156:159], v226, s[40:43], s66 offen offset:2304 sc1
    v_mfma_f32_16x16x32_bf16 v[56:59], v[108:111], v[24:27], v[56:59]
    ds_read_b128 v[124:127], v244 offset:50176
    v_mfma_f32_16x16x32_bf16 v[60:63], v[108:111], v[28:31], v[60:63]
    s_waitcnt lgkmcnt(2)
    v_mfma_f32_16x16x32_bf16 v[64:67], v[112:115], v[24:27], v[64:67]
    ds_read_b128 v[104:107], v244 offset:51200
    v_mfma_f32_16x16x32_bf16 v[68:71], v[112:115], v[28:31], v[68:71]
    v_nop
    s_bitcmp1_b32 s52, 1
    s_cbranch_scc0 SW2T
    v_swap_b32 v128, v144
    v_swap_b32 v129, v145
    v_swap_b32 v130, v146
    v_swap_b32 v131, v147
    v_swap_b32 v132, v148
    v_swap_b32 v133, v149
    v_swap_b32 v134, v150
    v_swap_b32 v135, v151
    v_swap_b32 v136, v152
    v_swap_b32 v137, v153
    v_swap_b32 v138, v154
    v_swap_b32 v139, v155
    v_swap_b32 v140, v156
    v_swap_b32 v141, v157
    v_swap_b32 v142, v158
KF_PG11:
    s_cbranch_execz KF_PG5
    v_swap_b32 v143, v159
SW2T:
    v_mfma_f32_16x16x32_bf16 v[72:75], v[116:119], v[24:27], v[72:75]
    ds_read_b128 v[108:111], v244 offset:53248
    v_mfma_f32_16x16x32_bf16 v[76:79], v[116:119], v[28:31], v[76:79]
    s_waitcnt lgkmcnt(2)
    v_mfma_f32_16x16x32_bf16 v[80:83], v[120:123], v[0:3], 0
    ds_read_b128 v[112:115], v244 offset:54272
    v_mfma_f32_16x16x32_bf16 v[84:87], v[120:123], v[4:7], 0
    v_nop
    s_bitcmp1_b32 s52, 0
    s_cbranch_scc0 SW3T
    v_swap_b32 v128, v136
    v_swap_b32 v129, v137
    v_swap_b32 v130, v138
    v_swap_b32 v131, v139
    v_swap_b32 v132, v140
    v_swap_b32 v133, v141
    v_swap_b32 v134, v142
    v_swap_b32 v135, v143
    v_swap_b32 v144, v152
    v_swap_b32 v145, v153
    v_swap_b32 v146, v154
    v_swap_b32 v147, v155
    v_swap_b32 v148, v156
    v_swap_b32 v149, v157
    v_swap_b32 v150, v158
    v_swap_b32 v151, v159
SW3T:
    v_mfma_f32_16x16x32_bf16 v[88:91], v[124:127], v[0:3], 0
    ds_read_b128 v[116:119], v244 offset:55296
    s_add_u32 s83, s6, 512
    s_lshr_b32 s83, s83, 1
    s_lshl_b32 s83, s83, 2
    s_load_dword s98, s[14:15], s83
    s_add_u32 s100, s78, 26542080
    s_sub_u32 s83, 25208, s92
    v_sub_u32 v241, s83, v249
    s_mul_i32 s83, s52, 6144
    s_add_u32 s83, s83, 98304
    v_add_u32 v254, s83, v244
    s_xor_b32 s83, s52, 1
    s_mul_i32 s83, s83, 6144
    s_add_u32 s83, s83, 98304
    v_add_u32 v253, s83, v244
    ds_write_b128 v253, v[136:139]
    ds_write_b128 v253, v[140:143] offset:1024
    s_xor_b32 s83, s52, 2
    s_mul_i32 s83, s83, 6144
    s_add_u32 s83, s83, 100352
    v_add_u32 v253, s83, v244
    ds_write_b128 v253, v[144:147]
    ds_write_b128 v253, v[148:151] offset:1024
    s_xor_b32 s83, s52, 3
    s_mul_i32 s83, s83, 6144
    s_add_u32 s83, s83, 102400
    v_add_u32 v253, s83, v244
    ds_write_b128 v253, v[152:155]
    ds_write_b128 v253, v[156:159] offset:1024
    v_mfma_f32_16x16x32_bf16 v[92:95], v[124:127], v[4:7], 0
    s_waitcnt lgkmcnt(8)
    v_mfma_f32_16x16x32_bf16 v[96:99], v[104:107], v[0:3], 0
    ds_read_b128 v[120:123], v244 offset:57344
    s_waitcnt lgkmcnt(0)
    s_lshl_b32 s83, s98, 16
    s_and_b32 s98, s98, s99
    s_bitcmp0_b32 s6, 0
    s_cselect_b32 s98, s83, s98
    s_barrier
    v_mfma_f32_16x16x32_bf16 v[100:103], v[104:107], v[4:7], 0
    ds_read_b64 v[208:209], v241 offset:3584
    v_mfma_f32_16x16x32_bf16 v[80:83], v[108:111], v[8:11], v[80:83]
    ds_read_b128 v[124:127], v244 offset:58368
    ds_read_b64 v[210:211], v241 offset:3072
    v_mfma_f32_16x16x32_bf16 v[84:87], v[108:111], v[12:15], v[84:87]
    ds_read_b128 v[192:195], v254
    v_mfma_f32_16x16x32_bf16 v[88:91], v[112:115], v[8:11], v[88:91]
    ds_read_b128 v[104:107], v244 offset:59392
    ds_read_b128 v[196:199], v254 offset:1024
    v_mfma_f32_16x16x32_bf16 v[92:95], v[112:115], v[12:15], v[92:95]
    ds_read_b128 v[200:203], v254 offset:2048
    v_mfma_f32_16x16x32_bf16 v[96:99], v[116:119], v[8:11], v[96:99]
    ds_read_b128 v[108:111], v244 offset:61440
    v_mfma_f32_16x16x32_bf16 v[100:103], v[116:119], v[12:15], v[100:103]
    ds_read_b128 v[204:207], v254 offset:3072
    s_waitcnt lgkmcnt(7)
    v_mfma_f32_16x16x32_bf16 v[80:83], v[120:123], v[16:19], v[80:83]
    ds_read_b128 v[112:115], v244 offset:62464
    v_mfma_f32_16x16x32_bf16 v[84:87], v[120:123], v[20:23], v[84:87]
    s_waitcnt lgkmcnt(1)
    v_add_f32 v128, v128, v192
    v_mfma_f32_16x16x32_bf16 v[88:91], v[124:127], v[16:19], v[88:91]
    ds_read_b128 v[116:119], v244 offset:63488
    v_add_f32 v129, v129, v193
    v_mfma_f32_16x16x32_bf16 v[92:95], v[124:127], v[20:23], v[92:95]
    s_barrier
    v_add_f32 v130, v130, v194
    v_mfma_f32_16x16x32_bf16 v[96:99], v[104:107], v[16:19], v[96:99]
    ds_read_b128 v[120:123], v251
    s_add_u32 m0, s91, 32768
    v_mfma_f32_16x16x32_bf16 v[100:103], v[104:107], v[20:23], v[100:103]
    buffer_load_dwordx4 v222, s[40:43], s19 offen sc1 lds
    v_mfma_f32_16x16x32_bf16 v[80:83], v[108:111], v[24:27], v[80:83]
    ds_read_b128 v[124:127], v251 offset:1024
    v_add_f32 v131, v131, v195
    v_mfma_f32_16x16x32_bf16 v[84:87], v[108:111], v[28:31], v[84:87]
    v_add_f32 v132, v132, v196
    s_waitcnt lgkmcnt(2)
    v_mfma_f32_16x16x32_bf16 v[88:91], v[112:115], v[24:27], v[88:91]
    ds_read_b128 v[104:107], v251 offset:2048
    v_add_f32 v133, v133, v197
    v_mfma_f32_16x16x32_bf16 v[92:95], v[112:115], v[28:31], v[92:95]
    buffer_load_dwordx4 v222, s[40:43], s19 offen offset:1024 sc1 lds
    v_mfma_f32_16x16x32_bf16 v[96:99], v[116:119], v[24:27], v[96:99]
    ds_read_b128 v[108:111], v251 offset:3072
    v_add_f32 v134, v134, v198
    v_mfma_f32_16x16x32_bf16 v[100:103], v[116:119], v[28:31], v[100:103]
    v_add_f32 v135, v135, v199
    s_waitcnt lgkmcnt(2)
    v_mfma_f32_16x16x32_bf16 v[48:51], v[120:123], a[0:3], v[48:51]
    ds_read_b128 v[112:115], v251 offset:4096
    v_add_f32 v128, v128, v200
    v_mfma_f32_16x16x32_bf16 v[52:55], v[120:123], a[4:7], v[52:55]
    buffer_load_dwordx4 v223, s[40:43], s19 offen offset:2048 sc1 lds
    v_mfma_f32_16x16x32_bf16 v[56:59], v[124:127], a[0:3], v[56:59]
    ds_read_b128 v[116:119], v251 offset:5120
    v_add_f32 v129, v129, v201
    v_mfma_f32_16x16x32_bf16 v[60:63], v[124:127], a[4:7], v[60:63]
    v_add_f32 v130, v130, v202
    s_waitcnt lgkmcnt(2)
    v_mfma_f32_16x16x32_bf16 v[64:67], v[104:107], a[0:3], v[64:67]
    ds_read_b128 v[120:123], v251 offset:6144
    v_add_f32 v131, v131, v203
    v_mfma_f32_16x16x32_bf16 v[68:71], v[104:107], a[4:7], v[68:71]
    buffer_load_dwordx4 v223, s[40:43], s19 offen offset:3072 sc1 lds
    v_mfma_f32_16x16x32_bf16 v[72:75], v[108:111], a[0:3], v[72:75]
    ds_read_b128 v[124:127], v251 offset:7168
    v_add_f32 v132, v132, v204
    v_mfma_f32_16x16x32_bf16 v[76:79], v[108:111], a[4:7], v[76:79]
    v_add_f32 v133, v133, v205
    s_waitcnt lgkmcnt(2)
    v_mfma_f32_16x16x32_bf16 v[48:51], v[112:115], a[8:11], v[48:51]
    ds_read_b128 v[104:107], v251 offset:8192
    v_add_f32 v134, v134, v206
    v_mfma_f32_16x16x32_bf16 v[52:55], v[112:115], a[12:15], v[52:55]
    v_add_f32 v135, v135, v207
    ds_read_b128 v[192:195], v254 offset:4096
    v_mfma_f32_16x16x32_bf16 v[56:59], v[116:119], a[8:11], v[56:59]
    ds_read_b128 v[108:111], v251 offset:9216
    ds_read_b128 v[196:199], v254 offset:5120
    v_mfma_f32_16x16x32_bf16 v[60:63], v[116:119], a[12:15], v[60:63]
    s_waitcnt lgkmcnt(4)
    v_mfma_f32_16x16x32_bf16 v[64:67], v[120:123], a[8:11], v[64:67]
    ds_read_b128 v[112:115], v251 offset:10240
    v_mfma_f32_16x16x32_bf16 v[68:71], v[120:123], a[12:15], v[68:71]
    v_mfma_f32_16x16x32_bf16 v[72:75], v[124:127], a[8:11], v[72:75]
    ds_read_b128 v[116:119], v251 offset:11264
    v_mfma_f32_16x16x32_bf16 v[76:79], v[124:127], a[12:15], v[76:79]
    s_waitcnt lgkmcnt(3)
    v_mfma_f32_16x16x32_bf16 v[48:51], v[104:107], a[16:19], v[48:51]
    ds_read_b128 v[120:123], v251 offset:12288
    v_mfma_f32_16x16x32_bf16 v[52:55], v[104:107], a[20:23], v[52:55]
    s_waitcnt lgkmcnt(3)
    v_add_f32 v128, v128, v192
    v_mfma_f32_16x16x32_bf16 v[56:59], v[108:111], a[16:19], v[56:59]
    ds_read_b128 v[124:127], v251 offset:13312
    v_add_f32 v129, v129, v193
    v_mfma_f32_16x16x32_bf16 v[60:63], v[108:111], a[20:23], v[60:63]
    v_add_f32 v130, v130, v194
    s_waitcnt lgkmcnt(2)
    v_mfma_f32_16x16x32_bf16 v[64:67], v[112:115], a[16:19], v[64:67]
    ds_read_b128 v[104:107], v251 offset:14336
    v_add_f32 v131, v131, v195
    v_mfma_f32_16x16x32_bf16 v[68:71], v[112:115], a[20:23], v[68:71]
    v_add_f32 v132, v132, v196
    v_add_f32 v133, v133, v197
    v_mfma_f32_16x16x32_bf16 v[72:75], v[116:119], a[16:19], v[72:75]
    ds_read_b128 v[108:111], v251 offset:15360
    v_add_f32 v134, v134, v198
    v_mfma_f32_16x16x32_bf16 v[76:79], v[116:119], a[20:23], v[76:79]
    v_add_f32 v135, v135, v199
    s_waitcnt lgkmcnt(2)
    v_mfma_f32_16x16x32_bf16 v[48:51], v[120:123], a[24:27], v[48:51]
    ds_read_b128 v[112:115], v251 offset:16384
    v_and_b32 v216, s99, v209
    v_mfma_f32_16x16x32_bf16 v[52:55], v[120:123], a[28:31], v[52:55]
    v_lshlrev_b32 v217, 16, v209
    v_and_b32 v218, s99, v208
    v_mfma_f32_16x16x32_bf16 v[56:59], v[124:127], a[24:27], v[56:59]
    ds_read_b128 v[116:119], v251 offset:17408
    v_lshlrev_b32 v219, 16, v208
    v_mfma_f32_16x16x32_bf16 v[60:63], v[124:127], a[28:31], v[60:63]
    v_fmac_f32 v128, s98, v216
    s_waitcnt lgkmcnt(2)
    v_mfma_f32_16x16x32_bf16 v[64:67], v[104:107], a[24:27], v[64:67]
    ds_read_b128 v[120:123], v251 offset:18432
    v_fmac_f32 v129, s98, v217
    v_mfma_f32_16x16x32_bf16 v[68:71], v[104:107], a[28:31], v[68:71]
    v_fmac_f32 v130, s98, v218
    v_fmac_f32 v131, s98, v219
    v_mfma_f32_16x16x32_bf16 v[72:75], v[108:111], a[24:27], v[72:75]
    ds_read_b128 v[124:127], v251 offset:20480
    v_cvt_pk_bf16_f32 v208, v128, v129
    v_mfma_f32_16x16x32_bf16 v[76:79], v[108:111], a[28:31], v[76:79]
    s_waitcnt lgkmcnt(2)
    v_mfma_f32_16x16x32_bf16 v[80:83], v[112:115], a[0:3], v[80:83]
    ds_read_b128 v[104:107], v251 offset:21504
    v_cvt_pk_bf16_f32 v209, v130, v131
    v_mfma_f32_16x16x32_bf16 v[84:87], v[112:115], a[4:7], v[84:87]
    buffer_store_dwordx2 v[208:209], v249, s[40:43], s100 offen sc1
    v_mfma_f32_16x16x32_bf16 v[88:91], v[116:119], a[0:3], v[88:91]
    ds_read_b128 v[108:111], v251 offset:22528
    v_mfma_f32_16x16x32_bf16 v[92:95], v[116:119], a[4:7], v[92:95]
    s_waitcnt lgkmcnt(2)
    v_mfma_f32_16x16x32_bf16 v[96:99], v[120:123], a[0:3], v[96:99]
    ds_read_b128 v[112:115], v251 offset:24576
    v_and_b32 v216, s99, v211
    v_mfma_f32_16x16x32_bf16 v[100:103], v[120:123], a[4:7], v[100:103]
    v_lshlrev_b32 v217, 16, v211
    v_mfma_f32_16x16x32_bf16 v[80:83], v[124:127], a[8:11], v[80:83]
    ds_read_b128 v[116:119], v251 offset:25600
    v_and_b32 v218, s99, v210
    v_mfma_f32_16x16x32_bf16 v[84:87], v[124:127], a[12:15], v[84:87]
    v_lshlrev_b32 v219, 16, v210
    s_waitcnt lgkmcnt(2)
    v_mfma_f32_16x16x32_bf16 v[88:91], v[104:107], a[8:11], v[88:91]
    ds_read_b128 v[120:123], v251 offset:26624
    v_fmac_f32 v132, s98, v216
    v_mfma_f32_16x16x32_bf16 v[92:95], v[104:107], a[12:15], v[92:95]
    v_fmac_f32 v133, s98, v217
    v_mfma_f32_16x16x32_bf16 v[96:99], v[108:111], a[8:11], v[96:99]
    ds_read_b128 v[124:127], v251 offset:28672
    v_fmac_f32 v134, s98, v218
    v_mfma_f32_16x16x32_bf16 v[100:103], v[108:111], a[12:15], v[100:103]
    v_fmac_f32 v135, s98, v219
    s_waitcnt lgkmcnt(2)
    v_mfma_f32_16x16x32_bf16 v[80:83], v[112:115], a[16:19], v[80:83]
    ds_read_b128 v[104:107], v251 offset:29696
    v_cvt_pk_bf16_f32 v210, v132, v133
    v_mfma_f32_16x16x32_bf16 v[84:87], v[112:115], a[20:23], v[84:87]
    v_cvt_pk_bf16_f32 v211, v134, v135
    v_mfma_f32_16x16x32_bf16 v[88:91], v[116:119], a[16:19], v[88:91]
    ds_read_b128 v[108:111], v251 offset:30720
    v_mfma_f32_16x16x32_bf16 v[92:95], v[116:119], a[20:23], v[92:95]
    s_barrier
    s_waitcnt lgkmcnt(2)
    v_mfma_f32_16x16x32_bf16 v[96:99], v[120:123], a[16:19], v[96:99]
    ds_read_b128 v[112:115], v252
    s_add_u32 m0, s91, 16384
    v_mfma_f32_16x16x32_bf16 v[100:103], v[120:123], a[20:23], v[100:103]
    buffer_load_dwordx4 v224, s[40:43], s19 offen sc1 lds
    v_mfma_f32_16x16x32_bf16 v[80:83], v[124:127], a[24:27], v[80:83]
    ds_read_b128 v[116:119], v252 offset:1024
    v_mfma_f32_16x16x32_bf16 v[84:87], v[124:127], a[28:31], v[84:87]
    s_waitcnt lgkmcnt(2)
    v_mfma_f32_16x16x32_bf16 v[88:91], v[104:107], a[24:27], v[88:91]
    ds_read_b128 v[120:123], v252 offset:2048
    v_mfma_f32_16x16x32_bf16 v[92:95], v[104:107], a[28:31], v[92:95]
    buffer_load_dwordx4 v224, s[40:43], s19 offen offset:1024 sc1 lds
    v_mfma_f32_16x16x32_bf16 v[96:99], v[108:111], a[24:27], v[96:99]
    ds_read_b128 v[124:127], v252 offset:3072
    buffer_store_dwordx2 v[210:211], v249, s[40:43], s100 offen offset:512 sc1
    v_mfma_f32_16x16x32_bf16 v[100:103], v[108:111], a[28:31], v[100:103]
    s_waitcnt lgkmcnt(2)
    v_mfma_f32_16x16x32_bf16 v[48:51], v[112:115], a[32:35], v[48:51]
    ds_read_b128 v[104:107], v252 offset:4096
    v_mfma_f32_16x16x32_bf16 v[52:55], v[112:115], a[36:39], v[52:55]
    buffer_load_dwordx4 v225, s[40:43], s19 offen offset:2048 sc1 lds
    v_mfma_f32_16x16x32_bf16 v[56:59], v[116:119], a[32:35], v[56:59]
    ds_read_b128 v[108:111], v252 offset:5120
    v_mfma_f32_16x16x32_bf16 v[60:63], v[116:119], a[36:39], v[60:63]
    s_waitcnt lgkmcnt(2)
    v_mfma_f32_16x16x32_bf16 v[64:67], v[120:123], a[32:35], v[64:67]
    ds_read_b128 v[112:115], v252 offset:6144
    s_add_u32 m0, s91, 49152
    v_mfma_f32_16x16x32_bf16 v[68:71], v[120:123], a[36:39], v[68:71]
    buffer_load_dwordx4 v222, s[40:43], s20 offen sc1 lds
    v_mfma_f32_16x16x32_bf16 v[72:75], v[124:127], a[32:35], v[72:75]
    ds_read_b128 v[116:119], v252 offset:7168
    v_mfma_f32_16x16x32_bf16 v[76:79], v[124:127], a[36:39], v[76:79]
    s_waitcnt lgkmcnt(2)
    v_mfma_f32_16x16x32_bf16 v[48:51], v[104:107], a[40:43], v[48:51]
    ds_read_b128 v[120:123], v252 offset:8192
    v_mfma_f32_16x16x32_bf16 v[52:55], v[104:107], a[44:47], v[52:55]
    buffer_load_dwordx4 v222, s[40:43], s20 offen offset:1024 sc1 lds
    v_mfma_f32_16x16x32_bf16 v[56:59], v[108:111], a[40:43], v[56:59]
    ds_read_b128 v[124:127], v252 offset:9216
    v_mfma_f32_16x16x32_bf16 v[60:63], v[108:111], a[44:47], v[60:63]
    s_waitcnt lgkmcnt(2)
    v_mfma_f32_16x16x32_bf16 v[64:67], v[112:115], a[40:43], v[64:67]
    ds_read_b128 v[104:107], v252 offset:10240
    v_mfma_f32_16x16x32_bf16 v[68:71], v[112:115], a[44:47], v[68:71]
    buffer_load_dwordx4 v223, s[40:43], s20 offen offset:2048 sc1 lds
    v_mfma_f32_16x16x32_bf16 v[72:75], v[116:119], a[40:43], v[72:75]
    ds_read_b128 v[108:111], v252 offset:11264
    v_mfma_f32_16x16x32_bf16 v[76:79], v[116:119], a[44:47], v[76:79]
    s_waitcnt lgkmcnt(2)
    v_mfma_f32_16x16x32_bf16 v[48:51], v[120:123], a[48:51], v[48:51]
    ds_read_b128 v[112:115], v252 offset:12288
    v_mfma_f32_16x16x32_bf16 v[52:55], v[120:123], a[52:55], v[52:55]
    buffer_load_dwordx4 v223, s[40:43], s20 offen offset:3072 sc1 lds
    v_mfma_f32_16x16x32_bf16 v[56:59], v[124:127], a[48:51], v[56:59]
    ds_read_b128 v[116:119], v252 offset:13312
    v_and_b32 v237, 15, v248
    v_mfma_f32_16x16x32_bf16 v[60:63], v[124:127], a[52:55], v[60:63]
    s_waitcnt lgkmcnt(2)
    v_mfma_f32_16x16x32_bf16 v[64:67], v[104:107], a[48:51], v[64:67]
    ds_read_b128 v[120:123], v252 offset:14336
    s_add_u32 m0, s91, 65536
    v_mfma_f32_16x16x32_bf16 v[68:71], v[104:107], a[52:55], v[68:71]
    buffer_load_dwordx4 v224, s[40:43], s20 offen sc1 lds
    v_mfma_f32_16x16x32_bf16 v[72:75], v[108:111], a[48:51], v[72:75]
    ds_read_b128 v[124:127], v252 offset:15360
    v_lshrrev_b32 v238, 4, v248
    v_mfma_f32_16x16x32_bf16 v[76:79], v[108:111], a[52:55], v[76:79]
    v_lshl_add_u32 v241, v237, 6, s91
    s_waitcnt vmcnt(43) lgkmcnt(2)
    v_mfma_f32_16x16x32_bf16 v[48:51], v[112:115], a[56:59], v[48:51]
    ds_read_b128 v[104:107], v252 offset:16384
    v_lshl_add_u32 v241, v238, 3, v241
    v_mfma_f32_16x16x32_bf16 v[52:55], v[112:115], a[60:63], v[52:55]
    buffer_load_dwordx4 v224, s[40:43], s20 offen offset:1024 sc1 lds
    v_mfma_f32_16x16x32_bf16 v[56:59], v[116:119], a[56:59], v[56:59]
    ds_read_b128 v[108:111], v252 offset:17408
    v_lshlrev_b32 v245, 2, v248
    v_mfma_f32_16x16x32_bf16 v[60:63], v[116:119], a[60:63], v[60:63]
    s_waitcnt lgkmcnt(2)
    v_mfma_f32_16x16x32_bf16 v[64:67], v[120:123], a[56:59], v[64:67]
    ds_read_b128 v[112:115], v252 offset:18432
    v_and_b32 v245, 48, v245
    v_mfma_f32_16x16x32_bf16 v[68:71], v[120:123], a[60:63], v[68:71]
    buffer_load_dwordx4 v225, s[40:43], s20 offen offset:2048 sc1 lds
    v_mfma_f32_16x16x32_bf16 v[72:75], v[124:127], a[56:59], v[72:75]
    ds_read_b128 v[116:119], v252 offset:20480
    v_mfma_f32_16x16x32_bf16 v[76:79], v[124:127], a[60:63], v[76:79]
    v_xor_b32 v241, v241, v245
    s_waitcnt lgkmcnt(2)
    v_mfma_f32_16x16x32_bf16 v[80:83], v[104:107], a[32:35], v[80:83]
    ds_read_b128 v[120:123], v252 offset:21504
    s_add_u32 m0, s91, 98304
    v_mfma_f32_16x16x32_bf16 v[84:87], v[104:107], a[36:39], v[84:87]
    buffer_load_dwordx4 v222, s[40:43], s21 offen sc1 lds
    v_mfma_f32_16x16x32_bf16 v[88:91], v[108:111], a[32:35], v[88:91]
    ds_read_b128 v[124:127], v252 offset:22528
    v_xor_b32 v245, 32, v241
    v_mfma_f32_16x16x32_bf16 v[92:95], v[108:111], a[36:39], v[92:95]
    v_add_u32 v253, s91, v244
    s_waitcnt lgkmcnt(2)
    v_mfma_f32_16x16x32_bf16 v[96:99], v[112:115], a[32:35], v[96:99]
    ds_read_b128 v[104:107], v252 offset:24576
    v_mfma_f32_16x16x32_bf16 v[100:103], v[112:115], a[36:39], v[100:103]
    buffer_load_dword v220, v255, s[40:43], s57 offen offset:64 sc1
    v_mfma_f32_16x16x32_bf16 v[80:83], v[116:119], a[40:43], v[80:83]
    ds_read_b128 v[108:111], v252 offset:25600
    s_mov_b32 s80, 0x33333333
    v_mfma_f32_16x16x32_bf16 v[84:87], v[116:119], a[44:47], v[84:87]
    s_mov_b32 s81, 0xcccccccc
    s_waitcnt lgkmcnt(2)
    v_mfma_f32_16x16x32_bf16 v[88:91], v[120:123], a[40:43], v[88:91]
    ds_read_b128 v[112:115], v252 offset:26624
    v_mfma_f32_16x16x32_bf16 v[92:95], v[120:123], a[44:47], v[92:95]
    buffer_load_dwordx4 v222, s[40:43], s21 offen offset:1024 sc1 lds
    v_mfma_f32_16x16x32_bf16 v[96:99], v[124:127], a[40:43], v[96:99]
    ds_read_b128 v[116:119], v252 offset:28672
    s_add_u32 s83, s91, 3072
    v_mfma_f32_16x16x32_bf16 v[100:103], v[124:127], a[44:47], v[100:103]
    s_waitcnt lgkmcnt(2)
    v_mfma_f32_16x16x32_bf16 v[80:83], v[104:107], a[48:51], v[80:83]
    ds_read_b128 v[120:123], v252 offset:29696
    v_lshl_add_u32 v237, v237, 2, s83
    v_mfma_f32_16x16x32_bf16 v[84:87], v[104:107], a[52:55], v[84:87]
    buffer_load_dwordx4 v223, s[40:43], s21 offen offset:2048 sc1 lds
    v_mfma_f32_16x16x32_bf16 v[88:91], v[108:111], a[48:51], v[88:91]
    ds_read_b128 v[124:127], v252 offset:30720
    v_lshlrev_b32 v236, 2, v248
    v_mfma_f32_16x16x32_bf16 v[92:95], v[108:111], a[52:55], v[92:95]
    s_waitcnt vmcnt(11)
    s_barrier
    s_waitcnt lgkmcnt(2)
    v_mfma_f32_16x16x32_bf16 v[96:99], v[112:115], a[48:51], v[96:99]
    ds_read_b128 v[104:107], v244 offset:32768
    v_lshrrev_b32 v238, 2, v248
    v_mfma_f32_16x16x32_bf16 v[100:103], v[112:115], a[52:55], v[100:103]
    buffer_load_dwordx4 v223, s[40:43], s21 offen offset:3072 sc1 lds
    v_mfma_f32_16x16x32_bf16 v[80:83], v[116:119], a[56:59], v[80:83]
    ds_read_b128 v[108:111], v244 offset:33792
    s_add_u32 m0, s91, 114688
    v_mfma_f32_16x16x32_bf16 v[84:87], v[116:119], a[60:63], v[84:87]
    v_mul_u32_u24 v254, 1152, v238
    s_waitcnt lgkmcnt(2)
    v_mfma_f32_16x16x32_bf16 v[88:91], v[120:123], a[56:59], v[88:91]
    ds_read_b128 v[112:115], v244 offset:34816
    v_mfma_f32_16x16x32_bf16 v[92:95], v[120:123], a[60:63], v[92:95]
    buffer_load_dwordx4 v224, s[40:43], s21 offen sc1 lds
    v_mfma_f32_16x16x32_bf16 v[96:99], v[124:127], a[56:59], v[96:99]
    ds_read_b128 v[116:119], v244 offset:35840
    v_lshlrev_b32 v239, 6, v238
    v_mfma_f32_16x16x32_bf16 v[100:103], v[124:127], a[60:63], v[100:103]
    v_lshlrev_b32 v238, 12, v238
    s_waitcnt lgkmcnt(2)
    v_mfma_f32_16x16x32_bf16 v[48:51], v[104:107], a[64:67], v[48:51]
    ds_read_b128 v[120:123], v244 offset:36864
    v_mfma_f32_16x16x32_bf16 v[52:55], v[104:107], a[68:71], v[52:55]
    buffer_load_dwordx4 v224, s[40:43], s21 offen offset:1024 sc1 lds
    v_mfma_f32_16x16x32_bf16 v[56:59], v[108:111], a[64:67], v[56:59]
    ds_read_b128 v[124:127], v244 offset:37888
    v_and_b32 v240, 3, v248
    v_mfma_f32_16x16x32_bf16 v[60:63], v[108:111], a[68:71], v[60:63]
    v_lshl_add_u32 v238, v240, 4, v238
    s_waitcnt lgkmcnt(2)
    v_mfma_f32_16x16x32_bf16 v[64:67], v[112:115], a[64:67], v[64:67]
    ds_read_b128 v[104:107], v244 offset:38912
    v_mfma_f32_16x16x32_bf16 v[68:71], v[112:115], a[68:71], v[68:71]
    buffer_load_dwordx4 v225, s[40:43], s21 offen offset:2048 sc1 lds
    v_mfma_f32_16x16x32_bf16 v[72:75], v[116:119], a[64:67], v[72:75]
    ds_read_b128 v[108:111], v244 offset:39936
    s_add_u32 m0, s91, 81920
    v_mfma_f32_16x16x32_bf16 v[76:79], v[116:119], a[68:71], v[76:79]
    v_lshl_add_u32 v239, v240, 3, v239
    s_waitcnt lgkmcnt(2)
    v_mfma_f32_16x16x32_bf16 v[48:51], v[120:123], a[72:75], v[48:51]
    ds_read_b128 v[112:115], v244 offset:40960
    v_lshrrev_b32 v246, 4, v248
    v_mfma_f32_16x16x32_bf16 v[52:55], v[120:123], a[76:79], v[52:55]
    buffer_load_dwordx4 v222, s[40:43], s30 offen sc1 lds
    v_mfma_f32_16x16x32_bf16 v[56:59], v[124:127], a[72:75], v[56:59]
    ds_read_b128 v[116:119], v244 offset:41984
    v_xor_b32 v240, v240, v246
    v_mfma_f32_16x16x32_bf16 v[60:63], v[124:127], a[76:79], v[60:63]
    s_waitcnt lgkmcnt(2)
    v_mfma_f32_16x16x32_bf16 v[64:67], v[104:107], a[72:75], v[64:67]
    ds_read_b128 v[120:123], v244 offset:43008
    v_lshl_add_u32 v254, v240, 4, v254
    v_mfma_f32_16x16x32_bf16 v[68:71], v[104:107], a[76:79], v[68:71]
    buffer_load_dwordx4 v222, s[40:43], s30 offen offset:1024 sc1 lds
    v_mfma_f32_16x16x32_bf16 v[72:75], v[108:111], a[72:75], v[72:75]
    ds_read_b128 v[124:127], v244 offset:44032
    s_add_u32 m0, s91, 83968
    v_mfma_f32_16x16x32_bf16 v[76:79], v[108:111], a[76:79], v[76:79]
    s_lshl_b32 s83, s52, 12
    s_waitcnt lgkmcnt(2)
    v_mfma_f32_16x16x32_bf16 v[48:51], v[112:115], a[80:83], v[48:51]
    ds_read_b128 v[104:107], v244 offset:45056
    v_add_u32 v239, s83, v239
    v_mfma_f32_16x16x32_bf16 v[52:55], v[112:115], a[84:87], v[52:55]
    buffer_load_dwordx4 v222, s[40:43], s31 offen sc1 lds
    v_mfma_f32_16x16x32_bf16 v[56:59], v[116:119], a[80:83], v[56:59]
    ds_read_b128 v[108:111], v244 offset:46080
    s_and_b32 s83, s2, 1
    v_mfma_f32_16x16x32_bf16 v[60:63], v[116:119], a[84:87], v[60:63]
    s_waitcnt lgkmcnt(2)
    v_mfma_f32_16x16x32_bf16 v[64:67], v[120:123], a[80:83], v[64:67]
    ds_read_b128 v[112:115], v244 offset:47104
    v_mfma_f32_16x16x32_bf16 v[68:71], v[120:123], a[84:87], v[68:71]
    buffer_load_dwordx4 v222, s[40:43], s31 offen offset:1024 sc1 lds
    v_mfma_f32_16x16x32_bf16 v[72:75], v[124:127], a[80:83], v[72:75]
    ds_read_b128 v[116:119], v244 offset:48128
    s_add_u32 m0, s91, 131072
    v_mfma_f32_16x16x32_bf16 v[76:79], v[124:127], a[84:87], v[76:79]
    s_lshl_b32 s83, s83, 3
    s_waitcnt lgkmcnt(2)
    v_mfma_f32_16x16x32_bf16 v[48:51], v[104:107], a[88:91], v[48:51]
    ds_read_b128 v[120:123], v244 offset:16384
    s_bfe_u32 s84, s2, 0x30003
    v_mfma_f32_16x16x32_bf16 v[52:55], v[104:107], a[92:95], v[52:55]
    buffer_load_dwordx4 v222, s[40:43], s89 offen sc1 lds
    v_mfma_f32_16x16x32_bf16 v[56:59], v[108:111], a[88:91], v[56:59]
    ds_read_b128 v[124:127], v244 offset:17408
    s_add_u32 s83, s83, s84
    v_mfma_f32_16x16x32_bf16 v[60:63], v[108:111], a[92:95], v[60:63]
    s_lshr_b32 s84, s2, 6
    s_waitcnt lgkmcnt(2)
    v_mfma_f32_16x16x32_bf16 v[64:67], v[112:115], a[88:91], v[64:67]
    ds_read_b128 v[104:107], v244 offset:18432
    v_mfma_f32_16x16x32_bf16 v[68:71], v[112:115], a[92:95], v[68:71]
    buffer_load_dwordx4 v222, s[40:43], s89 offen offset:1024 sc1 lds
    v_mfma_f32_16x16x32_bf16 v[72:75], v[116:119], a[88:91], v[72:75]
    ds_read_b128 v[108:111], v244 offset:20480
    s_lshl_b32 s85, s83, 2
    v_mfma_f32_16x16x32_bf16 v[76:79], v[116:119], a[92:95], v[76:79]
    s_waitcnt lgkmcnt(2)
    v_mfma_f32_16x16x32_bf16 v[80:83], v[120:123], a[64:67], v[80:83]
    ds_read_b128 v[112:115], v244 offset:21504
    s_add_u32 s78, s85, s84
    v_mfma_f32_16x16x32_bf16 v[84:87], v[120:123], a[68:71], v[84:87]
    s_waitcnt vmcnt(12)
    v_cmp_ne_u32 vcc, s77, v220
    s_cbranch_vccnz SLOW_HLT
BACK_HLT:
    buffer_load_dwordx4 a[160:163], v250, s[40:43], s67 offen sc1
    v_mfma_f32_16x16x32_bf16 v[88:91], v[124:127], a[64:67], v[88:91]
    ds_read_b128 v[116:119], v244 offset:22528
    s_add_u32 s83, s85, s52
    v_mfma_f32_16x16x32_bf16 v[92:95], v[124:127], a[68:71], v[92:95]
    s_waitcnt lgkmcnt(2)
    v_mfma_f32_16x16x32_bf16 v[96:99], v[104:107], a[64:67], v[96:99]
    ds_read_b128 v[120:123], v244 offset:24576
    s_lshl_b32 s85, s78, 2
    v_mfma_f32_16x16x32_bf16 v[100:103], v[104:107], a[68:71], v[100:103]
    buffer_load_dwordx4 a[164:167], v250, s[40:43], s67 offen offset:256 sc1
    v_mfma_f32_16x16x32_bf16 v[80:83], v[108:111], a[72:75], v[80:83]
    ds_read_b128 v[124:127], v244 offset:25600
    s_add_u32 s79, s85, s53
    v_mfma_f32_16x16x32_bf16 v[84:87], v[108:111], a[76:79], v[84:87]
    s_waitcnt lgkmcnt(2)
    v_mfma_f32_16x16x32_bf16 v[88:91], v[112:115], a[72:75], v[88:91]
    ds_read_b128 v[104:107], v244 offset:26624
    s_lshl_b32 s79, s79, 2
    v_mfma_f32_16x16x32_bf16 v[92:95], v[112:115], a[76:79], v[92:95]
    buffer_load_dwordx4 a[168:171], v250, s[40:43], s67 offen offset:2048 sc1
    v_mfma_f32_16x16x32_bf16 v[96:99], v[116:119], a[72:75], v[96:99]
    ds_read_b128 v[108:111], v244 offset:28672
    v_mfma_f32_16x16x32_bf16 v[100:103], v[116:119], a[76:79], v[100:103]
    s_add_u32 s79, s79, s52
    s_waitcnt lgkmcnt(2)
    v_mfma_f32_16x16x32_bf16 v[80:83], v[120:123], a[80:83], v[80:83]
    ds_read_b128 v[112:115], v244 offset:29696
    v_mfma_f32_16x16x32_bf16 v[84:87], v[120:123], a[84:87], v[84:87]
    buffer_load_dwordx4 a[172:175], v250, s[40:43], s67 offen offset:2304 sc1
    v_mfma_f32_16x16x32_bf16 v[88:91], v[124:127], a[80:83], v[88:91]
    ds_read_b128 v[116:119], v244 offset:30720
    s_mul_i32 s79, s79, 6144
    v_mfma_f32_16x16x32_bf16 v[92:95], v[124:127], a[84:87], v[92:95]
    s_barrier
    s_waitcnt lgkmcnt(2)
    v_mfma_f32_16x16x32_bf16 v[96:99], v[104:107], a[80:83], v[96:99]
    ds_read_b128 v[120:123], v244 offset:49152
    s_add_u32 s72, s79, 28909568
    v_mfma_f32_16x16x32_bf16 v[100:103], v[104:107], a[84:87], v[100:103]
    buffer_load_dwordx4 a[176:179], v226, s[40:43], s67 offen sc1
    v_mfma_f32_16x16x32_bf16 v[80:83], v[108:111], a[88:91], v[80:83]
    ds_read_b128 v[124:127], v244 offset:50176
    s_add_u32 s59, s72, 4096
    v_mfma_f32_16x16x32_bf16 v[84:87], v[108:111], a[92:95], v[84:87]
    s_add_u32 s85, s85, s52
    s_waitcnt lgkmcnt(2)
    v_mfma_f32_16x16x32_bf16 v[88:91], v[112:115], a[88:91], v[88:91]
    ds_read_b128 v[104:107], v244 offset:51200
    v_mfma_f32_16x16x32_bf16 v[92:95], v[112:115], a[92:95], v[92:95]
    buffer_load_dwordx4 a[180:183], v226, s[40:43], s67 offen offset:256 sc1
    v_mfma_f32_16x16x32_bf16 v[96:99], v[116:119], a[88:91], v[96:99]
    ds_read_b128 v[108:111], v244 offset:52224
    s_lshl_b32 s85, s85, 12
    v_mfma_f32_16x16x32_bf16 v[100:103], v[116:119], a[92:95], v[100:103]
    s_waitcnt lgkmcnt(2)
    v_mfma_f32_16x16x32_bf16 v[48:51], v[120:123], a[96:99], v[48:51]
    ds_read_b128 v[112:115], v244 offset:53248
    s_and_b32 s78, s53, 1
    v_mfma_f32_16x16x32_bf16 v[52:55], v[120:123], a[100:103], v[52:55]
    buffer_load_dwordx4 a[184:187], v226, s[40:43], s67 offen offset:2048 sc1
    v_mfma_f32_16x16x32_bf16 v[56:59], v[124:127], a[96:99], v[56:59]
    ds_read_b128 v[116:119], v244 offset:54272
    s_lshl_b32 s79, s78, 3
    v_mfma_f32_16x16x32_bf16 v[60:63], v[124:127], a[100:103], v[60:63]
    s_waitcnt lgkmcnt(2)
    v_mfma_f32_16x16x32_bf16 v[64:67], v[104:107], a[96:99], v[64:67]
    ds_read_b128 v[120:123], v244 offset:55296
    s_add_u32 s85, s85, s79
    v_mfma_f32_16x16x32_bf16 v[68:71], v[104:107], a[100:103], v[68:71]
    buffer_load_dwordx4 a[188:191], v226, s[40:43], s67 offen offset:2304 sc1
    v_mfma_f32_16x16x32_bf16 v[72:75], v[108:111], a[96:99], v[72:75]
    ds_read_b128 v[124:127], v244 offset:56320
    s_add_u32 s73, s85, 35201024
    v_mfma_f32_16x16x32_bf16 v[76:79], v[108:111], a[100:103], v[76:79]
    s_waitcnt lgkmcnt(2)
    v_mfma_f32_16x16x32_bf16 v[48:51], v[112:115], a[104:107], v[48:51]
    ds_read_b128 v[104:107], v244 offset:57344
    v_mfma_f32_16x16x32_bf16 v[52:55], v[112:115], a[108:111], v[52:55]
    buffer_load_dwordx4 a[192:195], v250, s[40:43], s4 offen sc1
    v_mfma_f32_16x16x32_bf16 v[56:59], v[116:119], a[104:107], v[56:59]
    ds_read_b128 v[108:111], v244 offset:58368
    s_mul_i32 s84, s84, 9
    v_mfma_f32_16x16x32_bf16 v[60:63], v[116:119], a[108:111], v[60:63]
    s_lshl_b32 s85, s53, 1
    s_waitcnt lgkmcnt(2)
    v_mfma_f32_16x16x32_bf16 v[64:67], v[120:123], a[104:107], v[64:67]
    ds_read_b128 v[112:115], v244 offset:59392
    v_mfma_f32_16x16x32_bf16 v[68:71], v[120:123], a[108:111], v[68:71]
    buffer_load_dwordx4 a[196:199], v250, s[40:43], s4 offen offset:256 sc1
    v_mfma_f32_16x16x32_bf16 v[72:75], v[124:127], a[104:107], v[72:75]
    ds_read_b128 v[116:119], v244 offset:60416
    s_add_u32 s85, s85, s84
    v_mfma_f32_16x16x32_bf16 v[76:79], v[124:127], a[108:111], v[76:79]
    s_add_u32 s84, s84, 8
    s_waitcnt lgkmcnt(2)
    v_mfma_f32_16x16x32_bf16 v[48:51], v[104:107], a[112:115], v[48:51]
    ds_read_b128 v[120:123], v244 offset:61440
    v_mfma_f32_16x16x32_bf16 v[52:55], v[104:107], a[116:119], v[52:55]
    buffer_load_dwordx4 a[200:203], v250, s[40:43], s4 offen offset:2048 sc1
    v_mfma_f32_16x16x32_bf16 v[56:59], v[108:111], a[112:115], v[56:59]
    ds_read_b128 v[124:127], v244 offset:62464
    s_mul_i32 s79, s83, 36864
    v_mfma_f32_16x16x32_bf16 v[60:63], v[108:111], a[116:119], v[60:63]
    s_lshl_b32 s68, s85, 5
    s_waitcnt lgkmcnt(2)
    v_mfma_f32_16x16x32_bf16 v[64:67], v[112:115], a[112:115], v[64:67]
    ds_read_b128 v[104:107], v244 offset:63488
    v_mfma_f32_16x16x32_bf16 v[68:71], v[112:115], a[116:119], v[68:71]
    buffer_load_dwordx4 a[204:207], v250, s[40:43], s4 offen offset:2304 sc1
    v_mfma_f32_16x16x32_bf16 v[72:75], v[116:119], a[112:115], v[72:75]
    ds_read_b128 v[108:111], v244 offset:64512
    s_add_u32 s68, s68, s79
    v_mfma_f32_16x16x32_bf16 v[76:79], v[116:119], a[116:119], v[76:79]
KF_PG12:
    s_cbranch_execz KF_WEND
    s_waitcnt lgkmcnt(2)
    v_mfma_f32_16x16x32_bf16 v[48:51], v[120:123], a[120:123], v[48:51]
    ds_read_b128 v[112:115], v251
    s_add_u32 s69, s68, 18432
    v_mfma_f32_16x16x32_bf16 v[52:55], v[120:123], a[124:127], v[52:55]
    buffer_load_dwordx4 a[208:211], v226, s[40:43], s4 offen sc1
    v_mfma_f32_16x16x32_bf16 v[56:59], v[124:127], a[120:123], v[56:59]
    ds_read_b128 v[116:119], v251 offset:1024
    s_lshl_b32 s70, s84, 5
    v_mfma_f32_16x16x32_bf16 v[60:63], v[124:127], a[124:127], v[60:63]
    s_waitcnt lgkmcnt(2)
    v_mfma_f32_16x16x32_bf16 v[64:67], v[104:107], a[120:123], v[64:67]
    ds_read_b128 v[120:123], v251 offset:2048
    s_add_u32 s70, s70, s79
    v_mfma_f32_16x16x32_bf16 v[68:71], v[104:107], a[124:127], v[68:71]
    buffer_load_dwordx4 a[212:215], v226, s[40:43], s4 offen offset:256 sc1
    v_mfma_f32_16x16x32_bf16 v[72:75], v[108:111], a[120:123], v[72:75]
    ds_read_b128 v[124:127], v251 offset:4096
    s_mul_i32 s79, s78, 18432
    v_mfma_f32_16x16x32_bf16 v[76:79], v[108:111], a[124:127], v[76:79]
    s_waitcnt lgkmcnt(2)
    v_mfma_f32_16x16x32_bf16 v[80:83], v[112:115], a[96:99], v[80:83]
    ds_read_b128 v[104:107], v251 offset:5120
    v_mfma_f32_16x16x32_bf16 v[84:87], v[112:115], a[100:103], v[84:87]
    buffer_load_dwordx4 a[216:219], v226, s[40:43], s4 offen offset:2048 sc1
    v_mfma_f32_16x16x32_bf16 v[88:91], v[116:119], a[96:99], v[88:91]
    ds_read_b128 v[108:111], v251 offset:6144
    buffer_load_dwordx4 v[176:179], v244, s[40:43], s58 offen offset:1024 sc1
    v_mfma_f32_16x16x32_bf16 v[92:95], v[116:119], a[100:103], v[92:95]
    s_add_u32 s70, s70, s79
    s_waitcnt lgkmcnt(2)
    v_mfma_f32_16x16x32_bf16 v[96:99], v[120:123], a[96:99], v[96:99]
    ds_read_b128 v[112:115], v251 offset:8192
    s_lshl_b32 s71, s83, 7
    v_mfma_f32_16x16x32_bf16 v[100:103], v[120:123], a[100:103], v[100:103]
    buffer_load_dwordx4 a[220:223], v226, s[40:43], s4 offen offset:2304 sc1
    v_mfma_f32_16x16x32_bf16 v[80:83], v[124:127], a[104:107], v[80:83]
    ds_read_b128 v[116:119], v251 offset:9216
    s_add_u32 s71, s71, 28901376
    v_mfma_f32_16x16x32_bf16 v[84:87], v[124:127], a[108:111], v[84:87]
    s_lshl_b32 s83, s83, 6
    s_waitcnt lgkmcnt(2)
    v_mfma_f32_16x16x32_bf16 v[88:91], v[104:107], a[104:107], v[88:91]
    ds_read_b128 v[120:123], v251 offset:10240
    v_mfma_f32_16x16x32_bf16 v[92:95], v[104:107], a[108:111], v[92:95]
    buffer_load_dwordx4 a[224:227], v250, s[40:43], s5 offen sc1
    v_mfma_f32_16x16x32_bf16 v[96:99], v[108:111], a[104:107], v[96:99]
    ds_read_b128 v[124:127], v251 offset:12288
    s_add_u32 s83, s83, 26542080
    v_mfma_f32_16x16x32_bf16 v[100:103], v[108:111], a[108:111], v[100:103]
    s_waitcnt lgkmcnt(2)
    v_mfma_f32_16x16x32_bf16 v[80:83], v[112:115], a[112:115], v[80:83]
    ds_read_b128 v[104:107], v251 offset:13312
    s_lshl_b32 s74, s85, 16
    v_mfma_f32_16x16x32_bf16 v[84:87], v[112:115], a[116:119], v[84:87]
    buffer_load_dwordx4 a[228:231], v250, s[40:43], s5 offen offset:256 sc1
    v_mfma_f32_16x16x32_bf16 v[88:91], v[116:119], a[112:115], v[88:91]
    ds_read_b128 v[108:111], v251 offset:14336
    s_add_u32 s74, s74, s83
    v_mfma_f32_16x16x32_bf16 v[92:95], v[116:119], a[116:119], v[92:95]
    s_waitcnt vmcnt(25)
    s_barrier
    s_waitcnt lgkmcnt(2)
    v_mfma_f32_16x16x32_bf16 v[96:99], v[120:123], a[112:115], v[96:99]
    ds_read_b128 v[112:115], v251 offset:32768
    s_lshl_b32 s75, s84, 16
    v_mfma_f32_16x16x32_bf16 v[100:103], v[120:123], a[116:119], v[100:103]
    buffer_load_dwordx4 a[232:235], v250, s[40:43], s5 offen offset:2048 sc1
    v_mfma_f32_16x16x32_bf16 v[80:83], v[124:127], a[120:123], v[80:83]
    ds_read_b128 v[116:119], v251 offset:33792
    s_add_u32 s75, s75, s83
    v_mfma_f32_16x16x32_bf16 v[84:87], v[124:127], a[124:127], v[84:87]
    s_waitcnt lgkmcnt(2)
    v_mfma_f32_16x16x32_bf16 v[88:91], v[104:107], a[120:123], v[88:91]
    ds_read_b128 v[120:123], v251 offset:34816
    s_lshl_b32 s79, s78, 5
    v_mfma_f32_16x16x32_bf16 v[92:95], v[104:107], a[124:127], v[92:95]
    buffer_load_dwordx4 a[236:239], v250, s[40:43], s5 offen offset:2304 sc1
    v_mfma_f32_16x16x32_bf16 v[96:99], v[108:111], a[120:123], v[96:99]
    ds_read_b128 v[124:127], v251 offset:35840
    s_add_u32 m0, s91, 131072
    v_mfma_f32_16x16x32_bf16 v[100:103], v[108:111], a[124:127], v[100:103]
    s_add_u32 s75, s75, s79
    s_waitcnt lgkmcnt(2)
    v_mfma_f32_16x16x32_bf16 v[48:51], v[112:115], a[128:131], v[48:51]
    ds_read_b128 v[104:107], v251 offset:36864
    v_mfma_f32_16x16x32_bf16 v[52:55], v[112:115], a[132:135], v[52:55]
    buffer_load_dwordx4 v223, s[40:43], s30 offen offset:2048 sc1 lds
    v_mfma_f32_16x16x32_bf16 v[56:59], v[116:119], a[128:131], v[56:59]
    ds_read_b128 v[108:111], v251 offset:37888
    s_lshl_b32 s79, s78, 6
    v_mfma_f32_16x16x32_bf16 v[60:63], v[116:119], a[132:135], v[60:63]
    v_add_u32 v249, s79, v237
    s_waitcnt lgkmcnt(2)
    v_mfma_f32_16x16x32_bf16 v[64:67], v[120:123], a[128:131], v[64:67]
    ds_read_b128 v[112:115], v251 offset:38912
    v_mfma_f32_16x16x32_bf16 v[68:71], v[120:123], a[132:135], v[68:71]
    buffer_load_dwordx4 v223, s[40:43], s30 offen offset:3072 sc1 lds
    v_mfma_f32_16x16x32_bf16 v[72:75], v[124:127], a[128:131], v[72:75]
    ds_read_b128 v[116:119], v251 offset:39936
    s_add_u32 m0, s91, 30720
    v_mfma_f32_16x16x32_bf16 v[76:79], v[124:127], a[132:135], v[76:79]
    s_mov_b64 s[44:45], s[26:27]
    s_waitcnt lgkmcnt(2)
    v_mfma_f32_16x16x32_bf16 v[48:51], v[104:107], a[136:139], v[48:51]
    ds_read_b128 v[120:123], v251 offset:40960
    s_mov_b32 s46, 2359296
    v_mfma_f32_16x16x32_bf16 v[52:55], v[104:107], a[140:143], v[52:55]
    buffer_load_dwordx4 v223, s[40:43], s31 offen offset:2048 sc1 lds
    v_mfma_f32_16x16x32_bf16 v[56:59], v[108:111], a[136:139], v[56:59]
    ds_read_b128 v[124:127], v251 offset:41984
    v_mfma_f32_16x16x32_bf16 v[60:63], v[108:111], a[140:143], v[60:63]
    s_waitcnt lgkmcnt(2)
    v_mfma_f32_16x16x32_bf16 v[64:67], v[112:115], a[136:139], v[64:67]
    ds_read_b128 v[104:107], v251 offset:43008
    v_mfma_f32_16x16x32_bf16 v[68:71], v[112:115], a[140:143], v[68:71]
    buffer_load_dwordx4 v223, s[40:43], s31 offen offset:3072 sc1 lds
    v_mfma_f32_16x16x32_bf16 v[72:75], v[116:119], a[136:139], v[72:75]
    ds_read_b128 v[108:111], v251 offset:44032
    s_add_u32 m0, s91, 32768
    v_mfma_f32_16x16x32_bf16 v[76:79], v[116:119], a[140:143], v[76:79]
    s_waitcnt lgkmcnt(2)
    v_mfma_f32_16x16x32_bf16 v[48:51], v[120:123], a[144:147], v[48:51]
    ds_read_b128 v[112:115], v251 offset:45056
    v_mfma_f32_16x16x32_bf16 v[52:55], v[120:123], a[148:151], v[52:55]
    buffer_load_dwordx4 v223, s[40:43], s89 offen offset:2048 sc1 lds
    v_mfma_f32_16x16x32_bf16 v[56:59], v[124:127], a[144:147], v[56:59]
    ds_read_b128 v[116:119], v251 offset:46080
    v_mfma_f32_16x16x32_bf16 v[60:63], v[124:127], a[148:151], v[60:63]
    s_waitcnt lgkmcnt(2)
    v_mfma_f32_16x16x32_bf16 v[64:67], v[104:107], a[144:147], v[64:67]
    ds_read_b128 v[120:123], v251 offset:47104
    v_mfma_f32_16x16x32_bf16 v[68:71], v[104:107], a[148:151], v[68:71]
    buffer_load_dwordx4 v223, s[40:43], s89 offen offset:3072 sc1 lds
    v_mfma_f32_16x16x32_bf16 v[72:75], v[108:111], a[144:147], v[72:75]
    ds_read_b128 v[124:127], v251 offset:48128
    v_mfma_f32_16x16x32_bf16 v[76:79], v[108:111], a[148:151], v[76:79]
    s_waitcnt lgkmcnt(2)
    v_mfma_f32_16x16x32_bf16 v[48:51], v[112:115], a[152:155], v[48:51]
    ds_read_b128 v[104:107], v251 offset:49152
    v_mfma_f32_16x16x32_bf16 v[52:55], v[112:115], a[156:159], v[52:55]
    buffer_load_dwordx4 a[240:243], v226, s[40:43], s5 offen sc1
    v_mfma_f32_16x16x32_bf16 v[56:59], v[116:119], a[152:155], v[56:59]
    ds_read_b128 v[108:111], v251 offset:50176
    v_mfma_f32_16x16x32_bf16 v[60:63], v[116:119], a[156:159], v[60:63]
    s_waitcnt lgkmcnt(2)
    v_mfma_f32_16x16x32_bf16 v[64:67], v[120:123], a[152:155], v[64:67]
    ds_read_b128 v[112:115], v251 offset:51200
    v_mfma_f32_16x16x32_bf16 v[68:71], v[120:123], a[156:159], v[68:71]
    buffer_load_dwordx4 a[244:247], v226, s[40:43], s5 offen offset:256 sc1
    v_mfma_f32_16x16x32_bf16 v[72:75], v[124:127], a[152:155], v[72:75]
    ds_read_b128 v[116:119], v251 offset:53248
    v_mfma_f32_16x16x32_bf16 v[76:79], v[124:127], a[156:159], v[76:79]
    s_waitcnt lgkmcnt(2)
    v_mfma_f32_16x16x32_bf16 v[80:83], v[104:107], a[128:131], v[80:83]
    ds_read_b128 v[120:123], v251 offset:54272
    v_mfma_f32_16x16x32_bf16 v[84:87], v[104:107], a[132:135], v[84:87]
    buffer_load_dwordx4 a[248:251], v226, s[40:43], s5 offen offset:2048 sc1
    v_mfma_f32_16x16x32_bf16 v[88:91], v[108:111], a[128:131], v[88:91]
    ds_read_b128 v[124:127], v251 offset:55296
    v_mfma_f32_16x16x32_bf16 v[92:95], v[108:111], a[132:135], v[92:95]
    s_waitcnt lgkmcnt(2)
    v_mfma_f32_16x16x32_bf16 v[96:99], v[112:115], a[128:131], v[96:99]
    ds_read_b128 v[104:107], v251 offset:57344
    v_mfma_f32_16x16x32_bf16 v[100:103], v[112:115], a[132:135], v[100:103]
    buffer_load_dwordx4 a[252:255], v226, s[40:43], s5 offen offset:2304 sc1
    v_mfma_f32_16x16x32_bf16 v[80:83], v[116:119], a[136:139], v[80:83]
    ds_read_b128 v[108:111], v251 offset:58368
    s_mov_b32 m0, s91
    v_mfma_f32_16x16x32_bf16 v[84:87], v[116:119], a[140:143], v[84:87]
    s_waitcnt lgkmcnt(2)
    v_mfma_f32_16x16x32_bf16 v[88:91], v[120:123], a[136:139], v[88:91]
    ds_read_b128 v[112:115], v251 offset:59392
    v_mfma_f32_16x16x32_bf16 v[92:95], v[120:123], a[140:143], v[92:95]
    buffer_load_dwordx4 v254, s[32:35], s68 offen lds
    v_mfma_f32_16x16x32_bf16 v[96:99], v[124:127], a[136:139], v[96:99]
    ds_read_b128 v[116:119], v251 offset:61440
    v_mfma_f32_16x16x32_bf16 v[100:103], v[124:127], a[140:143], v[100:103]
    s_add_u32 m0, s91, 1024
    s_waitcnt lgkmcnt(2)
    v_mfma_f32_16x16x32_bf16 v[80:83], v[104:107], a[144:147], v[80:83]
    ds_read_b128 v[120:123], v251 offset:62464
    v_mfma_f32_16x16x32_bf16 v[84:87], v[104:107], a[148:151], v[84:87]
    v_mfma_f32_16x16x32_bf16 v[88:91], v[108:111], a[144:147], v[88:91]
    ds_read_b128 v[124:127], v251 offset:63488
    v_mfma_f32_16x16x32_bf16 v[92:95], v[108:111], a[148:151], v[92:95]
    s_waitcnt vmcnt(32)
    s_barrier
    s_waitcnt lgkmcnt(2)
    v_mfma_f32_16x16x32_bf16 v[96:99], v[112:115], a[144:147], v[96:99]
    ds_read_b128 v[104:107], v251 offset:16384
    v_mfma_f32_16x16x32_bf16 v[100:103], v[112:115], a[148:151], v[100:103]
    buffer_load_dwordx4 v254, s[32:35], s69 offen lds
    v_mfma_f32_16x16x32_bf16 v[80:83], v[116:119], a[152:155], v[80:83]
    ds_read_b128 v[108:111], v251 offset:17408
    s_add_u32 m0, s91, 2048
    v_mfma_f32_16x16x32_bf16 v[84:87], v[116:119], a[156:159], v[84:87]
    s_waitcnt lgkmcnt(2)
    v_mfma_f32_16x16x32_bf16 v[88:91], v[120:123], a[152:155], v[88:91]
    ds_read_b128 v[112:115], v251 offset:20480
    v_mfma_f32_16x16x32_bf16 v[92:95], v[120:123], a[156:159], v[92:95]
    buffer_load_dwordx4 v254, s[32:35], s70 offen lds
    v_mfma_f32_16x16x32_bf16 v[96:99], v[124:127], a[152:155], v[96:99]
    ds_read_b128 v[116:119], v251 offset:21504
    v_mfma_f32_16x16x32_bf16 v[100:103], v[124:127], a[156:159], v[100:103]
    s_add_u32 m0, s91, 3072
    s_waitcnt vmcnt(32) lgkmcnt(2)
    v_mfma_f32_16x16x32_bf16 v[48:51], v[104:107], a[160:163], v[48:51]
    ds_read_b128 v[120:123], v251 offset:24576
    v_mfma_f32_16x16x32_bf16 v[52:55], v[104:107], a[164:167], v[52:55]
    v_mfma_f32_16x16x32_bf16 v[56:59], v[108:111], a[160:163], v[56:59]
    ds_read_b128 v[124:127], v251 offset:25600
    v_mfma_f32_16x16x32_bf16 v[60:63], v[108:111], a[164:167], v[60:63]
    s_waitcnt vmcnt(30) lgkmcnt(2)
    v_mfma_f32_16x16x32_bf16 v[48:51], v[112:115], a[168:171], v[48:51]
    ds_read_b128 v[104:107], v251 offset:28672
    v_mfma_f32_16x16x32_bf16 v[52:55], v[112:115], a[172:175], v[52:55]
    s_mov_b32 exec_hi, 0
    buffer_load_dword v236, s[40:43], s71 offen sc1 lds
    s_mov_b64 exec, -1
    s_add_u32 m0, s91, 147456
    s_nop 0
    buffer_load_dwordx4 v224, s[40:43], s30 offen sc1 lds
    v_mfma_f32_16x16x32_bf16 v[56:59], v[116:119], a[168:171], v[56:59]
    ds_read_b128 v[108:111], v251 offset:29696
    v_mfma_f32_16x16x32_bf16 v[60:63], v[116:119], a[172:175], v[60:63]
    s_waitcnt vmcnt(30) lgkmcnt(2)
    v_mfma_f32_16x16x32_bf16 v[48:51], v[120:123], a[176:179], v[48:51]
    ds_read_b128 v[112:115], v251 offset:18432
    v_mfma_f32_16x16x32_bf16 v[52:55], v[120:123], a[180:183], v[52:55]
    buffer_load_dwordx4 v224, s[40:43], s30 offen offset:1024 sc1 lds
    v_mfma_f32_16x16x32_bf16 v[56:59], v[124:127], a[176:179], v[56:59]
    ds_read_b128 v[116:119], v251 offset:19456
    v_mfma_f32_16x16x32_bf16 v[60:63], v[124:127], a[180:183], v[60:63]
    s_waitcnt vmcnt(29) lgkmcnt(2)
    v_mfma_f32_16x16x32_bf16 v[48:51], v[104:107], a[184:187], v[48:51]
    ds_read_b128 v[120:123], v251 offset:22528
    v_mfma_f32_16x16x32_bf16 v[52:55], v[104:107], a[188:191], v[52:55]
    buffer_load_dwordx4 v225, s[40:43], s30 offen offset:2048 sc1 lds
    v_mfma_f32_16x16x32_bf16 v[56:59], v[108:111], a[184:187], v[56:59]
    ds_read_b128 v[124:127], v251 offset:23552
    s_add_u32 m0, s91, 16384
    v_mfma_f32_16x16x32_bf16 v[60:63], v[108:111], a[188:191], v[60:63]
    s_waitcnt vmcnt(28) lgkmcnt(2)
    v_mfma_f32_16x16x32_bf16 v[48:51], v[112:115], a[192:195], v[48:51]
    ds_read_b128 v[104:107], v251 offset:26624
    v_mfma_f32_16x16x32_bf16 v[52:55], v[112:115], a[196:199], v[52:55]
    buffer_load_dwordx4 v224, s[40:43], s31 offen sc1 lds
    v_mfma_f32_16x16x32_bf16 v[56:59], v[116:119], a[192:195], v[56:59]
    ds_read_b128 v[108:111], v251 offset:27648
    v_mfma_f32_16x16x32_bf16 v[60:63], v[116:119], a[196:199], v[60:63]
    s_waitcnt vmcnt(27) lgkmcnt(2)
    v_mfma_f32_16x16x32_bf16 v[48:51], v[120:123], a[200:203], v[48:51]
    ds_read_b128 v[112:115], v251 offset:30720
    v_mfma_f32_16x16x32_bf16 v[52:55], v[120:123], a[204:207], v[52:55]
    buffer_load_dwordx4 v224, s[40:43], s31 offen offset:1024 sc1 lds
    v_mfma_f32_16x16x32_bf16 v[56:59], v[124:127], a[200:203], v[56:59]
    ds_read_b128 v[116:119], v251 offset:31744
    v_mfma_f32_16x16x32_bf16 v[60:63], v[124:127], a[204:207], v[60:63]
    s_waitcnt vmcnt(26) lgkmcnt(2)
    v_mfma_f32_16x16x32_bf16 v[48:51], v[104:107], a[208:211], v[48:51]
    ds_read_b128 v[120:123], v252
    v_mfma_f32_16x16x32_bf16 v[52:55], v[104:107], a[212:215], v[52:55]
    buffer_load_dwordx4 v225, s[40:43], s31 offen offset:2048 sc1 lds
    v_mfma_f32_16x16x32_bf16 v[56:59], v[108:111], a[208:211], v[56:59]
    ds_read_b128 v[124:127], v252 offset:1024
    s_add_u32 m0, s91, 49152
    v_mfma_f32_16x16x32_bf16 v[60:63], v[108:111], a[212:215], v[60:63]
    s_waitcnt vmcnt(24) lgkmcnt(2)
    v_mfma_f32_16x16x32_bf16 v[48:51], v[112:115], a[216:219], v[48:51]
    ds_read_b128 v[104:107], v252 offset:4096
    v_mfma_f32_16x16x32_bf16 v[52:55], v[112:115], a[220:223], v[52:55]
    buffer_load_dwordx4 v224, s[40:43], s89 offen sc1 lds
    v_mfma_f32_16x16x32_bf16 v[56:59], v[116:119], a[216:219], v[56:59]
    ds_read_b128 v[108:111], v252 offset:5120
    v_mfma_f32_16x16x32_bf16 v[60:63], v[116:119], a[220:223], v[60:63]
    s_waitcnt vmcnt(23) lgkmcnt(2)
    v_mfma_f32_16x16x32_bf16 v[48:51], v[120:123], a[224:227], v[48:51]
    ds_read_b128 v[112:115], v252 offset:8192
    v_mfma_f32_16x16x32_bf16 v[52:55], v[120:123], a[228:231], v[52:55]
    buffer_load_dwordx4 v224, s[40:43], s89 offen offset:1024 sc1 lds
    v_mfma_f32_16x16x32_bf16 v[56:59], v[124:127], a[224:227], v[56:59]
    ds_read_b128 v[116:119], v252 offset:9216
    v_mfma_f32_16x16x32_bf16 v[60:63], v[124:127], a[228:231], v[60:63]
    s_waitcnt vmcnt(22) lgkmcnt(2)
    v_mfma_f32_16x16x32_bf16 v[48:51], v[104:107], a[232:235], v[48:51]
    ds_read_b128 v[120:123], v252 offset:12288
    v_mfma_f32_16x16x32_bf16 v[52:55], v[104:107], a[236:239], v[52:55]
    buffer_load_dwordx4 v225, s[40:43], s89 offen offset:2048 sc1 lds
    v_mfma_f32_16x16x32_bf16 v[56:59], v[108:111], a[232:235], v[56:59]
    ds_read_b128 v[124:127], v252 offset:13312
    s_add_u32 m0, s91, 65536
    v_mfma_f32_16x16x32_bf16 v[60:63], v[108:111], a[236:239], v[60:63]
    s_waitcnt vmcnt(17)
    s_barrier
    s_waitcnt vmcnt(15) lgkmcnt(2)
    v_mfma_f32_16x16x32_bf16 v[48:51], v[112:115], a[240:243], v[48:51]
    ds_read_b128 v[104:107], v252 offset:2048
    v_mfma_f32_16x16x32_bf16 v[52:55], v[112:115], a[244:247], v[52:55]
    buffer_load_dwordx4 v221, s[40:43], s16 offen sc1 lds
    v_mfma_f32_16x16x32_bf16 v[56:59], v[116:119], a[240:243], v[56:59]
    ds_read_b128 v[108:111], v252 offset:3072
    v_mfma_f32_16x16x32_bf16 v[60:63], v[116:119], a[244:247], v[60:63]
    s_waitcnt vmcnt(14) lgkmcnt(2)
    v_mfma_f32_16x16x32_bf16 v[48:51], v[120:123], a[248:251], v[48:51]
    ds_read_b128 v[112:115], v252 offset:6144
    v_mfma_f32_16x16x32_bf16 v[52:55], v[120:123], a[252:255], v[52:55]
    buffer_load_dwordx4 v221, s[40:43], s16 offen offset:1024 sc1 lds
    v_mfma_f32_16x16x32_bf16 v[56:59], v[124:127], a[248:251], v[56:59]
    ds_read_b128 v[116:119], v252 offset:7168
    s_add_u32 m0, s91, 67584
    v_mfma_f32_16x16x32_bf16 v[60:63], v[124:127], a[252:255], v[60:63]
    s_nop 0
    v_cvt_pk_bf16_f32 v48, v48, v49
    s_waitcnt lgkmcnt(2)
    v_mfma_f32_16x16x32_bf16 v[64:67], v[104:107], a[160:163], v[64:67]
    ds_read_b128 v[120:123], v252 offset:10240
    v_cvt_pk_bf16_f32 v49, v50, v51
    v_mfma_f32_16x16x32_bf16 v[68:71], v[104:107], a[164:167], v[68:71]
    buffer_load_dwordx4 v221, s[40:43], s17 offen sc1 lds
    v_mfma_f32_16x16x32_bf16 v[72:75], v[108:111], a[160:163], v[72:75]
    ds_read_b128 v[124:127], v252 offset:11264
    v_cvt_pk_bf16_f32 v50, v52, v53
    v_mfma_f32_16x16x32_bf16 v[76:79], v[108:111], a[164:167], v[76:79]
    v_cvt_pk_bf16_f32 v51, v54, v55
    s_waitcnt lgkmcnt(2)
    v_mfma_f32_16x16x32_bf16 v[64:67], v[112:115], a[168:171], v[64:67]
    ds_read_b128 v[104:107], v252 offset:14336
    v_mfma_f32_16x16x32_bf16 v[68:71], v[112:115], a[172:175], v[68:71]
    buffer_load_dwordx4 v221, s[40:43], s17 offen offset:1024 sc1 lds
    v_mfma_f32_16x16x32_bf16 v[72:75], v[116:119], a[168:171], v[72:75]
    ds_read_b128 v[108:111], v252 offset:15360
    s_add_u32 m0, s91, 98304
    v_mfma_f32_16x16x32_bf16 v[76:79], v[116:119], a[172:175], v[76:79]
    buffer_store_dwordx4 v[48:51], v244, s[40:43], s93 offen sc1
    s_waitcnt lgkmcnt(2)
    v_mfma_f32_16x16x32_bf16 v[64:67], v[120:123], a[176:179], v[64:67]
    ds_read_b128 v[112:115], v244 offset:32768
    v_cvt_pk_bf16_f32 v56, v56, v57
    v_mfma_f32_16x16x32_bf16 v[68:71], v[120:123], a[180:183], v[68:71]
    buffer_load_dwordx4 v221, s[40:43], s18 offen sc1 lds
    v_mfma_f32_16x16x32_bf16 v[72:75], v[124:127], a[176:179], v[72:75]
    ds_read_b128 v[116:119], v244 offset:33792
    v_cvt_pk_bf16_f32 v57, v58, v59
    v_mfma_f32_16x16x32_bf16 v[76:79], v[124:127], a[180:183], v[76:79]
    v_cvt_pk_bf16_f32 v58, v60, v61
    s_waitcnt lgkmcnt(2)
    v_mfma_f32_16x16x32_bf16 v[64:67], v[104:107], a[184:187], v[64:67]
    ds_read_b128 v[120:123], v244 offset:36864
    v_cvt_pk_bf16_f32 v59, v62, v63
    buffer_store_dwordx4 v[56:59], v244, s[40:43], s93 offen offset:1024 sc1
    v_mfma_f32_16x16x32_bf16 v[68:71], v[104:107], a[188:191], v[68:71]
    buffer_load_dwordx4 v221, s[40:43], s18 offen offset:1024 sc1 lds
    v_mfma_f32_16x16x32_bf16 v[72:75], v[108:111], a[184:187], v[72:75]
    ds_read_b128 v[124:127], v244 offset:37888
    s_add_u32 m0, s91, 100352
    v_mfma_f32_16x16x32_bf16 v[76:79], v[108:111], a[188:191], v[76:79]
    s_waitcnt lgkmcnt(2)
    v_mfma_f32_16x16x32_bf16 v[64:67], v[112:115], a[192:195], v[64:67]
    ds_read_b128 v[104:107], v244 offset:40960
    v_mfma_f32_16x16x32_bf16 v[68:71], v[112:115], a[196:199], v[68:71]
    buffer_load_dwordx4 v221, s[40:43], s19 offen sc1 lds
    v_mfma_f32_16x16x32_bf16 v[72:75], v[116:119], a[192:195], v[72:75]
    ds_read_b128 v[108:111], v244 offset:41984
    v_mfma_f32_16x16x32_bf16 v[76:79], v[116:119], a[196:199], v[76:79]
    s_waitcnt lgkmcnt(2)
    v_mfma_f32_16x16x32_bf16 v[64:67], v[120:123], a[200:203], v[64:67]
    ds_read_b128 v[112:115], v244 offset:45056
    v_mfma_f32_16x16x32_bf16 v[68:71], v[120:123], a[204:207], v[68:71]
    buffer_load_dwordx4 v221, s[40:43], s19 offen offset:1024 sc1 lds
    v_mfma_f32_16x16x32_bf16 v[72:75], v[124:127], a[200:203], v[72:75]
    ds_read_b128 v[116:119], v244 offset:46080
    s_add_u32 m0, s91, 81920
    v_mfma_f32_16x16x32_bf16 v[76:79], v[124:127], a[204:207], v[76:79]
    s_waitcnt lgkmcnt(2)
    v_mfma_f32_16x16x32_bf16 v[64:67], v[104:107], a[208:211], v[64:67]
    ds_read_b128 v[120:123], v244 offset:34816
    v_mfma_f32_16x16x32_bf16 v[68:71], v[104:107], a[212:215], v[68:71]
    buffer_load_dwordx4 v221, s[40:43], s20 offen sc1 lds
    v_mfma_f32_16x16x32_bf16 v[72:75], v[108:111], a[208:211], v[72:75]
    ds_read_b128 v[124:127], v244 offset:35840
    v_mfma_f32_16x16x32_bf16 v[76:79], v[108:111], a[212:215], v[76:79]
    s_waitcnt lgkmcnt(2)
    v_mfma_f32_16x16x32_bf16 v[64:67], v[112:115], a[216:219], v[64:67]
    ds_read_b128 v[104:107], v244 offset:38912
    v_mfma_f32_16x16x32_bf16 v[68:71], v[112:115], a[220:223], v[68:71]
    buffer_load_dwordx4 v221, s[40:43], s20 offen offset:1024 sc1 lds
    v_mfma_f32_16x16x32_bf16 v[72:75], v[116:119], a[216:219], v[72:75]
    ds_read_b128 v[108:111], v244 offset:39936
    s_add_u32 m0, s91, 83968
    v_mfma_f32_16x16x32_bf16 v[76:79], v[116:119], a[220:223], v[76:79]
    s_waitcnt lgkmcnt(2)
    v_mfma_f32_16x16x32_bf16 v[64:67], v[120:123], a[224:227], v[64:67]
    ds_read_b128 v[112:115], v244 offset:43008
    v_mfma_f32_16x16x32_bf16 v[68:71], v[120:123], a[228:231], v[68:71]
    buffer_load_dwordx4 v221, s[40:43], s21 offen sc1 lds
    v_mfma_f32_16x16x32_bf16 v[72:75], v[124:127], a[224:227], v[72:75]
    ds_read_b128 v[116:119], v244 offset:44032
    v_mfma_f32_16x16x32_bf16 v[76:79], v[124:127], a[228:231], v[76:79]
    s_waitcnt lgkmcnt(2)
    v_mfma_f32_16x16x32_bf16 v[64:67], v[104:107], a[232:235], v[64:67]
    ds_read_b128 v[120:123], v244 offset:47104
    v_mfma_f32_16x16x32_bf16 v[68:71], v[104:107], a[236:239], v[68:71]
    buffer_load_dwordx4 v221, s[40:43], s21 offen offset:1024 sc1 lds
    v_mfma_f32_16x16x32_bf16 v[72:75], v[108:111], a[232:235], v[72:75]
    ds_read_b128 v[124:127], v244 offset:48128
    s_add_u32 m0, s91, 114688
    v_mfma_f32_16x16x32_bf16 v[76:79], v[108:111], a[236:239], v[76:79]
    s_waitcnt vmcnt(14)
    s_barrier
    s_waitcnt lgkmcnt(2)
    v_mfma_f32_16x16x32_bf16 v[64:67], v[112:115], a[240:243], v[64:67]
    ds_read_b128 v[104:107], v252 offset:16384
    v_mfma_f32_16x16x32_bf16 v[68:71], v[112:115], a[244:247], v[68:71]
    buffer_load_dwordx4 v221, s[40:43], s30 offen sc1 lds
    v_mfma_f32_16x16x32_bf16 v[72:75], v[116:119], a[240:243], v[72:75]
    ds_read_b128 v[108:111], v252 offset:17408
    v_mfma_f32_16x16x32_bf16 v[76:79], v[116:119], a[244:247], v[76:79]
    s_waitcnt lgkmcnt(2)
    v_mfma_f32_16x16x32_bf16 v[64:67], v[120:123], a[248:251], v[64:67]
    ds_read_b128 v[112:115], v252 offset:18432
    v_mfma_f32_16x16x32_bf16 v[68:71], v[120:123], a[252:255], v[68:71]
    buffer_load_dwordx4 v221, s[40:43], s30 offen offset:1024 sc1 lds
    v_mfma_f32_16x16x32_bf16 v[72:75], v[124:127], a[248:251], v[72:75]
    ds_read_b128 v[116:119], v252 offset:20480
    s_add_u32 m0, s91, 116736
    v_mfma_f32_16x16x32_bf16 v[76:79], v[124:127], a[252:255], v[76:79]
    s_nop 0
    v_cvt_pk_bf16_f32 v64, v64, v65
    s_waitcnt lgkmcnt(2)
    v_mfma_f32_16x16x32_bf16 v[80:83], v[104:107], a[160:163], v[80:83]
    ds_read_b128 v[120:123], v252 offset:21504
    v_cvt_pk_bf16_f32 v65, v66, v67
    v_mfma_f32_16x16x32_bf16 v[84:87], v[104:107], a[164:167], v[84:87]
    buffer_load_dwordx4 v221, s[40:43], s31 offen sc1 lds
    v_mfma_f32_16x16x32_bf16 v[88:91], v[108:111], a[160:163], v[88:91]
    ds_read_b128 v[124:127], v252 offset:22528
    v_cvt_pk_bf16_f32 v66, v68, v69
    v_mfma_f32_16x16x32_bf16 v[92:95], v[108:111], a[164:167], v[92:95]
    v_cvt_pk_bf16_f32 v67, v70, v71
    s_waitcnt lgkmcnt(2)
    v_mfma_f32_16x16x32_bf16 v[96:99], v[112:115], a[160:163], v[96:99]
    ds_read_b128 v[104:107], v252 offset:24576
    v_mfma_f32_16x16x32_bf16 v[100:103], v[112:115], a[164:167], v[100:103]
    buffer_load_dwordx4 v221, s[40:43], s31 offen offset:1024 sc1 lds
    v_mfma_f32_16x16x32_bf16 v[80:83], v[116:119], a[168:171], v[80:83]
    ds_read_b128 v[108:111], v252 offset:25600
    s_add_u32 m0, s91, 32768
    v_mfma_f32_16x16x32_bf16 v[84:87], v[116:119], a[172:175], v[84:87]
    buffer_store_dwordx4 v[64:67], v244, s[40:43], s94 offen sc1
    s_waitcnt lgkmcnt(2)
    v_mfma_f32_16x16x32_bf16 v[88:91], v[120:123], a[168:171], v[88:91]
    ds_read_b128 v[112:115], v252 offset:26624
    v_cvt_pk_bf16_f32 v72, v72, v73
    v_mfma_f32_16x16x32_bf16 v[92:95], v[120:123], a[172:175], v[92:95]
    buffer_load_dwordx4 v221, s[40:43], s89 offen sc1 lds
    v_mfma_f32_16x16x32_bf16 v[96:99], v[124:127], a[168:171], v[96:99]
    ds_read_b128 v[116:119], v252 offset:28672
    v_cvt_pk_bf16_f32 v73, v74, v75
    v_mfma_f32_16x16x32_bf16 v[100:103], v[124:127], a[172:175], v[100:103]
    v_cvt_pk_bf16_f32 v74, v76, v77
    s_waitcnt lgkmcnt(2)
    v_mfma_f32_16x16x32_bf16 v[80:83], v[104:107], a[176:179], v[80:83]
    ds_read_b128 v[120:123], v252 offset:29696
    v_cvt_pk_bf16_f32 v75, v78, v79
    buffer_store_dwordx4 v[72:75], v244, s[40:43], s94 offen offset:1024 sc1
    v_mfma_f32_16x16x32_bf16 v[84:87], v[104:107], a[180:183], v[84:87]
    buffer_load_dwordx4 v221, s[40:43], s89 offen offset:1024 sc1 lds
    v_mfma_f32_16x16x32_bf16 v[88:91], v[108:111], a[176:179], v[88:91]
    ds_read_b128 v[124:127], v252 offset:30720
    ds_read_b64 v[192:193], v241
    v_mfma_f32_16x16x32_bf16 v[92:95], v[108:111], a[180:183], v[92:95]
    ds_read_b64 v[194:195], v241 offset:1024
    s_waitcnt lgkmcnt(4)
    v_mfma_f32_16x16x32_bf16 v[96:99], v[112:115], a[176:179], v[96:99]
    ds_read_b128 v[104:107], v244 offset:16384
    ds_read_b64 v[196:197], v245
    v_mfma_f32_16x16x32_bf16 v[100:103], v[112:115], a[180:183], v[100:103]
    ds_read_b64 v[198:199], v245 offset:1024
    ds_read_b64 v[200:201], v241 offset:2048
    ds_read2_b32 v[212:213], v237 offset0:0 offset1:16
    ds_read_b32 v214, v249
    v_cmp_ne_u32 vcc, s77, v176
    v_cmp_ne_u32 s[86:87], s77, v177
    s_nop 0
    s_or_b64 vcc, vcc, s[86:87]
    v_cmp_ne_u32 s[86:87], s77, v178
    s_nop 0
    s_or_b64 vcc, vcc, s[86:87]
    v_cmp_ne_u32 s[86:87], s77, v179
    s_nop 0
    s_or_b64 vcc, vcc, s[86:87]
    s_cbranch_vccnz SLOW_J2T
BACK_J2T:
    s_lshl_b32 m0, s52, 12
    s_waitcnt lgkmcnt(0)
    buffer_load_dwordx4 v238, s[40:43], s74 offen sc1 lds
    v_mfma_f32_16x16x32_bf16 v[80:83], v[116:119], a[184:187], v[80:83]
    ds_read_b128 v[108:111], v244 offset:17408
    s_add_u32 s82, s74, 64512
    v_mfma_f32_16x16x32_bf16 v[84:87], v[116:119], a[188:191], v[84:87]
    v_mfma_f32_16x16x32_bf16 v[88:91], v[120:123], a[184:187], v[88:91]
    ds_read_b128 v[112:115], v244 offset:18432
    v_mfma_f32_16x16x32_bf16 v[92:95], v[120:123], a[188:191], v[92:95]
    buffer_load_dwordx4 v238, s[40:43], s82 offen offset:1024 sc1 lds
    v_mfma_f32_16x16x32_bf16 v[96:99], v[124:127], a[184:187], v[96:99]
    ds_read_b128 v[116:119], v244 offset:20480
    v_mfma_f32_16x16x32_bf16 v[100:103], v[124:127], a[188:191], v[100:103]
    s_sub_u32 s82, s75, 2048
    s_waitcnt lgkmcnt(2)
    v_mfma_f32_16x16x32_bf16 v[80:83], v[104:107], a[192:195], v[80:83]
    ds_read_b128 v[120:123], v244 offset:21504
    v_mfma_f32_16x16x32_bf16 v[84:87], v[104:107], a[196:199], v[84:87]
    v_mfma_f32_16x16x32_bf16 v[88:91], v[108:111], a[192:195], v[88:91]
    ds_read_b128 v[124:127], v244 offset:22528
    v_mfma_f32_16x16x32_bf16 v[92:95], v[108:111], a[196:199], v[92:95]
    s_waitcnt lgkmcnt(2)
    v_mfma_f32_16x16x32_bf16 v[96:99], v[112:115], a[192:195], v[96:99]
    ds_read_b128 v[104:107], v244 offset:24576
    v_mfma_f32_16x16x32_bf16 v[100:103], v[112:115], a[196:199], v[100:103]
    buffer_load_dwordx4 v238, s[40:43], s82 offen offset:2048 sc1 lds
    v_mfma_f32_16x16x32_bf16 v[80:83], v[116:119], a[200:203], v[80:83]
    ds_read_b128 v[108:111], v244 offset:25600
    v_mfma_f32_16x16x32_bf16 v[84:87], v[116:119], a[204:207], v[84:87]
    s_waitcnt lgkmcnt(2)
    v_mfma_f32_16x16x32_bf16 v[88:91], v[120:123], a[200:203], v[88:91]
    ds_read_b128 v[112:115], v244 offset:26624
    v_mfma_f32_16x16x32_bf16 v[92:95], v[120:123], a[204:207], v[92:95]
    v_mfma_f32_16x16x32_bf16 v[96:99], v[124:127], a[200:203], v[96:99]
    ds_read_b128 v[116:119], v244 offset:28672
    v_mfma_f32_16x16x32_bf16 v[100:103], v[124:127], a[204:207], v[100:103]
    s_waitcnt lgkmcnt(2)
    v_mfma_f32_16x16x32_bf16 v[80:83], v[104:107], a[208:211], v[80:83]
    ds_read_b128 v[120:123], v244 offset:29696
    v_mfma_f32_16x16x32_bf16 v[84:87], v[104:107], a[212:215], v[84:87]
    v_mfma_f32_16x16x32_bf16 v[88:91], v[108:111], a[208:211], v[88:91]
    ds_read_b128 v[124:127], v244 offset:30720
    v_mfma_f32_16x16x32_bf16 v[92:95], v[108:111], a[212:215], v[92:95]
    s_waitcnt lgkmcnt(2)
    v_mfma_f32_16x16x32_bf16 v[96:99], v[112:115], a[208:211], v[96:99]
    ds_read_b128 v[104:107], v244 offset:49152
    v_mfma_f32_16x16x32_bf16 v[100:103], v[112:115], a[212:215], v[100:103]
    v_mfma_f32_16x16x32_bf16 v[80:83], v[116:119], a[216:219], v[80:83]
    ds_read_b128 v[108:111], v244 offset:50176
    v_mfma_f32_16x16x32_bf16 v[84:87], v[116:119], a[220:223], v[84:87]
    s_waitcnt lgkmcnt(2)
    v_mfma_f32_16x16x32_bf16 v[88:91], v[120:123], a[216:219], v[88:91]
    ds_read_b128 v[112:115], v244 offset:51200
    v_mfma_f32_16x16x32_bf16 v[92:95], v[120:123], a[220:223], v[92:95]
    v_mfma_f32_16x16x32_bf16 v[96:99], v[124:127], a[216:219], v[96:99]
    ds_read_b128 v[116:119], v244 offset:53248
    v_mfma_f32_16x16x32_bf16 v[100:103], v[124:127], a[220:223], v[100:103]
    s_waitcnt lgkmcnt(2)
    v_mfma_f32_16x16x32_bf16 v[80:83], v[104:107], a[224:227], v[80:83]
    ds_read_b128 v[120:123], v244 offset:54272
    v_mfma_f32_16x16x32_bf16 v[84:87], v[104:107], a[228:231], v[84:87]
    v_mfma_f32_16x16x32_bf16 v[88:91], v[108:111], a[224:227], v[88:91]
    ds_read_b128 v[124:127], v244 offset:55296
    v_mfma_f32_16x16x32_bf16 v[92:95], v[108:111], a[228:231], v[92:95]
    s_waitcnt lgkmcnt(2)
    v_mfma_f32_16x16x32_bf16 v[96:99], v[112:115], a[224:227], v[96:99]
KF_PG13:
    s_cbranch_execz KF_WEND
    ds_read_b128 v[104:107], v244 offset:57344
    v_mfma_f32_16x16x32_bf16 v[100:103], v[112:115], a[228:231], v[100:103]
    v_mfma_f32_16x16x32_bf16 v[80:83], v[116:119], a[232:235], v[80:83]
    ds_read_b128 v[108:111], v244 offset:58368
    v_mfma_f32_16x16x32_bf16 v[84:87], v[116:119], a[236:239], v[84:87]
    s_waitcnt lgkmcnt(2)
    v_mfma_f32_16x16x32_bf16 v[88:91], v[120:123], a[232:235], v[88:91]
    ds_read_b128 v[112:115], v244 offset:59392
    v_mfma_f32_16x16x32_bf16 v[92:95], v[120:123], a[236:239], v[92:95]
    v_mfma_f32_16x16x32_bf16 v[96:99], v[124:127], a[232:235], v[96:99]
    ds_read_b128 v[116:119], v244 offset:61440
    v_mfma_f32_16x16x32_bf16 v[100:103], v[124:127], a[236:239], v[100:103]
    s_waitcnt lgkmcnt(2)
    v_mfma_f32_16x16x32_bf16 v[80:83], v[104:107], a[240:243], v[80:83]
    ds_read_b128 v[120:123], v244 offset:62464
    v_mfma_f32_16x16x32_bf16 v[84:87], v[104:107], a[244:247], v[84:87]
    v_mfma_f32_16x16x32_bf16 v[88:91], v[108:111], a[240:243], v[88:91]
    ds_read_b128 v[124:127], v244 offset:63488
    v_mfma_f32_16x16x32_bf16 v[92:95], v[108:111], a[244:247], v[92:95]
    s_waitcnt vmcnt(17)
    s_barrier
    s_waitcnt lgkmcnt(2)
    v_mfma_f32_16x16x32_bf16 v[96:99], v[112:115], a[240:243], v[96:99]
    ds_read_b128 v[104:107], v251
    v_mfma_f32_16x16x32_bf16 v[100:103], v[112:115], a[244:247], v[100:103]
    v_mfma_f32_16x16x32_bf16 v[80:83], v[116:119], a[248:251], v[80:83]
    ds_read_b128 v[108:111], v251 offset:1024
    v_mfma_f32_16x16x32_bf16 v[84:87], v[116:119], a[252:255], v[84:87]
    s_waitcnt lgkmcnt(2)
    v_mfma_f32_16x16x32_bf16 v[88:91], v[120:123], a[248:251], v[88:91]
    ds_read_b128 v[112:115], v251 offset:4096
    v_mfma_f32_16x16x32_bf16 v[92:95], v[120:123], a[252:255], v[92:95]
    s_nop 1
    v_cvt_pk_bf16_f32 v80, v80, v81
    v_cvt_pk_bf16_f32 v81, v82, v83
    v_mfma_f32_16x16x32_bf16 v[96:99], v[124:127], a[248:251], v[96:99]
    ds_read_b128 v[116:119], v251 offset:5120
    v_cvt_pk_bf16_f32 v82, v84, v85
    v_mfma_f32_16x16x32_bf16 v[100:103], v[124:127], a[252:255], v[100:103]
    v_cvt_pk_bf16_f32 v83, v86, v87
    s_waitcnt lgkmcnt(2)
    v_mfma_f32_16x16x32_bf16 v[32:35], v[104:107], v[0:3], 0
    ds_read_b128 v[120:123], v251 offset:8192
    v_mfma_f32_16x16x32_bf16 v[36:39], v[104:107], v[4:7], 0
    buffer_store_dwordx4 v[80:83], v244, s[40:43], s95 offen sc1
    v_mfma_f32_16x16x32_bf16 v[40:43], v[108:111], v[0:3], 0
    ds_read_b128 v[124:127], v251 offset:9216
    v_cvt_pk_bf16_f32 v88, v88, v89
    v_mfma_f32_16x16x32_bf16 v[44:47], v[108:111], v[4:7], 0
    v_cvt_pk_bf16_f32 v89, v90, v91
    s_waitcnt lgkmcnt(2)
    v_mfma_f32_16x16x32_bf16 v[32:35], v[112:115], v[8:11], v[32:35]
    ds_read_b128 v[104:107], v251 offset:12288
    v_cvt_pk_bf16_f32 v90, v92, v93
    v_mfma_f32_16x16x32_bf16 v[36:39], v[112:115], v[12:15], v[36:39]
    v_cvt_pk_bf16_f32 v91, v94, v95
    v_mfma_f32_16x16x32_bf16 v[40:43], v[116:119], v[8:11], v[40:43]
    ds_read_b128 v[108:111], v251 offset:13312
    v_mfma_f32_16x16x32_bf16 v[44:47], v[116:119], v[12:15], v[44:47]
    s_waitcnt lgkmcnt(2)
    v_mfma_f32_16x16x32_bf16 v[32:35], v[120:123], v[16:19], v[32:35]
    ds_read_b128 v[112:115], v251 offset:2048
    v_mfma_f32_16x16x32_bf16 v[36:39], v[120:123], v[20:23], v[36:39]
    buffer_store_dwordx4 v[88:91], v244, s[40:43], s95 offen offset:1024 sc1
    v_mfma_f32_16x16x32_bf16 v[40:43], v[124:127], v[16:19], v[40:43]
    ds_read_b128 v[116:119], v251 offset:3072
    v_cvt_pk_bf16_f32 v96, v96, v97
    v_mfma_f32_16x16x32_bf16 v[44:47], v[124:127], v[20:23], v[44:47]
    v_cvt_pk_bf16_f32 v97, v98, v99
    s_waitcnt lgkmcnt(2)
    v_mfma_f32_16x16x32_bf16 v[32:35], v[104:107], v[24:27], v[32:35]
    ds_read_b128 v[120:123], v251 offset:6144
    v_cvt_pk_bf16_f32 v98, v100, v101
    v_mfma_f32_16x16x32_bf16 v[36:39], v[104:107], v[28:31], v[36:39]
    v_cvt_pk_bf16_f32 v99, v102, v103
    v_mfma_f32_16x16x32_bf16 v[40:43], v[108:111], v[24:27], v[40:43]
    ds_read_b128 v[124:127], v251 offset:7168
    v_mfma_f32_16x16x32_bf16 v[44:47], v[108:111], v[28:31], v[44:47]
    buffer_store_dwordx4 v[96:99], v244, s[40:43], s96 offen sc1
    s_waitcnt lgkmcnt(2)
    v_mfma_f32_16x16x32_bf16 v[32:35], v[112:115], a[0:3], v[32:35]
    ds_read_b128 v[104:107], v251 offset:10240
    v_mfma_f32_16x16x32_bf16 v[36:39], v[112:115], a[4:7], v[36:39]
    v_mfma_f32_16x16x32_bf16 v[40:43], v[116:119], a[0:3], v[40:43]
    ds_read_b128 v[108:111], v251 offset:11264
    v_mfma_f32_16x16x32_bf16 v[44:47], v[116:119], a[4:7], v[44:47]
    s_waitcnt lgkmcnt(2)
    v_mfma_f32_16x16x32_bf16 v[32:35], v[120:123], a[8:11], v[32:35]
    ds_read_b128 v[112:115], v251 offset:14336
    v_mfma_f32_16x16x32_bf16 v[36:39], v[120:123], a[12:15], v[36:39]
    v_mfma_f32_16x16x32_bf16 v[40:43], v[124:127], a[8:11], v[40:43]
    ds_read_b128 v[116:119], v251 offset:15360
    v_mfma_f32_16x16x32_bf16 v[44:47], v[124:127], a[12:15], v[44:47]
    s_waitcnt lgkmcnt(2)
    v_mfma_f32_16x16x32_bf16 v[32:35], v[104:107], a[16:19], v[32:35]
    ds_read_b128 v[120:123], v251 offset:32768
    v_mfma_f32_16x16x32_bf16 v[36:39], v[104:107], a[20:23], v[36:39]
    v_mfma_f32_16x16x32_bf16 v[40:43], v[108:111], a[16:19], v[40:43]
    ds_read_b128 v[124:127], v251 offset:33792
    v_mfma_f32_16x16x32_bf16 v[44:47], v[108:111], a[20:23], v[44:47]
    s_waitcnt lgkmcnt(2)
    v_mfma_f32_16x16x32_bf16 v[32:35], v[112:115], a[24:27], v[32:35]
    ds_read_b128 v[104:107], v251 offset:36864
    v_mfma_f32_16x16x32_bf16 v[36:39], v[112:115], a[28:31], v[36:39]
    v_mfma_f32_16x16x32_bf16 v[40:43], v[116:119], a[24:27], v[40:43]
    ds_read_b128 v[108:111], v251 offset:37888
    v_mfma_f32_16x16x32_bf16 v[44:47], v[116:119], a[28:31], v[44:47]
    s_waitcnt lgkmcnt(2)
    v_mfma_f32_16x16x32_bf16 v[32:35], v[120:123], a[32:35], v[32:35]
    ds_read_b128 v[112:115], v251 offset:40960
    v_mfma_f32_16x16x32_bf16 v[36:39], v[120:123], a[36:39], v[36:39]
    s_waitcnt vmcnt(3)
    ds_read_b64_tr_b16 v[202:203], v239
    v_mfma_f32_16x16x32_bf16 v[40:43], v[124:127], a[32:35], v[40:43]
    ds_read_b128 v[116:119], v251 offset:41984
    ds_read_b64_tr_b16 v[204:205], v239 offset:32
    v_mfma_f32_16x16x32_bf16 v[44:47], v[124:127], a[36:39], v[44:47]
    ds_read_b64_tr_b16 v[206:207], v239 offset:1024
    s_waitcnt lgkmcnt(5)
    v_mfma_f32_16x16x32_bf16 v[32:35], v[104:107], a[40:43], v[32:35]
    ds_read_b128 v[120:123], v251 offset:45056
    ds_read_b64_tr_b16 v[208:209], v239 offset:1056
    v_mfma_f32_16x16x32_bf16 v[36:39], v[104:107], a[44:47], v[36:39]
    ds_read_b64_tr_b16 v[210:211], v239 offset:2048
    v_mfma_f32_16x16x32_bf16 v[40:43], v[108:111], a[40:43], v[40:43]
    ds_read_b128 v[124:127], v251 offset:46080
    v_mfma_f32_16x16x32_bf16 v[44:47], v[108:111], a[44:47], v[44:47]
    s_barrier
    s_waitcnt lgkmcnt(6)
    v_mfma_f32_16x16x32_bf16 v[32:35], v[112:115], a[48:51], v[32:35]
    ds_read_b128 v[104:107], v251 offset:34816
    v_mfma_f32_16x16x32_bf16 v[36:39], v[112:115], a[52:55], v[36:39]
    s_waitcnt lgkmcnt(2)
    v_pk_max_u16 v216, v202, v203
    v_mfma_f32_16x16x32_bf16 v[40:43], v[116:119], a[48:51], v[40:43]
    ds_read_b128 v[108:111], v251 offset:35840
    v_pk_max_u16 v217, v204, v205
    v_mfma_f32_16x16x32_bf16 v[44:47], v[116:119], a[52:55], v[44:47]
    v_pk_max_u16 v216, v216, v206
    s_waitcnt lgkmcnt(2)
    v_mfma_f32_16x16x32_bf16 v[32:35], v[120:123], a[56:59], v[32:35]
    ds_read_b128 v[112:115], v251 offset:38912
    v_pk_max_u16 v217, v217, v207
    v_mfma_f32_16x16x32_bf16 v[36:39], v[120:123], a[60:63], v[36:39]
    v_pk_max_u16 v216, v216, v208
    v_pk_max_u16 v217, v217, v209
    v_mfma_f32_16x16x32_bf16 v[40:43], v[124:127], a[56:59], v[40:43]
    ds_read_b128 v[116:119], v251 offset:39936
    v_pk_max_u16 v216, v216, v210
    v_mfma_f32_16x16x32_bf16 v[44:47], v[124:127], a[60:63], v[44:47]
    v_pk_max_u16 v217, v217, v211
    s_waitcnt lgkmcnt(2)
    v_mfma_f32_16x16x32_bf16 v[32:35], v[104:107], a[64:67], v[32:35]
    ds_read_b128 v[120:123], v251 offset:43008
    v_pk_max_u16 v216, v216, v217
    v_mfma_f32_16x16x32_bf16 v[36:39], v[104:107], a[68:71], v[36:39]
    v_lshlrev_b32 v217, 16, v216
    v_max_u32 v216, v216, v217
    v_mfma_f32_16x16x32_bf16 v[40:43], v[108:111], a[64:67], v[40:43]
    ds_read_b128 v[124:127], v251 offset:44032
    v_mfma_f32_16x16x32_bf16 v[44:47], v[108:111], a[68:71], v[44:47]
    s_waitcnt lgkmcnt(2)
    v_mfma_f32_16x16x32_bf16 v[32:35], v[112:115], a[72:75], v[32:35]
    ds_read_b128 v[104:107], v251 offset:47104
    v_mfma_f32_16x16x32_bf16 v[36:39], v[112:115], a[76:79], v[36:39]
    v_cmp_le_u32 vcc, s99, v216
    s_cbranch_vccnz SLOW_YT
BACK_YT:
    v_mfma_f32_16x16x32_bf16 v[40:43], v[116:119], a[72:75], v[40:43]
    ds_read_b128 v[108:111], v251 offset:48128
    v_lshlrev_b32 v48, 16, v192
    v_mfma_f32_16x16x32_bf16 v[44:47], v[116:119], a[76:79], v[44:47]
    v_lshlrev_b32 v68, 16, v202
    s_waitcnt lgkmcnt(2)
    v_mfma_f32_16x16x32_bf16 v[32:35], v[120:123], a[80:83], v[32:35]
    ds_read_b128 v[112:115], v251 offset:16384
    v_and_b32 v49, s99, v192
    v_mfma_f32_16x16x32_bf16 v[36:39], v[120:123], a[84:87], v[36:39]
    v_and_b32 v69, s99, v202
    v_lshlrev_b32 v50, 16, v193
    v_mfma_f32_16x16x32_bf16 v[40:43], v[124:127], a[80:83], v[40:43]
    ds_read_b128 v[116:119], v251 offset:17408
    v_lshlrev_b32 v70, 16, v203
    v_mfma_f32_16x16x32_bf16 v[44:47], v[124:127], a[84:87], v[44:47]
    v_and_b32 v51, s99, v193
    s_waitcnt lgkmcnt(2)
    v_mfma_f32_16x16x32_bf16 v[32:35], v[104:107], a[88:91], v[32:35]
    ds_read_b128 v[120:123], v251 offset:20480
    v_and_b32 v71, s99, v203
    v_mfma_f32_16x16x32_bf16 v[36:39], v[104:107], a[92:95], v[36:39]
    v_mul_f32 v48, v48, v68
    v_mul_f32 v49, v49, v69
    v_mfma_f32_16x16x32_bf16 v[40:43], v[108:111], a[88:91], v[40:43]
    ds_read_b128 v[124:127], v251 offset:21504
    v_mul_f32 v50, v50, v70
    v_mfma_f32_16x16x32_bf16 v[44:47], v[108:111], a[92:95], v[44:47]
    v_mul_f32 v51, v51, v71
    s_waitcnt lgkmcnt(2)
    v_mfma_f32_16x16x32_bf16 v[32:35], v[112:115], a[96:99], v[32:35]
    ds_read_b128 v[104:107], v251 offset:24576
    v_mul_f32 v48, v48, v212
    v_mfma_f32_16x16x32_bf16 v[36:39], v[112:115], a[100:103], v[36:39]
    buffer_load_dwordx4 v[128:131], v244, s[40:43], s72 offen sc1
    v_mfma_f32_16x16x32_bf16 v[40:43], v[116:119], a[96:99], v[40:43]
    ds_read_b128 v[108:111], v251 offset:25600
    v_mul_f32 v49, v49, v212
    v_mfma_f32_16x16x32_bf16 v[44:47], v[116:119], a[100:103], v[44:47]
    v_mul_f32 v50, v50, v212
    s_waitcnt lgkmcnt(2)
    v_mfma_f32_16x16x32_bf16 v[32:35], v[120:123], a[104:107], v[32:35]
    ds_read_b128 v[112:115], v251 offset:28672
    v_mul_f32 v51, v51, v212
    v_mfma_f32_16x16x32_bf16 v[36:39], v[120:123], a[108:111], v[36:39]
    buffer_load_dwordx4 v[132:135], v244, s[40:43], s72 offen offset:1024 sc1
    v_mfma_f32_16x16x32_bf16 v[40:43], v[124:127], a[104:107], v[40:43]
    ds_read_b128 v[116:119], v251 offset:29696
    v_lshlrev_b32 v52, 16, v194
    v_mfma_f32_16x16x32_bf16 v[44:47], v[124:127], a[108:111], v[44:47]
    v_lshlrev_b32 v68, 16, v204
    s_waitcnt lgkmcnt(2)
    v_mfma_f32_16x16x32_bf16 v[32:35], v[104:107], a[112:115], v[32:35]
    ds_read_b128 v[120:123], v251 offset:18432
    v_and_b32 v53, s99, v194
    v_mfma_f32_16x16x32_bf16 v[36:39], v[104:107], a[116:119], v[36:39]
    buffer_load_dwordx4 v[136:139], v244, s[40:43], s72 offen offset:2048 sc1
    v_mfma_f32_16x16x32_bf16 v[40:43], v[108:111], a[112:115], v[40:43]
    ds_read_b128 v[124:127], v251 offset:19456
    v_and_b32 v69, s99, v204
    v_mfma_f32_16x16x32_bf16 v[44:47], v[108:111], a[116:119], v[44:47]
    v_lshlrev_b32 v54, 16, v195
    s_waitcnt lgkmcnt(2)
    v_mfma_f32_16x16x32_bf16 v[32:35], v[112:115], a[120:123], v[32:35]
    ds_read_b128 v[104:107], v251 offset:22528
    v_lshlrev_b32 v70, 16, v205
    v_mfma_f32_16x16x32_bf16 v[36:39], v[112:115], a[124:127], v[36:39]
    buffer_load_dwordx4 v[140:143], v244, s[40:43], s72 offen offset:3072 sc1
    v_mfma_f32_16x16x32_bf16 v[40:43], v[116:119], a[120:123], v[40:43]
    ds_read_b128 v[108:111], v251 offset:23552
    v_and_b32 v55, s99, v195
    v_mfma_f32_16x16x32_bf16 v[44:47], v[116:119], a[124:127], v[44:47]
    v_and_b32 v71, s99, v205
    s_waitcnt lgkmcnt(2)
    v_mfma_f32_16x16x32_bf16 v[32:35], v[120:123], a[128:131], v[32:35]
    ds_read_b128 v[112:115], v251 offset:26624
    v_mul_f32 v52, v52, v68
    v_mfma_f32_16x16x32_bf16 v[36:39], v[120:123], a[132:135], v[36:39]
    v_mul_f32 v53, v53, v69
    v_mul_f32 v54, v54, v70
    v_mfma_f32_16x16x32_bf16 v[40:43], v[124:127], a[128:131], v[40:43]
    ds_read_b128 v[116:119], v251 offset:27648
    v_mul_f32 v55, v55, v71
    v_mfma_f32_16x16x32_bf16 v[44:47], v[124:127], a[132:135], v[44:47]
    v_mul_f32 v52, v52, v213
    s_waitcnt lgkmcnt(2)
    v_mfma_f32_16x16x32_bf16 v[32:35], v[104:107], a[136:139], v[32:35]
    ds_read_b128 v[120:123], v251 offset:30720
    v_mul_f32 v53, v53, v213
    v_mfma_f32_16x16x32_bf16 v[36:39], v[104:107], a[140:143], v[36:39]
    v_mul_f32 v54, v54, v213
    v_mul_f32 v55, v55, v213
    v_mfma_f32_16x16x32_bf16 v[40:43], v[108:111], a[136:139], v[40:43]
    ds_read_b128 v[124:127], v251 offset:31744
    v_lshlrev_b32 v56, 16, v196
    v_mfma_f32_16x16x32_bf16 v[44:47], v[108:111], a[140:143], v[44:47]
    s_barrier
    s_waitcnt lgkmcnt(2)
    v_mfma_f32_16x16x32_bf16 v[32:35], v[112:115], a[144:147], v[32:35]
    ds_read_b128 v[104:107], v251 offset:49152
    v_lshlrev_b32 v68, 16, v206
    v_mfma_f32_16x16x32_bf16 v[36:39], v[112:115], a[148:151], v[36:39]
    v_and_b32 v57, s99, v196
    v_and_b32 v69, s99, v206
    v_mfma_f32_16x16x32_bf16 v[40:43], v[116:119], a[144:147], v[40:43]
    ds_read_b128 v[108:111], v251 offset:50176
    v_lshlrev_b32 v58, 16, v197
    v_mfma_f32_16x16x32_bf16 v[44:47], v[116:119], a[148:151], v[44:47]
    v_lshlrev_b32 v70, 16, v207
    s_waitcnt lgkmcnt(2)
    v_mfma_f32_16x16x32_bf16 v[32:35], v[120:123], a[152:155], v[32:35]
    ds_read_b128 v[112:115], v251 offset:53248
    v_and_b32 v59, s99, v197
    v_mfma_f32_16x16x32_bf16 v[36:39], v[120:123], a[156:159], v[36:39]
    v_and_b32 v71, s99, v207
    v_mfma_f32_16x16x32_bf16 v[40:43], v[124:127], a[152:155], v[40:43]
    ds_read_b128 v[116:119], v251 offset:54272
    v_mul_f32 v56, v56, v68
    v_mfma_f32_16x16x32_bf16 v[44:47], v[124:127], a[156:159], v[44:47]
    v_mul_f32 v57, v57, v69
    s_waitcnt lgkmcnt(2)
    v_mfma_f32_16x16x32_bf16 v[32:35], v[104:107], a[160:163], v[32:35]
    ds_read_b128 v[120:123], v251 offset:57344
    v_mul_f32 v58, v58, v70
    v_mfma_f32_16x16x32_bf16 v[36:39], v[104:107], a[164:167], v[36:39]
    buffer_load_dwordx4 v[144:147], v244, s[40:43], s59 offen sc1
    v_mfma_f32_16x16x32_bf16 v[40:43], v[108:111], a[160:163], v[40:43]
    ds_read_b128 v[124:127], v251 offset:58368
    v_mul_f32 v59, v59, v71
    v_mfma_f32_16x16x32_bf16 v[44:47], v[108:111], a[164:167], v[44:47]
    v_mul_f32 v56, v56, v212
    s_waitcnt lgkmcnt(2)
    v_mfma_f32_16x16x32_bf16 v[32:35], v[112:115], a[168:171], v[32:35]
    ds_read_b128 v[104:107], v251 offset:61440
    v_mul_f32 v57, v57, v212
    v_mfma_f32_16x16x32_bf16 v[36:39], v[112:115], a[172:175], v[36:39]
    buffer_load_dwordx4 v[148:151], v244, s[40:43], s59 offen offset:1024 sc1
    v_mfma_f32_16x16x32_bf16 v[40:43], v[116:119], a[168:171], v[40:43]
    ds_read_b128 v[108:111], v251 offset:62464
    v_mul_f32 v58, v58, v212
    v_mfma_f32_16x16x32_bf16 v[44:47], v[116:119], a[172:175], v[44:47]
    v_mul_f32 v59, v59, v212
    s_waitcnt lgkmcnt(2)
    v_mfma_f32_16x16x32_bf16 v[32:35], v[120:123], a[176:179], v[32:35]
    ds_read_b128 v[112:115], v251 offset:51200
    v_lshlrev_b32 v60, 16, v198
    v_mfma_f32_16x16x32_bf16 v[36:39], v[120:123], a[180:183], v[36:39]
    buffer_load_dwordx2 v[152:153], v244, s[40:43], s73 offen sc1
    v_mfma_f32_16x16x32_bf16 v[40:43], v[124:127], a[176:179], v[40:43]
    ds_read_b128 v[116:119], v251 offset:52224
    v_lshlrev_b32 v68, 16, v208
    v_mfma_f32_16x16x32_bf16 v[44:47], v[124:127], a[180:183], v[44:47]
    v_and_b32 v61, s99, v198
    s_waitcnt lgkmcnt(2)
    v_mfma_f32_16x16x32_bf16 v[32:35], v[104:107], a[184:187], v[32:35]
    ds_read_b128 v[120:123], v251 offset:55296
    v_and_b32 v69, s99, v208
    v_mfma_f32_16x16x32_bf16 v[36:39], v[104:107], a[188:191], v[36:39]
    buffer_load_dwordx2 v[154:155], v244, s[40:43], s73 offen offset:1024 sc1
    v_mfma_f32_16x16x32_bf16 v[40:43], v[108:111], a[184:187], v[40:43]
    ds_read_b128 v[124:127], v251 offset:56320
    v_lshlrev_b32 v62, 16, v199
    v_mfma_f32_16x16x32_bf16 v[44:47], v[108:111], a[188:191], v[44:47]
    v_lshlrev_b32 v70, 16, v209
    s_waitcnt lgkmcnt(2)
    v_mfma_f32_16x16x32_bf16 v[32:35], v[112:115], a[192:195], v[32:35]
    ds_read_b128 v[104:107], v251 offset:59392
    v_and_b32 v63, s99, v199
    v_mfma_f32_16x16x32_bf16 v[36:39], v[112:115], a[196:199], v[36:39]
    buffer_load_dwordx2 v[156:157], v244, s[40:43], s73 offen offset:2048 sc1
    v_mfma_f32_16x16x32_bf16 v[40:43], v[116:119], a[192:195], v[40:43]
    ds_read_b128 v[108:111], v251 offset:60416
    v_and_b32 v71, s99, v209
    v_mfma_f32_16x16x32_bf16 v[44:47], v[116:119], a[196:199], v[44:47]
    v_mul_f32 v60, v60, v68
    s_waitcnt lgkmcnt(2)
    v_mfma_f32_16x16x32_bf16 v[32:35], v[120:123], a[200:203], v[32:35]
    ds_read_b128 v[112:115], v251 offset:63488
    v_mul_f32 v61, v61, v69
    v_mfma_f32_16x16x32_bf16 v[36:39], v[120:123], a[204:207], v[36:39]
    buffer_load_dwordx2 v[158:159], v244, s[40:43], s73 offen offset:3072 sc1
    v_mfma_f32_16x16x32_bf16 v[40:43], v[124:127], a[200:203], v[40:43]
    ds_read_b128 v[116:119], v251 offset:64512
    v_mul_f32 v62, v62, v70
    v_mfma_f32_16x16x32_bf16 v[44:47], v[124:127], a[204:207], v[44:47]
    v_mul_f32 v63, v63, v71
    s_waitcnt lgkmcnt(2)
    v_mfma_f32_16x16x32_bf16 v[32:35], v[104:107], a[208:211], v[32:35]
    ds_read_b128 v[120:123], v244 offset:32768
    v_mul_f32 v60, v60, v213
    v_mfma_f32_16x16x32_bf16 v[36:39], v[104:107], a[212:215], v[36:39]
    v_mul_f32 v61, v61, v213
    v_mul_f32 v62, v62, v213
    v_mfma_f32_16x16x32_bf16 v[40:43], v[108:111], a[208:211], v[40:43]
    ds_read_b128 v[124:127], v244 offset:33792
    v_mul_f32 v63, v63, v213
    v_mfma_f32_16x16x32_bf16 v[44:47], v[108:111], a[212:215], v[44:47]
    v_lshlrev_b32 v64, 16, v200
    s_waitcnt lgkmcnt(2)
    v_mfma_f32_16x16x32_bf16 v[32:35], v[112:115], a[216:219], v[32:35]
    ds_read_b128 v[104:107], v244 offset:36864
    v_lshlrev_b32 v68, 16, v210
    v_mfma_f32_16x16x32_bf16 v[36:39], v[112:115], a[220:223], v[36:39]
    v_and_b32 v65, s99, v200
    v_and_b32 v69, s99, v210
    v_mfma_f32_16x16x32_bf16 v[40:43], v[116:119], a[216:219], v[40:43]
    ds_read_b128 v[108:111], v244 offset:37888
    v_lshlrev_b32 v66, 16, v201
    v_mfma_f32_16x16x32_bf16 v[44:47], v[116:119], a[220:223], v[44:47]
    v_lshlrev_b32 v70, 16, v211
    s_waitcnt lgkmcnt(2)
    v_mfma_f32_16x16x32_bf16 v[32:35], v[120:123], a[224:227], v[32:35]
    ds_read_b128 v[112:115], v244 offset:40960
    v_and_b32 v67, s99, v201
    v_mfma_f32_16x16x32_bf16 v[36:39], v[120:123], a[228:231], v[36:39]
    v_and_b32 v71, s99, v211
    v_mul_f32 v64, v64, v68
    v_mfma_f32_16x16x32_bf16 v[40:43], v[124:127], a[224:227], v[40:43]
    ds_read_b128 v[116:119], v244 offset:41984
    v_mul_f32 v65, v65, v69
    v_mfma_f32_16x16x32_bf16 v[44:47], v[124:127], a[228:231], v[44:47]
    v_mul_f32 v66, v66, v70
    s_waitcnt lgkmcnt(2)
    v_mfma_f32_16x16x32_bf16 v[32:35], v[104:107], a[232:235], v[32:35]
    ds_read_b128 v[120:123], v244 offset:45056
    v_mul_f32 v67, v67, v71
    v_mfma_f32_16x16x32_bf16 v[36:39], v[104:107], a[236:239], v[36:39]
    v_mul_f32 v64, v64, v214
    v_mul_f32 v65, v65, v214
    v_mfma_f32_16x16x32_bf16 v[40:43], v[108:111], a[232:235], v[40:43]
    ds_read_b128 v[124:127], v244 offset:46080
    v_mul_f32 v66, v66, v214
    v_mfma_f32_16x16x32_bf16 v[44:47], v[108:111], a[236:239], v[44:47]
    v_mul_f32 v67, v67, v214
    s_waitcnt lgkmcnt(2)
    v_mfma_f32_16x16x32_bf16 v[32:35], v[112:115], a[240:243], v[32:35]
    v_sub_f32 v212, 1.0, v212
    v_mfma_f32_16x16x32_bf16 v[36:39], v[112:115], a[244:247], v[36:39]
    v_sub_f32 v213, 1.0, v213
    v_mfma_f32_16x16x32_bf16 v[40:43], v[116:119], a[240:243], v[40:43]
    v_sub_f32 v214, 1.0, v214
    v_mfma_f32_16x16x32_bf16 v[44:47], v[116:119], a[244:247], v[44:47]
    s_waitcnt lgkmcnt(0)
    v_mfma_f32_16x16x32_bf16 v[32:35], v[120:123], a[248:251], v[32:35]
    v_mfma_f32_16x16x32_bf16 v[36:39], v[120:123], a[252:255], v[36:39]
    v_mfma_f32_16x16x32_bf16 v[40:43], v[124:127], a[248:251], v[40:43]
    v_mfma_f32_16x16x32_bf16 v[44:47], v[124:127], a[252:255], v[44:47]
    s_waitcnt vmcnt(0)
    v_max3_u32 v72, v128, v129, v130
    v_max3_u32 v73, v131, v132, v133
    v_max3_u32 v72, v72, v134, v135
    v_max3_u32 v73, v73, v136, v137
    v_max3_u32 v72, v72, v138, v139
    v_max3_u32 v73, v73, v140, v141
    v_max3_u32 v72, v72, v142, v143
    v_max3_u32 v73, v73, v144, v145
    v_max3_u32 v72, v72, v146, v147
    v_max3_u32 v73, v73, v148, v149
    v_max3_u32 v72, v72, v150, v151
    v_max3_u32 v73, v73, v152, v153
    v_max3_u32 v72, v72, v154, v155
    v_max3_u32 v73, v73, v156, v157
    v_max3_u32 v72, v72, v158, v159
    v_max_u32 v72, v72, v73
    v_cmp_eq_u32 vcc, -1, v72
    s_cbranch_vccnz SLOW_RT
BACK_RT:
    v_lshlrev_b32 v160, 16, v128
    v_and_b32 v161, s99, v128
    v_lshlrev_b32 v162, 16, v129
    v_and_b32 v163, s99, v129
    v_lshlrev_b32 v164, 16, v136
    v_and_b32 v165, s99, v136
    v_lshlrev_b32 v166, 16, v137
    v_and_b32 v167, s99, v137
    v_lshlrev_b32 v168, 16, v144
    v_and_b32 v169, s99, v144
    v_lshlrev_b32 v170, 16, v145
    v_and_b32 v171, s99, v145
    v_add_f32 v160, v160, v164
    v_add_f32 v161, v161, v165
    v_add_f32 v162, v162, v166
    v_add_f32 v163, v163, v167
    v_add_f32 v32, v32, v168
    v_add_f32 v33, v33, v169
    v_add_f32 v34, v34, v170
    v_add_f32 v35, v35, v171
    v_add_f32 v32, v32, v160
    v_add_f32 v33, v33, v161
    v_add_f32 v34, v34, v162
    v_add_f32 v35, v35, v163
    v_fmac_f32 v48, v32, v212
    v_fmac_f32 v49, v33, v212
    v_fmac_f32 v50, v34, v212
    v_fmac_f32 v51, v35, v212
    v_cvt_pk_bf16_f32 v48, v48, v49
    v_cvt_pk_bf16_f32 v49, v50, v51
    ds_write_b64 v241, v[48:49]
    v_lshlrev_b32 v160, 16, v132
    v_and_b32 v161, s99, v132
    v_lshlrev_b32 v162, 16, v133
    v_and_b32 v163, s99, v133
    v_lshlrev_b32 v164, 16, v140
    v_and_b32 v165, s99, v140
    v_lshlrev_b32 v166, 16, v141
    v_and_b32 v167, s99, v141
    v_lshlrev_b32 v168, 16, v148
    v_and_b32 v169, s99, v148
    v_lshlrev_b32 v170, 16, v149
    v_and_b32 v171, s99, v149
    v_add_f32 v160, v160, v164
    v_add_f32 v161, v161, v165
    v_add_f32 v162, v162, v166
    v_add_f32 v163, v163, v167
    v_add_f32 v40, v40, v168
    v_add_f32 v41, v41, v169
    v_add_f32 v42, v42, v170
    v_add_f32 v43, v43, v171
    v_add_f32 v40, v40, v160
    v_add_f32 v41, v41, v161
    v_add_f32 v42, v42, v162
    v_add_f32 v43, v43, v163
    v_fmac_f32 v56, v40, v212
    v_fmac_f32 v57, v41, v212
    v_fmac_f32 v58, v42, v212
    v_fmac_f32 v59, v43, v212
    v_cvt_pk_bf16_f32 v56, v56, v57
    v_cvt_pk_bf16_f32 v57, v58, v59
    ds_write_b64 v245, v[56:57]
    ds_read_b128 v[192:195], v253
    v_lshlrev_b32 v160, 16, v130
    v_and_b32 v161, s99, v130
    v_lshlrev_b32 v162, 16, v131
    v_and_b32 v163, s99, v131
    v_lshlrev_b32 v164, 16, v138
    v_and_b32 v165, s99, v138
    v_lshlrev_b32 v166, 16, v139
    v_and_b32 v167, s99, v139
    v_lshlrev_b32 v168, 16, v146
    v_and_b32 v169, s99, v146
    v_lshlrev_b32 v170, 16, v147
    v_and_b32 v171, s99, v147
    v_add_f32 v160, v160, v164
    v_add_f32 v161, v161, v165
    v_add_f32 v162, v162, v166
    v_add_f32 v163, v163, v167
    v_add_f32 v36, v36, v168
    v_add_f32 v37, v37, v169
    v_add_f32 v38, v38, v170
    v_add_f32 v39, v39, v171
    v_add_f32 v36, v36, v160
    v_add_f32 v37, v37, v161
    v_add_f32 v38, v38, v162
    v_add_f32 v39, v39, v163
    v_fmac_f32 v52, v36, v213
    v_fmac_f32 v53, v37, v213
    v_fmac_f32 v54, v38, v213
    v_fmac_f32 v55, v39, v213
    v_cvt_pk_bf16_f32 v52, v52, v53
    v_cvt_pk_bf16_f32 v53, v54, v55
    s_waitcnt lgkmcnt(0)
    buffer_store_dwordx4 v[192:195], v254, s[44:47], s68 offen
    ds_write_b64 v241, v[52:53] offset:1024
    v_lshlrev_b32 v160, 16, v134
    v_and_b32 v161, s99, v134
    v_lshlrev_b32 v162, 16, v135
    v_and_b32 v163, s99, v135
    v_lshlrev_b32 v164, 16, v142
    v_and_b32 v165, s99, v142
    v_lshlrev_b32 v166, 16, v143
    v_and_b32 v167, s99, v143
    v_lshlrev_b32 v168, 16, v150
    v_and_b32 v169, s99, v150
    v_lshlrev_b32 v170, 16, v151
    v_and_b32 v171, s99, v151
    v_add_f32 v160, v160, v164
    v_add_f32 v161, v161, v165
    v_add_f32 v162, v162, v166
    v_add_f32 v163, v163, v167
    v_add_f32 v44, v44, v168
    v_add_f32 v45, v45, v169
    v_add_f32 v46, v46, v170
    v_add_f32 v47, v47, v171
    v_add_f32 v44, v44, v160
    v_add_f32 v45, v45, v161
    v_add_f32 v46, v46, v162
    v_add_f32 v47, v47, v163
    v_fmac_f32 v60, v44, v213
    v_fmac_f32 v61, v45, v213
    v_fmac_f32 v62, v46, v213
    v_fmac_f32 v63, v47, v213
    v_cvt_pk_bf16_f32 v60, v60, v61
    v_cvt_pk_bf16_f32 v61, v62, v63
    ds_write_b64 v245, v[60:61] offset:1024
    ds_read_b128 v[196:199], v253 offset:1024
    v_lshlrev_b32 v172, 16, v152
    v_and_b32 v173, s99, v152
    v_lshlrev_b32 v174, 16, v153
    v_and_b32 v175, s99, v153
    v_lshlrev_b32 v160, 16, v154
    v_and_b32 v161, s99, v154
    v_lshlrev_b32 v162, 16, v155
    v_and_b32 v163, s99, v155
    v_lshlrev_b32 v164, 16, v156
    v_and_b32 v165, s99, v156
    v_lshlrev_b32 v166, 16, v157
    v_and_b32 v167, s99, v157
    v_lshlrev_b32 v168, 16, v158
    v_and_b32 v169, s99, v158
    v_lshlrev_b32 v170, 16, v159
    v_and_b32 v171, s99, v159
    v_add_f32 v160, v160, v164
    v_add_f32 v161, v161, v165
    v_add_f32 v162, v162, v166
    v_add_f32 v163, v163, v167
    v_add_f32 v172, v172, v168
    v_add_f32 v173, v173, v169
    v_add_f32 v174, v174, v170
    v_add_f32 v175, v175, v171
    v_add_f32 v172, v172, v160
    v_add_f32 v173, v173, v161
    v_add_f32 v174, v174, v162
    v_add_f32 v175, v175, v163
    v_fmac_f32 v64, v172, v214
    v_fmac_f32 v65, v173, v214
    v_fmac_f32 v66, v174, v214
    v_fmac_f32 v67, v175, v214
    v_cvt_pk_bf16_f32 v64, v64, v65
    v_cvt_pk_bf16_f32 v65, v66, v67
    s_waitcnt lgkmcnt(0)
    buffer_store_dwordx4 v[196:199], v254, s[44:47], s69 offen
    ds_write_b64 v241, v[64:65] offset:2048
    ds_read_b128 v[200:203], v253 offset:2048
    s_mov_b64 exec, s[80:81]
    s_waitcnt lgkmcnt(0)
    buffer_store_dwordx4 v[200:203], v254, s[44:47], s70 offen
    s_endpgm
SLOW_N:
    s_sleep 4
    buffer_load_dword a254, off, s[44:47], 0 sc1
    s_waitcnt vmcnt(0)
    v_accvgpr_read_b32 v249, a254
    v_cmp_eq_u32 vcc, 0, v249
    s_cbranch_vccz BACK_N
    s_sub_u32 s3, s3, 1
    s_cbranch_scc0 SLOW_N
    s_mov_b32 s3, 0
    s_branch BACK_N
SLOW_J1:
    s_sleep 4
    buffer_load_dwordx4 v[252:255], v244, s[40:43], s58 offen sc1
    s_waitcnt vmcnt(0)
    v_cmp_ne_u32 vcc, s77, v252
    v_cmp_ne_u32 s[86:87], s77, v253
    s_nop 0
    s_or_b64 vcc, vcc, s[86:87]
    v_cmp_ne_u32 s[86:87], s77, v254
    s_nop 0
    s_or_b64 vcc, vcc, s[86:87]
    v_cmp_ne_u32 s[86:87], s77, v255
    s_nop 0
    s_or_b64 vcc, vcc, s[86:87]
    s_cbranch_vccz BACK_J1
    s_sub_u32 s3, s3, 1
    s_cbranch_scc0 SLOW_J1
    s_mov_b32 s3, 0
    s_branch BACK_J1
SLOW_J3:
    s_sleep 4
    buffer_load_dwordx4 v[176:179], v244, s[40:43], s58 offen offset:2048 sc1
    s_waitcnt vmcnt(0)
    v_cmp_ne_u32 vcc, s77, v176
    v_cmp_ne_u32 s[86:87], s77, v177
    s_nop 0
    s_or_b64 vcc, vcc, s[86:87]
    v_cmp_ne_u32 s[86:87], s77, v178
    s_nop 0
    s_or_b64 vcc, vcc, s[86:87]
    v_cmp_ne_u32 s[86:87], s77, v179
    s_nop 0
    s_or_b64 vcc, vcc, s[86:87]
    s_cbranch_vccz BACK_J3
    s_sub_u32 s3, s3, 1
    s_cbranch_scc0 SLOW_J3
    s_mov_b32 s3, 0
    s_branch BACK_J3
SLOW_J2D:
    s_sleep 4
    buffer_load_dwordx4 v[176:179], v244, s[40:43], s58 offen offset:1024 sc1
    s_waitcnt vmcnt(0)
    v_cmp_ne_u32 vcc, s77, v176
    v_cmp_ne_u32 s[86:87], s77, v177
    s_nop 0
    s_or_b64 vcc, vcc, s[86:87]
    v_cmp_ne_u32 s[86:87], s77, v178
    s_nop 0
    s_or_b64 vcc, vcc, s[86:87]
    v_cmp_ne_u32 s[86:87], s77, v179
    s_nop 0
    s_or_b64 vcc, vcc, s[86:87]
    s_cbranch_vccz BACK_J2D
    s_sub_u32 s3, s3, 1
    s_cbranch_scc0 SLOW_J2D
    s_mov_b32 s3, 0
    s_branch BACK_J2D
SLOW_HED:
    s_sleep 4
    buffer_load_dword v220, v255, s[40:43], s57 offen sc1
    s_waitcnt vmcnt(0)
    v_cmp_ne_u32 vcc, s77, v220
    s_cbranch_vccz BACK_HED
    s_sub_u32 s3, s3, 1
    s_cbranch_scc0 SLOW_HED
    s_mov_b32 s3, 0
    s_branch BACK_HED
SLOW_HLD:
    s_sleep 4
    buffer_load_dword v220, v255, s[40:43], s57 offen offset:64 sc1
    s_waitcnt vmcnt(0)
    v_cmp_ne_u32 vcc, s77, v220
    s_cbranch_vccz BACK_HLD
    s_sub_u32 s3, s3, 1
    s_cbranch_scc0 SLOW_HLD
    s_mov_b32 s3, 0
    s_branch BACK_HLD
SLOW_YD:
    s_sleep 4
    s_lshl_b32 m0, s52, 12
    s_nop 0
    buffer_load_dwordx4 v238, s[40:43], s74 offen sc1 lds
    s_add_u32 s84, s74, 64512
    buffer_load_dwordx4 v238, s[40:43], s84 offen offset:1024 sc1 lds
    s_sub_u32 s84, s75, 2048
    buffer_load_dwordx4 v238, s[40:43], s84 offen offset:2048 sc1 lds
    s_waitcnt vmcnt(0)
    ds_read_b64_tr_b16 v[202:203], v239
    ds_read_b64_tr_b16 v[204:205], v239 offset:32
    ds_read_b64_tr_b16 v[206:207], v239 offset:1024
    ds_read_b64_tr_b16 v[208:209], v239 offset:1056
    ds_read_b64_tr_b16 v[210:211], v239 offset:2048
    s_waitcnt lgkmcnt(0)
    v_pk_max_u16 v216, v202, v203
    v_pk_max_u16 v217, v204, v205
    v_pk_max_u16 v216, v216, v206
    v_pk_max_u16 v217, v217, v207
    v_pk_max_u16 v216, v216, v208
    v_pk_max_u16 v217, v217, v209
    v_pk_max_u16 v216, v216, v210
    v_pk_max_u16 v217, v217, v211
    v_pk_max_u16 v216, v216, v217
    v_lshlrev_b32 v217, 16, v216
    v_max_u32 v216, v216, v217
    v_cmp_le_u32 vcc, s99, v216
    s_cbranch_vccz BACK_YD
    s_sub_u32 s3, s3, 1
    s_cbranch_scc0 SLOW_YD
    s_mov_b32 s3, 0
    s_branch BACK_YD
SLOW_RD:
    s_sleep 2
    buffer_load_dwordx4 v[128:131], v244, s[40:43], s72 offen sc1
    buffer_load_dwordx4 v[132:135], v244, s[40:43], s72 offen offset:1024 sc1
    buffer_load_dwordx4 v[136:139], v244, s[40:43], s72 offen offset:2048 sc1
    buffer_load_dwordx4 v[140:143], v244, s[40:43], s72 offen offset:3072 sc1
    buffer_load_dwordx4 v[144:147], v244, s[40:43], s59 offen sc1
    buffer_load_dwordx4 v[148:151], v244, s[40:43], s59 offen offset:1024 sc1
    buffer_load_dwordx2 v[152:153], v244, s[40:43], s73 offen sc1
    buffer_load_dwordx2 v[154:155], v244, s[40:43], s73 offen offset:1024 sc1
    buffer_load_dwordx2 v[156:157], v244, s[40:43], s73 offen offset:2048 sc1
    buffer_load_dwordx2 v[158:159], v244, s[40:43], s73 offen offset:3072 sc1
    s_waitcnt vmcnt(0)
    v_max3_u32 v72, v128, v129, v130
    v_max3_u32 v73, v131, v132, v133
    v_max3_u32 v72, v72, v134, v135
    v_max3_u32 v73, v73, v136, v137
    v_max3_u32 v72, v72, v138, v139
    v_max3_u32 v73, v73, v140, v141
    v_max3_u32 v72, v72, v142, v143
    v_max3_u32 v73, v73, v144, v145
    v_max3_u32 v72, v72, v146, v147
    v_max3_u32 v73, v73, v148, v149
    v_max3_u32 v72, v72, v150, v151
    v_max3_u32 v73, v73, v152, v153
    v_max3_u32 v72, v72, v154, v155
    v_max3_u32 v73, v73, v156, v157
    v_max3_u32 v72, v72, v158, v159
    v_max_u32 v72, v72, v73
    v_cmp_eq_u32 vcc, -1, v72
    s_cbranch_vccz BACK_RD
    s_sub_u32 s3, s3, 1
    s_cbranch_scc0 SLOW_RD
    s_mov_b32 s3, 0
    s_branch BACK_RD
SLOW_J2T:
    s_sleep 4
    buffer_load_dwordx4 v[176:179], v244, s[40:43], s58 offen offset:1024 sc1
    s_waitcnt vmcnt(0)
    v_cmp_ne_u32 vcc, s77, v176
    v_cmp_ne_u32 s[86:87], s77, v177
    s_nop 0
    s_or_b64 vcc, vcc, s[86:87]
    v_cmp_ne_u32 s[86:87], s77, v178
    s_nop 0
    s_or_b64 vcc, vcc, s[86:87]
    v_cmp_ne_u32 s[86:87], s77, v179
    s_nop 0
    s_or_b64 vcc, vcc, s[86:87]
    s_cbranch_vccz BACK_J2T
    s_sub_u32 s3, s3, 1
    s_cbranch_scc0 SLOW_J2T
    s_mov_b32 s3, 0
    s_branch BACK_J2T
SLOW_HET:
    s_sleep 4
    buffer_load_dword v220, v255, s[40:43], s57 offen sc1
    s_waitcnt vmcnt(0)
    v_cmp_ne_u32 vcc, s77, v220
    s_cbranch_vccz BACK_HET
    s_sub_u32 s3, s3, 1
    s_cbranch_scc0 SLOW_HET
    s_mov_b32 s3, 0
    s_branch BACK_HET
SLOW_HLT:
    s_sleep 4
    buffer_load_dword v220, v255, s[40:43], s57 offen offset:64 sc1
    s_waitcnt vmcnt(0)
    v_cmp_ne_u32 vcc, s77, v220
    s_cbranch_vccz BACK_HLT
    s_sub_u32 s3, s3, 1
    s_cbranch_scc0 SLOW_HLT
    s_mov_b32 s3, 0
    s_branch BACK_HLT
SLOW_YT:
    s_sleep 4
    s_lshl_b32 m0, s52, 12
    s_nop 0
    buffer_load_dwordx4 v238, s[40:43], s74 offen sc1 lds
    s_add_u32 s84, s74, 64512
    buffer_load_dwordx4 v238, s[40:43], s84 offen offset:1024 sc1 lds
    s_sub_u32 s84, s75, 2048
    buffer_load_dwordx4 v238, s[40:43], s84 offen offset:2048 sc1 lds
    s_waitcnt vmcnt(0)
    ds_read_b64_tr_b16 v[202:203], v239
    ds_read_b64_tr_b16 v[204:205], v239 offset:32
    ds_read_b64_tr_b16 v[206:207], v239 offset:1024
    ds_read_b64_tr_b16 v[208:209], v239 offset:1056
    ds_read_b64_tr_b16 v[210:211], v239 offset:2048
    s_waitcnt lgkmcnt(0)
    v_pk_max_u16 v216, v202, v203
    v_pk_max_u16 v217, v204, v205
    v_pk_max_u16 v216, v216, v206
    v_pk_max_u16 v217, v217, v207
    v_pk_max_u16 v216, v216, v208
    v_pk_max_u16 v217, v217, v209
    v_pk_max_u16 v216, v216, v210
    v_pk_max_u16 v217, v217, v211
    v_pk_max_u16 v216, v216, v217
    v_lshlrev_b32 v217, 16, v216
    v_max_u32 v216, v216, v217
    v_cmp_le_u32 vcc, s99, v216
    s_cbranch_vccz BACK_YT
    s_sub_u32 s3, s3, 1
    s_cbranch_scc0 SLOW_YT
    s_mov_b32 s3, 0
    s_branch BACK_YT
SLOW_RT:
    s_sleep 2
    buffer_load_dwordx4 v[128:131], v244, s[40:43], s72 offen sc1
    buffer_load_dwordx4 v[132:135], v244, s[40:43], s72 offen offset:1024 sc1
    buffer_load_dwordx4 v[136:139], v244, s[40:43], s72 offen offset:2048 sc1
    buffer_load_dwordx4 v[140:143], v244, s[40:43], s72 offen offset:3072 sc1
    buffer_load_dwordx4 v[144:147], v244, s[40:43], s59 offen sc1
    buffer_load_dwordx4 v[148:151], v244, s[40:43], s59 offen offset:1024 sc1
    buffer_load_dwordx2 v[152:153], v244, s[40:43], s73 offen sc1
    buffer_load_dwordx2 v[154:155], v244, s[40:43], s73 offen offset:1024 sc1
    buffer_load_dwordx2 v[156:157], v244, s[40:43], s73 offen offset:2048 sc1
    buffer_load_dwordx2 v[158:159], v244, s[40:43], s73 offen offset:3072 sc1
    s_waitcnt vmcnt(0)
    v_max3_u32 v72, v128, v129, v130
    v_max3_u32 v73, v131, v132, v133
    v_max3_u32 v72, v72, v134, v135
    v_max3_u32 v73, v73, v136, v137
    v_max3_u32 v72, v72, v138, v139
    v_max3_u32 v73, v73, v140, v141
    v_max3_u32 v72, v72, v142, v143
    v_max3_u32 v73, v73, v144, v145
    v_max3_u32 v72, v72, v146, v147
    v_max3_u32 v73, v73, v148, v149
    v_max3_u32 v72, v72, v150, v151
    v_max3_u32 v73, v73, v152, v153
    v_max3_u32 v72, v72, v154, v155
    v_max3_u32 v73, v73, v156, v157
    v_max3_u32 v72, v72, v158, v159
    v_max_u32 v72, v72, v73
    v_cmp_eq_u32 vcc, -1, v72
    s_cbranch_vccz BACK_RT
    s_sub_u32 s3, s3, 1
    s_cbranch_scc0 SLOW_RT
    s_mov_b32 s3, 0
    s_branch BACK_RT
KF_END:
    s_endpgm
.section .rodata,"a"
.p2align 6
.amdhsa_kernel gated_mix__ssm_conv_h3__glu_gated_swiglu__prompt_kernel
  .amdhsa_next_free_vgpr 512
  .amdhsa_next_free_sgpr 102
  .amdhsa_accum_offset 256
  .amdhsa_group_segment_fixed_size 0
  .amdhsa_kernarg_size 112
  .amdhsa_user_sgpr_count 2
  .amdhsa_user_sgpr_kernarg_segment_ptr 1
  .amdhsa_system_sgpr_workgroup_id_x 1
.end_amdhsa_kernel
```
